```python
import torch

def _softmax(x, axis=-1):
    return torch.softmax(x, dim=axis)
def _gelu(x):
    return torch.nn.functional.gelu(x, approximate="tanh")
def _silu(x):
    return torch.nn.functional.silu(x)
def _sigmoid(x):
    return torch.sigmoid(x)
def _layernorm(x, axis=-1, eps=1e-5):
    m = x.mean(dim=axis, keepdim=True)
    v = x.var(dim=axis, keepdim=True, unbiased=False)
    return (x - m) / torch.sqrt(v + eps)
def _scatter_add(tgt, idx, src, axis=0):
    return tgt.clone().index_add_(axis, idx, src)
def _segment_sum(src, seg, n):
    out = torch.zeros((n,) + src.shape[1:], dtype=src.dtype)
    return out.index_add_(0, seg, src)
def _pad(x, pw):
    flat = tuple(v for pair in reversed(pw) for v in pair)
    return torch.nn.functional.pad(x, flat)

kernel_name = 'interleave_layers__spectral_gfnet__ssm_conv_s5__prompt'

def setup_inputs():

    _w = (lambda a: (lambda t: t.to(torch.bfloat16) if t.is_floating_point() else t)(torch.as_tensor(a)))
    def _A_setup():
        B, S, D = 1, 2048, 448
        Df = D // 2 + 1
        return {
            "x": _w((lambda *s: torch.randn(*s, dtype=torch.bfloat16) * 0.05)(B, S, D)),
            "w_r": _w((lambda *s: torch.randn(*s, dtype=torch.bfloat16) * 1.6)(S, Df) * 0.02),
            "w_i": _w((lambda *s: torch.randn(*s, dtype=torch.bfloat16) * 1.6)(S, Df) * 0.02),
        }
    _A_in = _A_setup()

    def _B_setup():
        B, S, D = 1, 2048, 448
        P = D
        Lambda_re = -0.5 * (lambda _x: torch.exp(torch.as_tensor(_x)))((lambda *s: torch.randn(*s, dtype=torch.bfloat16) * 0.2)(P))
        Lambda_im = (lambda *s: torch.randn(*s, dtype=torch.bfloat16) * 0.8)(P) * 1.0
        B_re = (lambda *s: torch.randn(*s, dtype=torch.bfloat16) * 0.2)(P, D) * (D ** -0.5)
        B_im = (lambda *s: torch.randn(*s, dtype=torch.bfloat16) * 0.2)(P, D) * (D ** -0.5)
        C_re = (lambda *s: torch.randn(*s, dtype=torch.bfloat16) * 0.2)(D, P) * (P ** -0.5)
        C_im = (lambda *s: torch.randn(*s, dtype=torch.bfloat16) * 0.2)(D, P) * (P ** -0.5)
        log_dt = (lambda *s: torch.randn(*s, dtype=torch.bfloat16) * 0.2)(P) * 0.3 - 2.0
        Dskip = (lambda *s: torch.randn(*s, dtype=torch.bfloat16) * 0.05)(D)
        return {
            "x": _w((lambda *s: torch.randn(*s, dtype=torch.bfloat16) * 0.05)(B, S, D)),
            "Lambda_re": _w(Lambda_re),
            "Lambda_im": _w(Lambda_im),
            "B_re": _w(B_re),
            "B_im": _w(B_im),
            "C_re": _w(C_re),
            "C_im": _w(C_im),
            "log_dt": _w(log_dt),
            "Dskip": _w(Dskip),
        }
    _B_in = _B_setup()

    return {
        "A_x": _A_in["x"],
        "A_w_r": _A_in["w_r"],
        "A_w_i": _A_in["w_i"],
        "B_x": _B_in["x"],
        "B_Lambda_re": _B_in["Lambda_re"],
        "B_Lambda_im": _B_in["Lambda_im"],
        "B_B_re": _B_in["B_re"],
        "B_B_im": _B_in["B_im"],
        "B_C_re": _B_in["C_re"],
        "B_C_im": _B_in["C_im"],
        "B_log_dt": _B_in["log_dt"],
        "B_Dskip": _B_in["Dskip"],
    }

def reference(A_x, A_w_r, A_w_i, B_x, B_Lambda_re, B_Lambda_im, B_B_re, B_B_im, B_C_re, B_C_im, B_log_dt, B_Dskip):
    def _A_ref(x, w_r, w_i):
        B, S, D = x.shape
        X = (lambda x, axes=(-2,-1): torch.fft.rfft2(x.float(), dim=axes))(x, axes=(-2, -1))
        W = w_r + 1j * w_i
        X = X * W
        y = (lambda x, s, axes=(-2,-1): torch.fft.irfft2(x, s=s, dim=axes).to(torch.bfloat16))(X, (S, D), axes=(-2, -1))
        return y

    def _B_ref(x, Lambda_re, Lambda_im, B_re, B_im, C_re, C_im, log_dt, Dskip):
        Bsz, L, H = x.shape
        Lam = Lambda_re + 1j * Lambda_im
        Bmat = B_re + 1j * B_im
        Cmat = C_re + 1j * C_im
        dt = torch.exp(log_dt)
        Lam_bar = torch.exp(dt * Lam)
        B_bar = ((Lam_bar - 1.0) / Lam)[:, None] * Bmat
        Bu = torch.einsum("bld,pd->blp", x + 0j, B_bar)
        h = torch.zeros_like(Bu[:, 0, :])
        hs = []
        for t in range(L):
            h = Lam_bar[None, :] * h + Bu[:, t, :]
            hs.append(h)
        hseq = torch.stack(hs, 1)
        y = 2.0 * torch.einsum("blp,dp->bld", hseq, Cmat).real + x * Dskip[None, None, :]
        return y

    x = A_x
    x = x + _A_ref(_layernorm(x, axis=-1), A_w_r, A_w_i)
    x = x + _B_ref(_layernorm(x, axis=-1), B_Lambda_re, B_Lambda_im, B_B_re, B_B_im, B_C_re, B_C_im, B_log_dt, B_Dskip)
    x = x + _A_ref(_layernorm(x, axis=-1), A_w_r, A_w_i)
    x = x + _B_ref(_layernorm(x, axis=-1), B_Lambda_re, B_Lambda_im, B_B_re, B_B_im, B_C_re, B_C_im, B_log_dt, B_Dskip)
    return x
```

```asm
; @launch kernel=km_kernel grid=(256,1,1) block=(256,1,1) lds=147456
.amdgcn_target "amdgcn-amd-amdhsa--gfx950"
.text
.globl km_kernel
.p2align 8
.type km_kernel,@function
km_kernel:
s_cmp_ge_u32 s2, 256
s_cbranch_scc1 KP_exit
s_load_dwordx2 s[4:5], s[0:1], 112
s_load_dwordx2 s[56:57], s[0:1], 104
s_cmp_ge_u32 s2, 224
s_cbranch_scc1 KP_aux
s_load_dwordx2 s[8:9], s[0:1], 0
s_load_dwordx2 s[16:17], s[0:1], 96
s_load_dwordx8 s[40:47], s[0:1], 32
s_load_dwordx8 s[48:55], s[0:1], 64
s_cmp_ge_u32 s2, 8
s_cbranch_scc1 KM_nopf
s_getpc_b64 s[28:29]
s_add_u32 s28, s28, km_kernel@rel32@lo+4
s_addc_u32 s29, s29, km_kernel@rel32@hi+12
v_lshlrev_b32 v2, 4, v0
global_load_dwordx4 v[240:243], v2, s[28:29]
v_add_u32 v2, 4096, v2
global_load_dwordx4 v[240:243], v2, s[28:29]
v_add_u32 v2, 4096, v2
global_load_dwordx4 v[240:243], v2, s[28:29]
KM_nopf:
v_and_b32 v1, 63, v0
v_lshrrev_b32 v2, 6, v0
s_nop 0
v_readfirstlane_b32 s20, v2
v_and_b32 v3, 15, v1
v_lshrrev_b32 v4, 4, v1
v_lshlrev_b32 v231, 4, v1
s_and_b32 s21, s20, 1
s_lshr_b32 s22, s20, 1
s_lshl_b32 s28, s21, 7
v_xor_b32 v230, s28, v231
s_cmp_eq_u32 s2, 0
s_cselect_b32 s25, 0, 1.0
s_lshr_b32 s28, s2, 3
s_mul_i32 s23, s28, 9363
s_lshr_b32 s23, s23, 16
s_mul_i32 s29, s23, 7
s_sub_u32 s24, s28, s29
s_and_b32 s28, s2, 7
s_lshl_b32 s28, s28, 2
s_add_u32 s23, s23, s28
s_lshl_b32 s30, s23, 2
s_add_u32 s30, s30, s20
s_mul_i32 s30, s30, 14336
s_lshl_b32 s28, s20, 14
s_mov_b32 m0, s28
s_min_u32 s59, s23, 29
s_sub_u32 s59, s59, 26
s_cmp_lt_u32 s23, 28
s_cselect_b32 s59, 1, s59
s_cmp_lt_u32 s23, 14
s_cselect_b32 s59, 0, s59
s_lshl_b32 s36, s23, 1
s_add_u32 s36, s36, s21
s_mul_i32 s36, s36, 14336
s_cmp_ge_u32 s23, 21
s_cselect_b32 s31, 21, 14
s_sub_u32 s31, s23, s31
s_lshl_b32 s31, s31, 7
s_mul_i32 s32, s20, 100352
s_add_u32 s31, s31, s32
s_cmp_eq_u32 s59, 0
s_cselect_b32 s36, s36, 0
s_cselect_b32 s37, 896, 0
s_cmp_eq_u32 s59, 1
s_cselect_b32 s36, s31, s36
s_cselect_b32 s37, 7168, s37
s_cselect_b32 s39, 0, 16
s_cselect_b64 vcc, -1, 0
s_mov_b32 s38, 0
v_lshrrev_b32 v5, 3, v1
v_mul_u32_u24 v5, 896, v5
v_and_b32 v6, 7, v1
v_bfe_u32 v7, v1, 4, 1
v_lshlrev_b32 v7, 2, v7
v_xor_b32 v6, v6, v7
v_lshl_add_u32 v5, v6, 4, v5
v_cndmask_b32 v222, v231, v5, vcc
s_mov_b32 s34, 0x3b124925
s_mov_b32 s35, 0x43e00000
v_and_b32 v120, 31, v1
s_lshl_b32 s28, s24, 6
s_lshl_b32 s29, s22, 5
s_add_u32 s28, s28, s29
s_lshl_b32 s29, s21, 3
v_xor_b32 v120, s29, v120
v_add_u32 v120, s28, v120
v_lshrrev_b32 v121, 5, v1
v_lshlrev_b32 v121, 3, v121
s_mul_i32 s28, s21, 224
v_add_u32 v121, s28, v121
v_cvt_f32_u32 v121, v121
v_lshrrev_b32 v113, 1, v120
v_and_b32 v115, 1, v120
v_cvt_f32_u32 v113, v113
v_cvt_f32_u32 v115, v115
v_cmp_eq_u32 vcc, 0, v120
v_mul_f32 v115, 0x3e800000, v115
v_mov_b32 v112, 0x3d88d677
v_mov_b32 v116, 0x43600000
v_mov_b32 v117, 0x3d41848f
v_cndmask_b32 v113, v113, v116, vcc
v_cndmask_b32 v112, v112, v117, vcc
v_cmp_eq_u32 vcc, 1, v120
v_mov_b32 v117, 0x3d41848f
v_add_f32 v116, 0x42c00000, v121
v_cndmask_b32 v115, v115, 0, vcc
v_cndmask_b32 v112, v112, v117, vcc
v_mul_f32 v116, v116, v113
v_mul_f32 v119, 0x41800000, v113
v_mul_f32 v117, s34, v116
v_mul_f32 v118, s34, v119
v_rndne_f32 v117, v117
v_rndne_f32 v118, v118
v_fma_f32 v116, -v117, s35, v116
v_fma_f32 v119, -v118, s35, v119
v_fma_f32 v116, v116, s34, v115
v_mul_f32 v119, s34, v119
v_mul_f32 v118, s34, v113
v_cos_f32 v114, v119
v_add_f32 v119, v119, v116
v_cos_f32 v80, v116
v_add_f32 v116, v116, v118
v_cos_f32 v88, v119
v_add_f32 v119, v119, v118
v_cos_f32 v81, v116
v_add_f32 v116, v116, v118
v_cos_f32 v89, v119
v_add_f32 v119, v119, v118
v_cos_f32 v82, v116
v_add_f32 v116, v116, v118
v_cos_f32 v90, v119
v_add_f32 v119, v119, v118
v_cos_f32 v83, v116
v_add_f32 v116, v116, v118
v_cos_f32 v91, v119
v_add_f32 v119, v119, v118
v_cos_f32 v84, v116
v_add_f32 v116, v116, v118
v_cos_f32 v92, v119
v_add_f32 v119, v119, v118
v_cos_f32 v85, v116
v_add_f32 v116, v116, v118
v_cos_f32 v93, v119
v_add_f32 v119, v119, v118
v_cos_f32 v86, v116
v_add_f32 v116, v116, v118
v_cos_f32 v94, v119
v_add_f32 v119, v119, v118
v_cos_f32 v87, v116
v_cos_f32 v95, v119
s_mul_i32 s29, s23, 7
s_add_u32 s29, s29, s24
s_lshl_b32 s29, s29, 1
s_add_u32 s29, s29, s21
s_lshl_b32 s29, s29, 11
s_lshl_b32 s31, s24, 2
s_add_u32 s31, s31, s20
s_mul_i32 s31, s31, 14336
s_mul_i32 s28, s20, 100352
s_sub_u32 s28, s36, s28
s_add_u32 s31, s31, s28
s_cmp_eq_u32 s59, 1
s_cselect_b32 s29, s31, s29
s_cselect_b32 s31, s37, 1024
s_add_u32 s31, s31, s29
s_mul_i32 s32, s23, 7
s_add_u32 s32, s32, s24
s_lshl_b32 s32, s32, 2
s_add_u32 s32, s32, s20
s_lshl_b32 s32, s32, 11
s_waitcnt lgkmcnt(0)
s_mov_b32 s10, 1835008
s_mov_b32 s11, 0x20000
s_mov_b32 s6, 30408704
s_mov_b32 s7, 0x20000
s_mov_b32 s18, 3670016
s_mov_b32 s19, 0x20000
s_cmp_eq_u32 s22, 0
s_cselect_b32 s12, s44, s46
s_cselect_b32 s13, s45, s47
s_cmp_ge_u32 s23, 21
s_cselect_b32 s48, s50, s48
s_cselect_b32 s49, s51, s49
s_cmp_eq_u32 s59, 1
s_cselect_b32 s12, s48, s12
s_cselect_b32 s13, s49, s13
s_cmp_ge_u32 s59, 2
s_cselect_b32 s12, s54, s12
s_cselect_b32 s13, s55, s13
s_mov_b32 s14, 401408
s_cselect_b32 s14, 896, s14
s_cmp_eq_u32 s59, 3
s_cselect_b32 s14, 0, s14
s_mov_b32 s15, 0x20000
buffer_load_dwordx4 v[248:251], v231, s[8:11], s32 offen
buffer_load_dwordx4 v[252:255], v231, s[8:11], s32 offen offset:1024
buffer_load_dwordx4 v231, s[8:11], s30 offen lds
s_add_u32 m0, m0, 1024
s_add_u32 s30, s30, 896
v_xor_b32 v2, 16, v231
buffer_load_dwordx4 v2, s[8:11], s30 offen lds
s_add_u32 m0, m0, 1024
s_add_u32 s30, s30, 896
v_xor_b32 v2, 32, v231
buffer_load_dwordx4 v2, s[8:11], s30 offen lds
s_add_u32 m0, m0, 1024
s_add_u32 s30, s30, 896
v_xor_b32 v2, 48, v231
buffer_load_dwordx4 v2, s[8:11], s30 offen lds
s_add_u32 m0, m0, 1024
s_add_u32 s30, s30, 896
v_xor_b32 v2, 64, v231
buffer_load_dwordx4 v2, s[8:11], s30 offen lds
s_add_u32 m0, m0, 1024
s_add_u32 s30, s30, 896
v_xor_b32 v2, 80, v231
buffer_load_dwordx4 v2, s[8:11], s30 offen lds
s_add_u32 m0, m0, 1024
s_add_u32 s30, s30, 896
v_xor_b32 v2, 96, v231
buffer_load_dwordx4 v2, s[8:11], s30 offen lds
s_add_u32 m0, m0, 1024
s_add_u32 s30, s30, 896
v_xor_b32 v2, 112, v231
buffer_load_dwordx4 v2, s[8:11], s30 offen lds
s_add_u32 m0, m0, 1024
s_add_u32 s30, s30, 896
v_xor_b32 v2, 128, v231
buffer_load_dwordx4 v2, s[8:11], s30 offen lds
s_add_u32 m0, m0, 1024
s_add_u32 s30, s30, 896
v_xor_b32 v2, 144, v231
buffer_load_dwordx4 v2, s[8:11], s30 offen lds
s_add_u32 m0, m0, 1024
s_add_u32 s30, s30, 896
v_xor_b32 v2, 160, v231
buffer_load_dwordx4 v2, s[8:11], s30 offen lds
s_add_u32 m0, m0, 1024
s_add_u32 s30, s30, 896
v_xor_b32 v2, 176, v231
buffer_load_dwordx4 v2, s[8:11], s30 offen lds
s_add_u32 m0, m0, 1024
s_add_u32 s30, s30, 896
v_xor_b32 v2, 192, v231
buffer_load_dwordx4 v2, s[8:11], s30 offen lds
s_add_u32 m0, m0, 1024
s_add_u32 s30, s30, 896
v_xor_b32 v2, 208, v231
buffer_load_dwordx4 v2, s[8:11], s30 offen lds
s_add_u32 m0, m0, 1024
s_add_u32 s30, s30, 896
v_xor_b32 v2, 224, v231
buffer_load_dwordx4 v2, s[8:11], s30 offen lds
s_add_u32 m0, m0, 1024
s_add_u32 s30, s30, 896
v_xor_b32 v2, 240, v231
buffer_load_dwordx4 v2, s[8:11], s30 offen lds
buffer_load_dwordx4 v[240:243], v222, s[12:15], s29 offen
buffer_load_dwordx4 v[244:247], v222, s[12:15], s31 offen
s_lshl_b32 s28, s20, 14
s_add_u32 s28, s28, 81920
s_mov_b32 m0, s28
s_lshl_b32 s31, s24, 2
s_add_u32 s31, s31, s20
s_mul_i32 s26, s31, 28672
s_add_u32 s26, s26, 15728640
s_mul_i32 s27, s31, 14336
s_add_u32 s27, s27, 16777216
s_lshl_b32 s31, s31, 5
s_lshl_b32 s58, s24, 1
s_add_u32 s58, s58, s21
s_lshl_b32 s58, s58, 1
s_add_u32 s58, s58, s22
s_mul_i32 s58, s58, 28672
s_add_u32 s58, s58, 17825792
v_lshl_add_u32 v5, v3, 1, s31
s_min_u32 s28, s23, 13
s_lshl_b32 s28, s28, 6
v_and_b32 v6, 31, v1
v_lshl_add_u32 v6, v6, 1, s28
v_add_f32 v114, v114, v114
v_pk_mul_f32 v[80:81], v[80:81], v[112:113] op_sel_hi:[1,0]
v_pk_mul_f32 v[82:83], v[82:83], v[112:113] op_sel_hi:[1,0]
v_pk_mul_f32 v[84:85], v[84:85], v[112:113] op_sel_hi:[1,0]
v_pk_mul_f32 v[86:87], v[86:87], v[112:113] op_sel_hi:[1,0]
v_pk_mul_f32 v[88:89], v[88:89], v[112:113] op_sel_hi:[1,0]
v_pk_mul_f32 v[90:91], v[90:91], v[112:113] op_sel_hi:[1,0]
v_pk_mul_f32 v[92:93], v[92:93], v[112:113] op_sel_hi:[1,0]
v_pk_mul_f32 v[94:95], v[94:95], v[112:113] op_sel_hi:[1,0]
v_pk_fma_f32 v[96:97], v[114:115], v[80:81], v[88:89] op_sel_hi:[0,1,1] neg_lo:[0,0,1] neg_hi:[0,0,1]
v_pk_fma_f32 v[98:99], v[114:115], v[82:83], v[90:91] op_sel_hi:[0,1,1] neg_lo:[0,0,1] neg_hi:[0,0,1]
v_pk_fma_f32 v[100:101], v[114:115], v[84:85], v[92:93] op_sel_hi:[0,1,1] neg_lo:[0,0,1] neg_hi:[0,0,1]
v_pk_fma_f32 v[102:103], v[114:115], v[86:87], v[94:95] op_sel_hi:[0,1,1] neg_lo:[0,0,1] neg_hi:[0,0,1]
v_pk_fma_f32 v[104:105], v[114:115], v[88:89], v[80:81] op_sel_hi:[0,1,1] neg_lo:[0,0,1] neg_hi:[0,0,1]
v_pk_fma_f32 v[106:107], v[114:115], v[90:91], v[82:83] op_sel_hi:[0,1,1] neg_lo:[0,0,1] neg_hi:[0,0,1]
v_pk_fma_f32 v[108:109], v[114:115], v[92:93], v[84:85] op_sel_hi:[0,1,1] neg_lo:[0,0,1] neg_hi:[0,0,1]
v_pk_fma_f32 v[110:111], v[114:115], v[94:95], v[86:87] op_sel_hi:[0,1,1] neg_lo:[0,0,1] neg_hi:[0,0,1]
v_cvt_pk_bf16_f32 v32, v80, v81
v_cvt_pk_bf16_f32 v33, v82, v83
v_cvt_pk_bf16_f32 v34, v84, v85
v_cvt_pk_bf16_f32 v35, v86, v87
v_cvt_pk_bf16_f32 v36, v88, v89
v_cvt_pk_bf16_f32 v37, v90, v91
v_cvt_pk_bf16_f32 v38, v92, v93
v_cvt_pk_bf16_f32 v39, v94, v95
v_pk_fma_f32 v[88:89], v[114:115], v[104:105], v[88:89] op_sel_hi:[0,1,1] neg_lo:[0,0,1] neg_hi:[0,0,1]
v_pk_fma_f32 v[90:91], v[114:115], v[106:107], v[90:91] op_sel_hi:[0,1,1] neg_lo:[0,0,1] neg_hi:[0,0,1]
v_pk_fma_f32 v[92:93], v[114:115], v[108:109], v[92:93] op_sel_hi:[0,1,1] neg_lo:[0,0,1] neg_hi:[0,0,1]
v_pk_fma_f32 v[94:95], v[114:115], v[110:111], v[94:95] op_sel_hi:[0,1,1] neg_lo:[0,0,1] neg_hi:[0,0,1]
v_pk_fma_f32 v[80:81], v[114:115], v[96:97], v[80:81] op_sel_hi:[0,1,1] neg_lo:[0,0,1] neg_hi:[0,0,1]
v_pk_fma_f32 v[82:83], v[114:115], v[98:99], v[82:83] op_sel_hi:[0,1,1] neg_lo:[0,0,1] neg_hi:[0,0,1]
v_pk_fma_f32 v[84:85], v[114:115], v[100:101], v[84:85] op_sel_hi:[0,1,1] neg_lo:[0,0,1] neg_hi:[0,0,1]
v_pk_fma_f32 v[86:87], v[114:115], v[102:103], v[86:87] op_sel_hi:[0,1,1] neg_lo:[0,0,1] neg_hi:[0,0,1]
v_cvt_pk_bf16_f32 v40, v104, v105
v_cvt_pk_bf16_f32 v41, v106, v107
v_cvt_pk_bf16_f32 v42, v108, v109
v_cvt_pk_bf16_f32 v43, v110, v111
v_cvt_pk_bf16_f32 v28, v96, v97
v_cvt_pk_bf16_f32 v29, v98, v99
v_cvt_pk_bf16_f32 v30, v100, v101
v_cvt_pk_bf16_f32 v31, v102, v103
v_pk_fma_f32 v[104:105], v[114:115], v[88:89], v[104:105] op_sel_hi:[0,1,1] neg_lo:[0,0,1] neg_hi:[0,0,1]
v_pk_fma_f32 v[106:107], v[114:115], v[90:91], v[106:107] op_sel_hi:[0,1,1] neg_lo:[0,0,1] neg_hi:[0,0,1]
v_pk_fma_f32 v[108:109], v[114:115], v[92:93], v[108:109] op_sel_hi:[0,1,1] neg_lo:[0,0,1] neg_hi:[0,0,1]
v_pk_fma_f32 v[110:111], v[114:115], v[94:95], v[110:111] op_sel_hi:[0,1,1] neg_lo:[0,0,1] neg_hi:[0,0,1]
v_pk_fma_f32 v[96:97], v[114:115], v[80:81], v[96:97] op_sel_hi:[0,1,1] neg_lo:[0,0,1] neg_hi:[0,0,1]
v_pk_fma_f32 v[98:99], v[114:115], v[82:83], v[98:99] op_sel_hi:[0,1,1] neg_lo:[0,0,1] neg_hi:[0,0,1]
v_pk_fma_f32 v[100:101], v[114:115], v[84:85], v[100:101] op_sel_hi:[0,1,1] neg_lo:[0,0,1] neg_hi:[0,0,1]
v_pk_fma_f32 v[102:103], v[114:115], v[86:87], v[102:103] op_sel_hi:[0,1,1] neg_lo:[0,0,1] neg_hi:[0,0,1]
v_cvt_pk_bf16_f32 v44, v88, v89
v_cvt_pk_bf16_f32 v45, v90, v91
v_cvt_pk_bf16_f32 v46, v92, v93
v_cvt_pk_bf16_f32 v47, v94, v95
v_cvt_pk_bf16_f32 v24, v80, v81
v_cvt_pk_bf16_f32 v25, v82, v83
v_cvt_pk_bf16_f32 v26, v84, v85
v_cvt_pk_bf16_f32 v27, v86, v87
v_pk_fma_f32 v[88:89], v[114:115], v[104:105], v[88:89] op_sel_hi:[0,1,1] neg_lo:[0,0,1] neg_hi:[0,0,1]
v_pk_fma_f32 v[90:91], v[114:115], v[106:107], v[90:91] op_sel_hi:[0,1,1] neg_lo:[0,0,1] neg_hi:[0,0,1]
v_pk_fma_f32 v[92:93], v[114:115], v[108:109], v[92:93] op_sel_hi:[0,1,1] neg_lo:[0,0,1] neg_hi:[0,0,1]
v_pk_fma_f32 v[94:95], v[114:115], v[110:111], v[94:95] op_sel_hi:[0,1,1] neg_lo:[0,0,1] neg_hi:[0,0,1]
v_pk_fma_f32 v[80:81], v[114:115], v[96:97], v[80:81] op_sel_hi:[0,1,1] neg_lo:[0,0,1] neg_hi:[0,0,1]
v_pk_fma_f32 v[82:83], v[114:115], v[98:99], v[82:83] op_sel_hi:[0,1,1] neg_lo:[0,0,1] neg_hi:[0,0,1]
v_pk_fma_f32 v[84:85], v[114:115], v[100:101], v[84:85] op_sel_hi:[0,1,1] neg_lo:[0,0,1] neg_hi:[0,0,1]
v_pk_fma_f32 v[86:87], v[114:115], v[102:103], v[86:87] op_sel_hi:[0,1,1] neg_lo:[0,0,1] neg_hi:[0,0,1]
v_cvt_pk_bf16_f32 v48, v104, v105
v_cvt_pk_bf16_f32 v49, v106, v107
v_cvt_pk_bf16_f32 v50, v108, v109
v_cvt_pk_bf16_f32 v51, v110, v111
v_cvt_pk_bf16_f32 v20, v96, v97
v_cvt_pk_bf16_f32 v21, v98, v99
v_cvt_pk_bf16_f32 v22, v100, v101
v_cvt_pk_bf16_f32 v23, v102, v103
v_pk_fma_f32 v[104:105], v[114:115], v[88:89], v[104:105] op_sel_hi:[0,1,1] neg_lo:[0,0,1] neg_hi:[0,0,1]
v_pk_fma_f32 v[106:107], v[114:115], v[90:91], v[106:107] op_sel_hi:[0,1,1] neg_lo:[0,0,1] neg_hi:[0,0,1]
v_pk_fma_f32 v[108:109], v[114:115], v[92:93], v[108:109] op_sel_hi:[0,1,1] neg_lo:[0,0,1] neg_hi:[0,0,1]
v_pk_fma_f32 v[110:111], v[114:115], v[94:95], v[110:111] op_sel_hi:[0,1,1] neg_lo:[0,0,1] neg_hi:[0,0,1]
v_pk_fma_f32 v[96:97], v[114:115], v[80:81], v[96:97] op_sel_hi:[0,1,1] neg_lo:[0,0,1] neg_hi:[0,0,1]
v_pk_fma_f32 v[98:99], v[114:115], v[82:83], v[98:99] op_sel_hi:[0,1,1] neg_lo:[0,0,1] neg_hi:[0,0,1]
v_pk_fma_f32 v[100:101], v[114:115], v[84:85], v[100:101] op_sel_hi:[0,1,1] neg_lo:[0,0,1] neg_hi:[0,0,1]
v_pk_fma_f32 v[102:103], v[114:115], v[86:87], v[102:103] op_sel_hi:[0,1,1] neg_lo:[0,0,1] neg_hi:[0,0,1]
v_cvt_pk_bf16_f32 v52, v88, v89
v_cvt_pk_bf16_f32 v53, v90, v91
v_cvt_pk_bf16_f32 v54, v92, v93
v_cvt_pk_bf16_f32 v55, v94, v95
v_cvt_pk_bf16_f32 v16, v80, v81
v_cvt_pk_bf16_f32 v17, v82, v83
v_cvt_pk_bf16_f32 v18, v84, v85
v_cvt_pk_bf16_f32 v19, v86, v87
v_pk_fma_f32 v[88:89], v[114:115], v[104:105], v[88:89] op_sel_hi:[0,1,1] neg_lo:[0,0,1] neg_hi:[0,0,1]
v_pk_fma_f32 v[90:91], v[114:115], v[106:107], v[90:91] op_sel_hi:[0,1,1] neg_lo:[0,0,1] neg_hi:[0,0,1]
v_pk_fma_f32 v[92:93], v[114:115], v[108:109], v[92:93] op_sel_hi:[0,1,1] neg_lo:[0,0,1] neg_hi:[0,0,1]
v_pk_fma_f32 v[94:95], v[114:115], v[110:111], v[94:95] op_sel_hi:[0,1,1] neg_lo:[0,0,1] neg_hi:[0,0,1]
v_pk_fma_f32 v[80:81], v[114:115], v[96:97], v[80:81] op_sel_hi:[0,1,1] neg_lo:[0,0,1] neg_hi:[0,0,1]
v_pk_fma_f32 v[82:83], v[114:115], v[98:99], v[82:83] op_sel_hi:[0,1,1] neg_lo:[0,0,1] neg_hi:[0,0,1]
v_pk_fma_f32 v[84:85], v[114:115], v[100:101], v[84:85] op_sel_hi:[0,1,1] neg_lo:[0,0,1] neg_hi:[0,0,1]
v_pk_fma_f32 v[86:87], v[114:115], v[102:103], v[86:87] op_sel_hi:[0,1,1] neg_lo:[0,0,1] neg_hi:[0,0,1]
v_cvt_pk_bf16_f32 v56, v104, v105
v_cvt_pk_bf16_f32 v57, v106, v107
v_cvt_pk_bf16_f32 v58, v108, v109
v_cvt_pk_bf16_f32 v59, v110, v111
v_cvt_pk_bf16_f32 v12, v96, v97
v_cvt_pk_bf16_f32 v13, v98, v99
v_cvt_pk_bf16_f32 v14, v100, v101
v_cvt_pk_bf16_f32 v15, v102, v103
v_cvt_pk_bf16_f32 v60, v88, v89
v_cvt_pk_bf16_f32 v61, v90, v91
v_cvt_pk_bf16_f32 v62, v92, v93
v_cvt_pk_bf16_f32 v63, v94, v95
v_cvt_pk_bf16_f32 v8, v80, v81
v_cvt_pk_bf16_f32 v9, v82, v83
v_cvt_pk_bf16_f32 v10, v84, v85
v_cvt_pk_bf16_f32 v11, v86, v87
s_lshl_b32 s28, s20, 12
s_add_u32 s28, s28, 65536
s_xor_b32 s29, s28, 4096
v_add_u32 v223, s28, v231
v_add_u32 v224, s29, v231
v_and_b32 v225, 31, v1
v_lshrrev_b32 v226, 5, v1
v_xor_b32 v226, v226, v3
v_lshlrev_b32 v226, 4, v226
v_lshl_add_u32 v225, v225, 10, v226
v_cmp_eq_u32 s[44:45], 1, v4
v_cmp_eq_u32 s[46:47], 2, v4
v_cmp_eq_u32 s[48:49], 3, v4
v_mov_b32 v248, -1
v_mov_b32 v249, -1
v_mov_b32 v250, -1
v_mov_b32 v251, -1
s_lshl_b32 s29, s2, 2
s_add_u32 s29, s29, s20
s_lshl_b32 s29, s29, 11
s_add_u32 s29, s29, 3145728
s_lshl_b32 s28, s20, 4
v_add_u32 v7, s28, v3
v_cvt_f32_u32 v160, v7
v_cvt_f32_u32 v163, v4
v_mul_f32 v162, 0x3c800000, v160
v_mul_f32 v161, 4.0, v163
v_mul_f32 v161, v161, v162
v_mul_f32 v164, 0x41500000, v162
v_cos_f32 v168, v161
v_sin_f32 v176, v161
v_add_f32 v161, v161, v162
v_cos_f32 v169, v161
v_sin_f32 v177, v161
v_add_f32 v161, v161, v162
v_cos_f32 v170, v161
v_sin_f32 v178, v161
v_add_f32 v161, v161, v162
v_cos_f32 v171, v161
v_sin_f32 v179, v161
v_add_f32 v161, v161, v164
v_cos_f32 v172, v161
v_sin_f32 v180, v161
v_add_f32 v161, v161, v162
v_cos_f32 v173, v161
v_sin_f32 v181, v161
v_add_f32 v161, v161, v162
v_cos_f32 v174, v161
v_sin_f32 v182, v161
v_add_f32 v161, v161, v162
v_cos_f32 v175, v161
v_sin_f32 v183, v161
v_and_b32 v7, 1, v7
v_lshlrev_b32 v7, 15, v7
v_lshl_or_b32 v7, v7, 16, v7
v_cvt_pk_bf16_f32 v80, v168, v169
v_cvt_pk_bf16_f32 v88, v176, v177
v_cvt_pk_bf16_f32 v81, v170, v171
v_cvt_pk_bf16_f32 v89, v178, v179
v_cvt_pk_bf16_f32 v82, v172, v173
v_cvt_pk_bf16_f32 v90, v180, v181
v_cvt_pk_bf16_f32 v83, v174, v175
v_cvt_pk_bf16_f32 v91, v182, v183
v_xor_b32 v84, v7, v80
v_xor_b32 v92, v7, v88
v_xor_b32 v85, v7, v81
v_xor_b32 v93, v7, v89
v_xor_b32 v86, v7, v82
v_xor_b32 v94, v7, v90
v_xor_b32 v87, v7, v83
v_xor_b32 v95, v7, v91
v_xor_b32 v96, 0x80008000, v88
v_xor_b32 v97, 0x80008000, v89
v_xor_b32 v98, 0x80008000, v90
v_xor_b32 v99, 0x80008000, v91
v_xor_b32 v100, 0x80008000, v92
v_xor_b32 v101, 0x80008000, v93
v_xor_b32 v102, 0x80008000, v94
v_xor_b32 v103, 0x80008000, v95
v_lshlrev_b32 v2, 2, v0
v_mov_b32 v7, -1
s_lshl_b32 s28, s2, 10
s_add_u32 s28, s28, 19922944
buffer_store_dword v7, v2, s[4:7], s28 offen sc1
global_load_ushort v232, v5, s[40:41]
global_load_ushort v233, v5, s[42:43]
global_load_ushort v234, v5, s[52:53]
global_load_ushort v228, v5, s[54:55]
global_load_ushort v235, v6, s[40:41]
global_load_ushort v236, v6, s[42:43]
global_load_ushort v237, v6, s[52:53]
s_waitcnt vmcnt(10)
s_barrier
s_mul_i32 s33, s21, 448
v_xor_b32 v226, s33, v225
s_add_u32 s33, s33, 32
ds_read_b128 v[190:193], v226
ds_read_b128 v[194:197], v226 offset:32768
v_xor_b32 v226, s33, v225
s_add_u32 s33, s33, 32
ds_read_b128 v[198:201], v226
ds_read_b128 v[202:205], v226 offset:32768
v_xor_b32 v226, s33, v225
s_add_u32 s33, s33, 32
ds_read_b128 v[206:209], v226
ds_read_b128 v[210:213], v226 offset:32768
v_xor_b32 v226, s33, v225
s_add_u32 s33, s33, 32
ds_read_b128 v[214:217], v226
ds_read_b128 v[218:221], v226 offset:32768
s_waitcnt lgkmcnt(6)
v_mfma_f32_32x32x16_bf16 v[64:79], v[8:11], v[190:193], 0
v_and_b32 v227, 31, v1
v_xor_b32 v2, s38, v222
buffer_load_dwordx4 v2, s[12:15], s36 offen lds
s_add_u32 m0, m0, 1024
s_add_u32 s36, s36, s37
s_add_u32 s38, s38, s39
v_mfma_f32_32x32x16_bf16 v[144:159], v[8:11], v[194:197], 0
v_lshlrev_b32 v227, 2, v227
v_xor_b32 v2, s38, v222
buffer_load_dwordx4 v2, s[12:15], s36 offen lds
s_add_u32 m0, m0, 1024
s_add_u32 s36, s36, s37
s_add_u32 s38, s38, s39
v_xor_b32 v226, s33, v225
s_add_u32 s33, s33, 32
ds_read_b128 v[190:193], v226
ds_read_b128 v[194:197], v226 offset:32768
s_waitcnt lgkmcnt(6)
v_mfma_f32_32x32x16_bf16 v[64:79], v[12:15], v[198:201], v[64:79]
v_lshrrev_b32 v6, 5, v1
v_xor_b32 v2, s38, v222
buffer_load_dwordx4 v2, s[12:15], s36 offen lds
s_add_u32 m0, m0, 1024
s_add_u32 s36, s36, s37
s_add_u32 s38, s38, s39
v_mfma_f32_32x32x16_bf16 v[144:159], v[12:15], v[202:205], v[144:159]
v_lshl_add_u32 v229, v6, 9, v227
v_xor_b32 v2, s38, v222
buffer_load_dwordx4 v2, s[12:15], s36 offen lds
s_add_u32 m0, m0, 1024
s_add_u32 s36, s36, s37
s_add_u32 s38, s38, s39
v_xor_b32 v226, s33, v225
s_add_u32 s33, s33, 32
ds_read_b128 v[198:201], v226
ds_read_b128 v[202:205], v226 offset:32768
s_waitcnt lgkmcnt(6)
v_mfma_f32_32x32x16_bf16 v[64:79], v[16:19], v[206:209], v[64:79]
v_lshl_add_u32 v227, v6, 7, v227
v_xor_b32 v2, s38, v222
buffer_load_dwordx4 v2, s[12:15], s36 offen lds
s_add_u32 m0, m0, 1024
s_add_u32 s36, s36, s37
s_add_u32 s38, s38, s39
v_mfma_f32_32x32x16_bf16 v[144:159], v[16:19], v[210:213], v[144:159]
s_lshl_b32 s28, s22, 12
v_xor_b32 v2, s38, v222
buffer_load_dwordx4 v2, s[12:15], s36 offen lds
s_add_u32 m0, m0, 1024
s_add_u32 s36, s36, s37
s_add_u32 s38, s38, s39
v_xor_b32 v226, s33, v225
s_add_u32 s33, s33, 32
ds_read_b128 v[206:209], v226
ds_read_b128 v[210:213], v226 offset:32768
s_waitcnt lgkmcnt(6)
v_mfma_f32_32x32x16_bf16 v[64:79], v[20:23], v[214:217], v[64:79]
s_lshl_b32 s29, s21, 10
v_xor_b32 v2, s38, v222
buffer_load_dwordx4 v2, s[12:15], s36 offen lds
s_add_u32 m0, m0, 1024
s_add_u32 s36, s36, s37
s_add_u32 s38, s38, s39
v_mfma_f32_32x32x16_bf16 v[144:159], v[20:23], v[218:221], v[144:159]
s_add_u32 s28, s28, s29
v_xor_b32 v2, s38, v222
buffer_load_dwordx4 v2, s[12:15], s36 offen lds
s_add_u32 m0, m0, 1024
s_add_u32 s36, s36, s37
s_add_u32 s38, s38, s39
v_xor_b32 v226, s33, v225
s_add_u32 s33, s33, 32
ds_read_b128 v[214:217], v226
ds_read_b128 v[218:221], v226 offset:32768
s_waitcnt lgkmcnt(6)
v_mfma_f32_32x32x16_bf16 v[64:79], v[24:27], v[190:193], v[64:79]
v_add_u32 v229, s28, v229
v_xor_b32 v2, s38, v222
buffer_load_dwordx4 v2, s[12:15], s36 offen lds
s_add_u32 m0, m0, 1024
s_add_u32 s36, s36, s37
s_add_u32 s38, s38, s39
v_mfma_f32_32x32x16_bf16 v[144:159], v[24:27], v[194:197], v[144:159]
s_lshl_b32 s28, s20, 8
v_xor_b32 v226, s33, v225
s_add_u32 s33, s33, 32
ds_read_b128 v[190:193], v226
ds_read_b128 v[194:197], v226 offset:32768
s_waitcnt lgkmcnt(6)
v_mfma_f32_32x32x16_bf16 v[64:79], v[28:31], v[198:201], v[64:79]
v_add_u32 v227, s28, v227
v_xor_b32 v2, s38, v222
buffer_load_dwordx4 v2, s[12:15], s36 offen lds
s_add_u32 m0, m0, 1024
s_add_u32 s36, s36, s37
s_add_u32 s38, s38, s39
v_mfma_f32_32x32x16_bf16 v[144:159], v[28:31], v[202:205], v[144:159]
v_lshlrev_b32 v5, 13, v4
v_xor_b32 v226, s33, v225
s_add_u32 s33, s33, 32
ds_read_b128 v[198:201], v226
ds_read_b128 v[202:205], v226 offset:32768
s_waitcnt lgkmcnt(6)
v_mfma_f32_32x32x16_bf16 v[64:79], v[32:35], v[206:209], v[64:79]
v_lshl_add_u32 v5, v3, 4, v5
v_xor_b32 v2, s38, v222
buffer_load_dwordx4 v2, s[12:15], s36 offen lds
s_add_u32 m0, m0, 1024
s_add_u32 s36, s36, s37
s_add_u32 s38, s38, s39
v_mfma_f32_32x32x16_bf16 v[144:159], v[32:35], v[210:213], v[144:159]
s_lshl_b32 s28, s20, 11
v_xor_b32 v226, s33, v225
s_add_u32 s33, s33, 32
ds_read_b128 v[206:209], v226
ds_read_b128 v[210:213], v226 offset:32768
s_waitcnt lgkmcnt(6)
v_mfma_f32_32x32x16_bf16 v[64:79], v[36:39], v[214:217], v[64:79]
v_add_u32 v6, s28, v231
v_xor_b32 v2, s38, v222
buffer_load_dwordx4 v2, s[12:15], s36 offen lds
s_add_u32 m0, m0, 1024
s_add_u32 s36, s36, s37
s_add_u32 s38, s38, s39
v_mfma_f32_32x32x16_bf16 v[144:159], v[36:39], v[218:221], v[144:159]
s_lshl_b32 s28, s24, 2
v_xor_b32 v226, s33, v225
s_add_u32 s33, s33, 32
ds_read_b128 v[214:217], v226
ds_read_b128 v[218:221], v226 offset:32768
s_waitcnt lgkmcnt(6)
v_mfma_f32_32x32x16_bf16 v[64:79], v[40:43], v[190:193], v[64:79]
s_add_u32 s28, s28, s20
v_xor_b32 v2, s38, v222
buffer_load_dwordx4 v2, s[12:15], s36 offen lds
s_add_u32 m0, m0, 1024
s_add_u32 s36, s36, s37
s_add_u32 s38, s38, s39
v_mfma_f32_32x32x16_bf16 v[144:159], v[40:43], v[194:197], v[144:159]
s_lshl_b32 s28, s28, 16
v_xor_b32 v226, s33, v225
s_add_u32 s33, s33, 32
ds_read_b128 v[190:193], v226
ds_read_b128 v[194:197], v226 offset:32768
s_waitcnt lgkmcnt(6)
v_mfma_f32_32x32x16_bf16 v[64:79], v[44:47], v[198:201], v[64:79]
s_lshl_b32 s29, s23, 8
v_xor_b32 v2, s38, v222
buffer_load_dwordx4 v2, s[12:15], s36 offen lds
s_add_u32 m0, m0, 1024
s_add_u32 s36, s36, s37
s_add_u32 s38, s38, s39
v_mfma_f32_32x32x16_bf16 v[144:159], v[44:47], v[202:205], v[144:159]
s_add_u32 s28, s28, s29
v_xor_b32 v226, s33, v225
s_add_u32 s33, s33, 32
ds_read_b128 v[198:201], v226
ds_read_b128 v[202:205], v226 offset:32768
s_waitcnt lgkmcnt(6)
v_mfma_f32_32x32x16_bf16 v[64:79], v[48:51], v[206:209], v[64:79]
s_add_u32 s28, s28, 0
v_xor_b32 v2, s38, v222
buffer_load_dwordx4 v2, s[12:15], s36 offen lds
s_add_u32 m0, m0, 1024
s_add_u32 s36, s36, s37
s_add_u32 s38, s38, s39
v_mfma_f32_32x32x16_bf16 v[144:159], v[48:51], v[210:213], v[144:159]
s_add_u32 s30, s28, 32768
s_waitcnt lgkmcnt(4)
v_mfma_f32_32x32x16_bf16 v[64:79], v[52:55], v[214:217], v[64:79]
s_add_u32 s29, s29, 20611072
v_xor_b32 v2, s38, v222
buffer_load_dwordx4 v2, s[12:15], s36 offen lds
s_add_u32 m0, m0, 1024
s_add_u32 s36, s36, s37
s_add_u32 s38, s38, s39
v_mfma_f32_32x32x16_bf16 v[144:159], v[52:55], v[218:221], v[144:159]
s_waitcnt lgkmcnt(2)
v_mfma_f32_32x32x16_bf16 v[64:79], v[56:59], v[190:193], v[64:79]
v_mfma_f32_32x32x16_bf16 v[144:159], v[56:59], v[194:197], v[144:159]
s_waitcnt lgkmcnt(0)
v_mfma_f32_32x32x16_bf16 v[64:79], v[60:63], v[198:201], v[64:79]
v_mfma_f32_32x32x16_bf16 v[144:159], v[60:63], v[202:205], v[144:159]
s_nop 10
ds_write_b128 v223, v[68:71] offset:0
ds_write_b128 v223, v[76:79] offset:1024
ds_write_b128 v223, v[148:151] offset:2048
ds_write_b128 v223, v[156:159] offset:3072
s_waitcnt lgkmcnt(0)
s_barrier
ds_read_b128 v[190:193], v224 offset:0
ds_read_b128 v[194:197], v224 offset:1024
ds_read_b128 v[198:201], v224 offset:2048
ds_read_b128 v[202:205], v224 offset:3072
s_waitcnt lgkmcnt(3)
v_pk_add_f32 v[64:65], v[64:65], v[190:191]
v_pk_add_f32 v[66:67], v[66:67], v[192:193]
s_waitcnt lgkmcnt(2)
v_pk_add_f32 v[72:73], v[72:73], v[194:195]
v_pk_add_f32 v[74:75], v[74:75], v[196:197]
s_waitcnt lgkmcnt(1)
v_pk_add_f32 v[144:145], v[144:145], v[198:199]
v_pk_add_f32 v[146:147], v[146:147], v[200:201]
s_waitcnt lgkmcnt(0)
v_pk_add_f32 v[152:153], v[152:153], v[202:203]
v_pk_add_f32 v[154:155], v[154:155], v[204:205]
s_load_dword s33, s[56:57], 0
s_load_dword s38, s[56:57], 128
v_cvt_pk_bf16_f32 v206, v64, v65
ds_write_b32 v229, v206 offset:0
v_cvt_pk_bf16_f32 v207, v66, v67
ds_write_b32 v229, v207 offset:256
v_cvt_pk_bf16_f32 v208, v72, v73
ds_write_b32 v229, v208 offset:2048
v_cvt_pk_bf16_f32 v209, v74, v75
ds_write_b32 v229, v209 offset:2304
v_cvt_pk_bf16_f32 v210, v144, v145
ds_write_b32 v229, v210 offset:128
v_cvt_pk_bf16_f32 v211, v146, v147
ds_write_b32 v229, v211 offset:384
v_cvt_pk_bf16_f32 v212, v152, v153
ds_write_b32 v229, v212 offset:2176
v_cvt_pk_bf16_f32 v213, v154, v155
ds_write_b32 v229, v213 offset:2432
s_or_b32 s31, s24, s20
s_cmp_lg_u32 s31, 0
s_cbranch_scc1 nodc_1
v_cmp_gt_u32 vcc, 32, v1
s_nop 1
v_cndmask_b32 v65, v65, 0, vcc
v_cndmask_b32 v145, v145, 0, vcc
nodc_1:
v_mul_f32 v214, v64, v64
v_mul_f32 v215, v144, v144
v_fmac_f32 v214, v65, v65
v_fmac_f32 v215, v145, v145
v_fmac_f32 v214, v66, v66
v_fmac_f32 v215, v146, v146
v_fmac_f32 v214, v67, v67
v_fmac_f32 v215, v147, v147
v_fmac_f32 v214, v72, v72
v_fmac_f32 v215, v152, v152
v_fmac_f32 v214, v73, v73
v_fmac_f32 v215, v153, v153
v_fmac_f32 v214, v74, v74
v_fmac_f32 v215, v154, v154
v_fmac_f32 v214, v75, v75
v_fmac_f32 v215, v155, v155
s_nop 1
v_permlane32_swap_b32 v214, v215
v_add_f32 v214, v214, v215
ds_write_b32 v227, v214 offset:8192
v_lshlrev_b32 v227, 2, v1
s_waitcnt lgkmcnt(0)
s_add_u32 s33, s33, s38
s_cmp_ge_u32 s33, 32
s_cbranch_scc1 gate_2_d
v_and_b32 v2, 1, v1
v_lshlrev_b32 v2, 7, v2
s_mov_b32 s33, 0
gate_2:
global_load_dword v7, v2, s[56:57] sc1
s_add_u32 s33, s33, 1
s_cmp_gt_u32 s33, 32768
s_cbranch_scc1 gate_2_d
s_waitcnt vmcnt(0)
v_cmp_gt_u32 vcc, 16, v7
s_cbranch_vccnz gate_2
gate_2_d:
s_barrier
ds_read_b128 v[64:67], v6
ds_read_b128 v[68:71], v6 offset:1024
s_cmp_lg_u32 s20, 1
s_cbranch_scc1 ssq_3
ds_read2st64_b32 v[206:207], v227 offset0:32 offset1:33
ds_read2st64_b32 v[208:209], v227 offset0:34 offset1:35
s_waitcnt lgkmcnt(0)
v_pk_add_f32 v[206:207], v[206:207], v[208:209]
v_add_f32 v206, v206, v207
buffer_atomic_add_f32 v206, v227, s[4:7], s29 offen sc1
ssq_3:
s_waitcnt lgkmcnt(1)
buffer_store_dwordx4 v[64:67], v5, s[4:7], s28 offen sc1
s_waitcnt lgkmcnt(0)
buffer_store_dwordx4 v[68:71], v5, s[4:7], s30 offen sc1
v_lshrrev_b32 v7, 2, v3
v_lshlrev_b32 v7, 3, v7
v_and_or_b32 v7, v3, 3, v7
v_add_u32 v7, 0, v7
v_cvt_f32_u32 v162, v7
v_mul_f32 v162, 0x3d000000, v162
v_mul_f32 v161, 0x41000000, v163
v_mul_f32 v161, v161, v162
v_cos_f32 v168, v161
v_sin_f32 v176, v161
v_add_f32 v161, v161, v162
v_cos_f32 v169, v161
v_sin_f32 v177, v161
v_add_f32 v161, v161, v162
v_cos_f32 v170, v161
v_sin_f32 v178, v161
v_add_f32 v161, v161, v162
v_cos_f32 v171, v161
v_sin_f32 v179, v161
v_add_f32 v161, v161, v162
v_cos_f32 v172, v161
v_sin_f32 v180, v161
v_add_f32 v161, v161, v162
v_cos_f32 v173, v161
v_sin_f32 v181, v161
v_add_f32 v161, v161, v162
v_cos_f32 v174, v161
v_sin_f32 v182, v161
v_add_f32 v161, v161, v162
v_cos_f32 v175, v161
v_sin_f32 v183, v161
v_cvt_pk_bf16_f32 v104, v168, v169
v_cvt_pk_bf16_f32 v112, v176, v177
v_cvt_pk_bf16_f32 v105, v170, v171
v_cvt_pk_bf16_f32 v113, v178, v179
v_cvt_pk_bf16_f32 v106, v172, v173
v_cvt_pk_bf16_f32 v114, v180, v181
v_cvt_pk_bf16_f32 v107, v174, v175
v_cvt_pk_bf16_f32 v115, v182, v183
v_lshrrev_b32 v7, 2, v3
v_lshlrev_b32 v7, 3, v7
v_and_or_b32 v7, v3, 3, v7
v_add_u32 v7, 4, v7
v_cvt_f32_u32 v162, v7
v_mul_f32 v162, 0x3d000000, v162
v_mul_f32 v161, 0x41000000, v163
v_mul_f32 v161, v161, v162
v_cos_f32 v168, v161
v_sin_f32 v176, v161
v_add_f32 v161, v161, v162
v_cos_f32 v169, v161
v_sin_f32 v177, v161
v_add_f32 v161, v161, v162
v_cos_f32 v170, v161
v_sin_f32 v178, v161
v_add_f32 v161, v161, v162
v_cos_f32 v171, v161
v_sin_f32 v179, v161
v_add_f32 v161, v161, v162
v_cos_f32 v172, v161
v_sin_f32 v180, v161
v_add_f32 v161, v161, v162
v_cos_f32 v173, v161
v_sin_f32 v181, v161
v_add_f32 v161, v161, v162
v_cos_f32 v174, v161
v_sin_f32 v182, v161
v_add_f32 v161, v161, v162
v_cos_f32 v175, v161
v_sin_f32 v183, v161
v_cvt_pk_bf16_f32 v108, v168, v169
v_cvt_pk_bf16_f32 v116, v176, v177
v_cvt_pk_bf16_f32 v109, v170, v171
v_cvt_pk_bf16_f32 v117, v178, v179
v_cvt_pk_bf16_f32 v110, v172, v173
v_cvt_pk_bf16_f32 v118, v180, v181
v_cvt_pk_bf16_f32 v111, v174, v175
v_cvt_pk_bf16_f32 v119, v182, v183
v_xor_b32 v120, 0x80008000, v112
v_xor_b32 v121, 0x80008000, v113
v_xor_b32 v122, 0x80008000, v114
v_xor_b32 v123, 0x80008000, v115
v_xor_b32 v124, 0x80008000, v116
v_xor_b32 v125, 0x80008000, v117
v_xor_b32 v126, 0x80008000, v118
v_xor_b32 v127, 0x80008000, v119
s_waitcnt vmcnt(18)
v_lshlrev_b32 v235, 16, v235
v_lshlrev_b32 v236, 16, v236
v_lshlrev_b32 v237, 16, v237
v_mul_f32 v237, 0x3fb8aa3b, v237
v_exp_f32 v237, v237
s_nop 0
v_cvt_pk_bf16_f32 v237, v237, v237
v_lshlrev_b32 v237, 16, v237
v_mul_f32 v240, v237, v235
v_mul_f32 v240, 0x3fb8aa3b, v240
v_exp_f32 v240, v240
v_mul_f32 v241, v237, v236
v_mul_f32 v241, 0x3e22f983, v241
v_fract_f32 v241, v241
v_cos_f32 v238, v241
v_sin_f32 v239, v241
v_mul_f32 v238, v238, v240
v_mul_f32 v239, v239, v240
v_subrev_f32 v238, 1.0, v238
v_mul_f32 v240, v235, v235
v_fmac_f32 v240, v236, v236
v_rcp_f32 v240, v240
v_mul_f32 v242, v238, v235
v_fmac_f32 v242, v239, v236
v_mul_f32 v243, v239, v235
v_fma_f32 v243, -v238, v236, v243
v_mul_f32 v242, v242, v240
v_mul_f32 v243, v243, v240
v_add_u32 v225, 81920, v225
v_mov_b32 v244, 0
s_and_b32 s29, s2, 15
s_lshl_b32 s29, s29, 7
s_add_u32 s29, s29, 20447232
s_waitcnt vmcnt(0)
s_barrier
s_cmp_lg_u32 s20, 0
s_cbranch_scc1 sig_4
v_mov_b32 v5, 1
v_mul_u32_u24 v6, 2048, v1
s_mov_b32 exec_lo, 65535
s_mov_b32 exec_hi, 0
buffer_atomic_add v5, v6, s[4:7], s29 offen sc1
s_mov_b64 exec, -1
sig_4:
s_cmp_eq_u32 s59, 1
s_cbranch_scc1 KM_m2
s_cmp_eq_u32 s59, 3
s_cbranch_scc1 KM_none
s_mul_i32 s33, s21, 448
v_xor_b32 v226, s33, v225
s_add_u32 s33, s33, 32
ds_read_b128 v[190:193], v226
ds_read_b128 v[194:197], v226 offset:32768
v_xor_b32 v226, s33, v225
s_add_u32 s33, s33, 32
ds_read_b128 v[198:201], v226
ds_read_b128 v[202:205], v226 offset:32768
v_xor_b32 v226, s33, v225
s_add_u32 s33, s33, 32
ds_read_b128 v[206:209], v226
ds_read_b128 v[210:213], v226 offset:32768
v_xor_b32 v226, s33, v225
s_add_u32 s33, s33, 32
ds_read_b128 v[214:217], v226
ds_read_b128 v[218:221], v226 offset:32768
s_waitcnt lgkmcnt(6)
v_mfma_f32_32x32x16_bf16 v[64:79], v[8:11], v[190:193], 0
v_bfe_u32 v244, v1, 4, 1
v_mul_u32_u24 v244, 28672, v244
v_lshrrev_b32 v245, 5, v1
v_mfma_f32_32x32x16_bf16 v[144:159], v[8:11], v[194:197], 0
v_lshl_add_u32 v244, v245, 8, v244
v_lshl_add_u32 v244, v3, 4, v244
s_mul_i32 s30, s23, 28
v_xor_b32 v226, s33, v225
s_add_u32 s33, s33, 32
ds_read_b128 v[190:193], v226
ds_read_b128 v[194:197], v226 offset:32768
s_waitcnt lgkmcnt(6)
v_mfma_f32_32x32x16_bf16 v[64:79], v[12:15], v[198:201], v[64:79]
s_lshl_b32 s29, s24, 1
s_add_u32 s30, s30, s29
s_add_u32 s30, s30, s22
v_mfma_f32_32x32x16_bf16 v[144:159], v[12:15], v[202:205], v[144:159]
s_lshl_b32 s30, s30, 11
s_lshl_b32 s29, s21, 9
s_add_u32 s30, s30, s29
v_xor_b32 v226, s33, v225
s_add_u32 s33, s33, 32
ds_read_b128 v[198:201], v226
ds_read_b128 v[202:205], v226 offset:32768
s_waitcnt lgkmcnt(6)
v_mfma_f32_32x32x16_bf16 v[64:79], v[16:19], v[206:209], v[64:79]
s_add_u32 s36, s30, 15728640
s_lshr_b32 s37, s23, 1
s_lshl_b32 s37, s37, 10
v_mfma_f32_32x32x16_bf16 v[144:159], v[16:19], v[210:213], v[144:159]
s_add_u32 s37, s37, 20594688
v_xor_b32 v226, s33, v225
s_add_u32 s33, s33, 32
ds_read_b128 v[206:209], v226
ds_read_b128 v[210:213], v226 offset:32768
s_waitcnt lgkmcnt(6)
v_mfma_f32_32x32x16_bf16 v[64:79], v[20:23], v[214:217], v[64:79]
v_mfma_f32_32x32x16_bf16 v[144:159], v[20:23], v[218:221], v[144:159]
v_xor_b32 v226, s33, v225
s_add_u32 s33, s33, 32
ds_read_b128 v[214:217], v226
ds_read_b128 v[218:221], v226 offset:32768
s_waitcnt lgkmcnt(6)
v_mfma_f32_32x32x16_bf16 v[64:79], v[24:27], v[190:193], v[64:79]
v_mfma_f32_32x32x16_bf16 v[144:159], v[24:27], v[194:197], v[144:159]
v_xor_b32 v226, s33, v225
s_add_u32 s33, s33, 32
ds_read_b128 v[190:193], v226
ds_read_b128 v[194:197], v226 offset:32768
s_waitcnt lgkmcnt(6)
v_mfma_f32_32x32x16_bf16 v[64:79], v[28:31], v[198:201], v[64:79]
v_mfma_f32_32x32x16_bf16 v[144:159], v[28:31], v[202:205], v[144:159]
v_xor_b32 v226, s33, v225
s_add_u32 s33, s33, 32
ds_read_b128 v[198:201], v226
ds_read_b128 v[202:205], v226 offset:32768
s_waitcnt lgkmcnt(6)
v_mfma_f32_32x32x16_bf16 v[64:79], v[32:35], v[206:209], v[64:79]
v_mfma_f32_32x32x16_bf16 v[144:159], v[32:35], v[210:213], v[144:159]
v_xor_b32 v226, s33, v225
s_add_u32 s33, s33, 32
ds_read_b128 v[206:209], v226
ds_read_b128 v[210:213], v226 offset:32768
s_waitcnt lgkmcnt(6)
v_mfma_f32_32x32x16_bf16 v[64:79], v[36:39], v[214:217], v[64:79]
v_mfma_f32_32x32x16_bf16 v[144:159], v[36:39], v[218:221], v[144:159]
s_cmp_lg_u32 s20, 0
s_cbranch_scc1 pi_5
s_and_b32 s28, s2, 15
s_mul_i32 s29, s28, 2048
s_add_u32 s29, s29, 20447232
v_and_b32 v5, 15, v1
v_lshlrev_b32 v5, 7, v5
v_add_u32 v5, s29, v5
v_mov_b32 v6, 14
s_mov_b32 s50, 65535
s_mov_b32 s51, 0
v_mov_b32 v2, 0
s_mov_b64 exec, s[50:51]
buffer_atomic_or v2, v5, s[4:7], 0 offen sc0 sc1
s_mov_b64 exec, -1
pi_5:
v_xor_b32 v226, s33, v225
s_add_u32 s33, s33, 32
ds_read_b128 v[214:217], v226
ds_read_b128 v[218:221], v226 offset:32768
s_waitcnt lgkmcnt(6)
v_mfma_f32_32x32x16_bf16 v[64:79], v[40:43], v[190:193], v[64:79]
v_mfma_f32_32x32x16_bf16 v[144:159], v[40:43], v[194:197], v[144:159]
v_xor_b32 v226, s33, v225
s_add_u32 s33, s33, 32
ds_read_b128 v[190:193], v226
ds_read_b128 v[194:197], v226 offset:32768
s_waitcnt lgkmcnt(6)
v_mfma_f32_32x32x16_bf16 v[64:79], v[44:47], v[198:201], v[64:79]
v_mfma_f32_32x32x16_bf16 v[144:159], v[44:47], v[202:205], v[144:159]
v_xor_b32 v226, s33, v225
s_add_u32 s33, s33, 32
ds_read_b128 v[198:201], v226
ds_read_b128 v[202:205], v226 offset:32768
s_waitcnt lgkmcnt(6)
v_mfma_f32_32x32x16_bf16 v[64:79], v[48:51], v[206:209], v[64:79]
v_mfma_f32_32x32x16_bf16 v[144:159], v[48:51], v[210:213], v[144:159]
s_waitcnt lgkmcnt(4)
v_mfma_f32_32x32x16_bf16 v[64:79], v[52:55], v[214:217], v[64:79]
v_mfma_f32_32x32x16_bf16 v[144:159], v[52:55], v[218:221], v[144:159]
s_waitcnt lgkmcnt(2)
v_mfma_f32_32x32x16_bf16 v[64:79], v[56:59], v[190:193], v[64:79]
v_mfma_f32_32x32x16_bf16 v[144:159], v[56:59], v[194:197], v[144:159]
s_waitcnt lgkmcnt(0)
v_mfma_f32_32x32x16_bf16 v[64:79], v[60:63], v[198:201], v[64:79]
v_mfma_f32_32x32x16_bf16 v[144:159], v[60:63], v[202:205], v[144:159]
s_branch KM_join
KM_m2:
v_bfe_u32 v244, v1, 2, 2
v_lshrrev_b32 v245, 5, v1
v_lshl_add_u32 v245, v245, 3, v244
v_lshlrev_b32 v245, 7, v245
v_lshrrev_b32 v244, 1, v244
v_lshl_add_u32 v245, v244, 6, v245
v_bfe_u32 v244, v1, 1, 1
v_xor_b32 v244, s21, v244
v_lshl_add_u32 v245, v244, 5, v245
v_bfe_u32 v244, v1, 4, 1
v_lshl_add_u32 v245, v244, 4, v245
v_and_b32 v244, 1, v1
v_lshl_add_u32 v245, v244, 3, v245
s_lshl_b32 s28, s21, 15
s_add_u32 s28, s28, 81920
v_add_u32 v244, s28, v245
v_xor_b32 v245, 64, v244
ds_read_b64_tr_b16 v[190:191], v244 offset:0
ds_read_b64_tr_b16 v[192:193], v244 offset:512
ds_read_b64_tr_b16 v[194:195], v245 offset:0
ds_read_b64_tr_b16 v[196:197], v245 offset:512
ds_read_b64_tr_b16 v[198:199], v244 offset:2048
ds_read_b64_tr_b16 v[200:201], v244 offset:2560
ds_read_b64_tr_b16 v[202:203], v245 offset:2048
ds_read_b64_tr_b16 v[204:205], v245 offset:2560
ds_read_b64_tr_b16 v[206:207], v244 offset:4096
ds_read_b64_tr_b16 v[208:209], v244 offset:4608
ds_read_b64_tr_b16 v[210:211], v245 offset:4096
ds_read_b64_tr_b16 v[212:213], v245 offset:4608
ds_read_b64_tr_b16 v[214:215], v244 offset:6144
ds_read_b64_tr_b16 v[216:217], v244 offset:6656
ds_read_b64_tr_b16 v[218:219], v245 offset:6144
ds_read_b64_tr_b16 v[220:221], v245 offset:6656
s_waitcnt lgkmcnt(12)
v_mfma_f32_32x32x16_bf16 v[64:79], v[190:193], v[8:11], 0
v_xor_b32 v224, 0x80, v224
s_min_u32 s30, s23, 21
s_lshr_b32 s30, s30, 0
v_mfma_f32_32x32x16_bf16 v[144:159], v[194:197], v[8:11], 0
s_sub_u32 s30, s30, 14
s_mul_i32 s30, s30, 37
s_lshr_b32 s30, s30, 8
ds_read_b64_tr_b16 v[190:191], v244 offset:8192
ds_read_b64_tr_b16 v[192:193], v244 offset:8704
ds_read_b64_tr_b16 v[194:195], v245 offset:8192
ds_read_b64_tr_b16 v[196:197], v245 offset:8704
s_waitcnt lgkmcnt(12)
v_mfma_f32_32x32x16_bf16 v[64:79], v[198:201], v[12:15], v[64:79]
s_mul_i32 s29, s30, 7
s_add_u32 s29, s29, 14
s_sub_u32 s29, s23, s29
v_mfma_f32_32x32x16_bf16 v[144:159], v[202:205], v[12:15], v[144:159]
s_lshl_b32 s28, s24, 1
s_add_u32 s28, s28, s30
s_lshl_b32 s28, s28, 1
ds_read_b64_tr_b16 v[198:199], v244 offset:10240
ds_read_b64_tr_b16 v[200:201], v244 offset:10752
ds_read_b64_tr_b16 v[202:203], v245 offset:10240
ds_read_b64_tr_b16 v[204:205], v245 offset:10752
s_waitcnt lgkmcnt(12)
v_mfma_f32_32x32x16_bf16 v[64:79], v[206:209], v[16:19], v[64:79]
s_add_u32 s28, s28, s22
s_mul_i32 s28, s28, 28
s_lshl_b32 s29, s29, 2
v_mfma_f32_32x32x16_bf16 v[144:159], v[210:213], v[16:19], v[144:159]
s_add_u32 s28, s28, s29
s_add_u32 s28, s28, s21
s_lshl_b32 s28, s28, 10
ds_read_b64_tr_b16 v[206:207], v244 offset:12288
ds_read_b64_tr_b16 v[208:209], v244 offset:12800
ds_read_b64_tr_b16 v[210:211], v245 offset:12288
ds_read_b64_tr_b16 v[212:213], v245 offset:12800
s_waitcnt lgkmcnt(12)
v_mfma_f32_32x32x16_bf16 v[64:79], v[214:217], v[20:23], v[64:79]
s_add_u32 s36, s28, 17825792
s_lshl_b32 s37, s24, 10
s_add_u32 s37, s37, 20601856
v_mfma_f32_32x32x16_bf16 v[144:159], v[218:221], v[20:23], v[144:159]
ds_read_b64_tr_b16 v[214:215], v244 offset:16384
ds_read_b64_tr_b16 v[216:217], v244 offset:16896
ds_read_b64_tr_b16 v[218:219], v245 offset:16384
ds_read_b64_tr_b16 v[220:221], v245 offset:16896
s_waitcnt lgkmcnt(12)
v_mfma_f32_32x32x16_bf16 v[64:79], v[190:193], v[24:27], v[64:79]
v_mfma_f32_32x32x16_bf16 v[144:159], v[194:197], v[24:27], v[144:159]
ds_read_b64_tr_b16 v[190:191], v244 offset:18432
ds_read_b64_tr_b16 v[192:193], v244 offset:18944
ds_read_b64_tr_b16 v[194:195], v245 offset:18432
ds_read_b64_tr_b16 v[196:197], v245 offset:18944
s_waitcnt lgkmcnt(12)
v_mfma_f32_32x32x16_bf16 v[64:79], v[198:201], v[28:31], v[64:79]
v_mfma_f32_32x32x16_bf16 v[144:159], v[202:205], v[28:31], v[144:159]
ds_read_b64_tr_b16 v[198:199], v244 offset:20480
ds_read_b64_tr_b16 v[200:201], v244 offset:20992
ds_read_b64_tr_b16 v[202:203], v245 offset:20480
ds_read_b64_tr_b16 v[204:205], v245 offset:20992
s_waitcnt lgkmcnt(12)
v_mfma_f32_32x32x16_bf16 v[64:79], v[206:209], v[32:35], v[64:79]
v_mfma_f32_32x32x16_bf16 v[144:159], v[210:213], v[32:35], v[144:159]
ds_read_b64_tr_b16 v[206:207], v244 offset:22528
ds_read_b64_tr_b16 v[208:209], v244 offset:23040
ds_read_b64_tr_b16 v[210:211], v245 offset:22528
ds_read_b64_tr_b16 v[212:213], v245 offset:23040
s_waitcnt lgkmcnt(12)
v_mfma_f32_32x32x16_bf16 v[64:79], v[214:217], v[36:39], v[64:79]
v_mfma_f32_32x32x16_bf16 v[144:159], v[218:221], v[36:39], v[144:159]
s_cmp_lg_u32 s20, 0
s_cbranch_scc1 pi_6
s_and_b32 s28, s2, 15
s_mul_i32 s29, s28, 2048
s_add_u32 s29, s29, 20447232
v_and_b32 v5, 15, v1
v_lshlrev_b32 v5, 7, v5
v_add_u32 v5, s29, v5
v_mov_b32 v6, 14
s_mov_b32 s50, 65535
s_mov_b32 s51, 0
v_mov_b32 v2, 0
s_mov_b64 exec, s[50:51]
buffer_atomic_or v2, v5, s[4:7], 0 offen sc0 sc1
s_mov_b64 exec, -1
pi_6:
ds_read_b64_tr_b16 v[214:215], v244 offset:24576
ds_read_b64_tr_b16 v[216:217], v244 offset:25088
ds_read_b64_tr_b16 v[218:219], v245 offset:24576
ds_read_b64_tr_b16 v[220:221], v245 offset:25088
s_waitcnt lgkmcnt(12)
v_mfma_f32_32x32x16_bf16 v[64:79], v[190:193], v[40:43], v[64:79]
v_mfma_f32_32x32x16_bf16 v[144:159], v[194:197], v[40:43], v[144:159]
ds_read_b64_tr_b16 v[190:191], v244 offset:26624
ds_read_b64_tr_b16 v[192:193], v244 offset:27136
ds_read_b64_tr_b16 v[194:195], v245 offset:26624
ds_read_b64_tr_b16 v[196:197], v245 offset:27136
s_waitcnt lgkmcnt(12)
v_mfma_f32_32x32x16_bf16 v[64:79], v[198:201], v[44:47], v[64:79]
v_mfma_f32_32x32x16_bf16 v[144:159], v[202:205], v[44:47], v[144:159]
ds_read_b64_tr_b16 v[198:199], v244 offset:28672
ds_read_b64_tr_b16 v[200:201], v244 offset:29184
ds_read_b64_tr_b16 v[202:203], v245 offset:28672
ds_read_b64_tr_b16 v[204:205], v245 offset:29184
s_waitcnt lgkmcnt(12)
v_mfma_f32_32x32x16_bf16 v[64:79], v[206:209], v[48:51], v[64:79]
v_mfma_f32_32x32x16_bf16 v[144:159], v[210:213], v[48:51], v[144:159]
s_waitcnt lgkmcnt(8)
v_mfma_f32_32x32x16_bf16 v[64:79], v[214:217], v[52:55], v[64:79]
v_mfma_f32_32x32x16_bf16 v[144:159], v[218:221], v[52:55], v[144:159]
s_waitcnt lgkmcnt(4)
v_mfma_f32_32x32x16_bf16 v[64:79], v[190:193], v[56:59], v[64:79]
v_mfma_f32_32x32x16_bf16 v[144:159], v[194:197], v[56:59], v[144:159]
s_waitcnt lgkmcnt(0)
v_mfma_f32_32x32x16_bf16 v[64:79], v[198:201], v[60:63], v[64:79]
v_mfma_f32_32x32x16_bf16 v[144:159], v[202:205], v[60:63], v[144:159]
s_branch KM_join
KM_none:
s_cmp_lg_u32 s20, 0
s_cbranch_scc1 pi_7
s_and_b32 s28, s2, 15
s_mul_i32 s29, s28, 2048
s_add_u32 s29, s29, 20447232
v_and_b32 v5, 15, v1
v_lshlrev_b32 v5, 7, v5
v_add_u32 v5, s29, v5
v_mov_b32 v6, 14
s_mov_b32 s50, 65535
s_mov_b32 s51, 0
v_mov_b32 v2, 0
s_mov_b64 exec, s[50:51]
buffer_atomic_or v2, v5, s[4:7], 0 offen sc0 sc1
s_mov_b64 exec, -1
pi_7:
s_mov_b32 s37, 20610048
KM_join:
s_cmp_lg_u32 s20, 0
s_cbranch_scc1 poll_8_d
s_mov_b32 s28, 0
s_mov_b64 exec, s[50:51]
s_waitcnt vmcnt(0)
poll_8:
v_cmp_gt_u32 vcc, v6, v2
s_add_u32 s28, s28, 1
s_and_b64 exec, vcc, vcc
s_cbranch_scc0 poll_8_d
s_cmp_gt_u32 s28, 32768
s_cbranch_scc1 poll_8_d
v_mov_b32 v2, 0
buffer_atomic_or v2, v5, s[4:7], 0 offen sc0 sc1
s_waitcnt vmcnt(0)
s_branch poll_8
poll_8_d:
s_mov_b64 exec, -1
s_barrier
v_lshlrev_b32 v5, 7, v3
v_lshl_add_u32 v5, v4, 4, v5
s_lshl_b32 s28, s20, 11
v_add_u32 v5, s28, v5
s_lshl_b32 s29, s2, 13
s_add_u32 s29, s29, 0
s_mov_b32 s30, 20611072
s_mov_b32 s31, 0x40e00000
s_mov_b32 s32, 0x46124925
v_mov_b32 v162, 0x4227c5ac
s_mov_b32 s28, 0
buffer_load_dwordx4 v[16:19], v5, s[4:7], s30 offen sc1
buffer_load_dwordx4 v[20:23], v5, s[4:7], s30 offen offset:64 sc1
buffer_load_dwordx4 v[8:11], v5, s[4:7], s29 offen sc1
buffer_load_dwordx4 v[12:15], v5, s[4:7], s29 offen offset:64 sc1
s_and_b32 s28, s2, 15
s_lshl_b32 s28, s28, 2
s_add_u32 s28, s28, s20
s_lshl_b32 s28, s28, 7
s_add_u32 s28, s28, 20635648
v_mov_b32 v250, s28
v_mov_b32 v251, 32
v_mov_b32 v252, 0
s_mov_b64 exec, 1
buffer_atomic_or v252, v250, s[4:7], 0 offen sc0 sc1
s_mov_b64 exec, -1
s_cmp_eq_u32 s59, 3
s_cbranch_scc1 KM_en
ds_write_b128 v223, v[68:71] offset:0
ds_write_b128 v223, v[76:79] offset:1024
ds_write_b128 v223, v[148:151] offset:2048
ds_write_b128 v223, v[156:159] offset:3072
s_waitcnt lgkmcnt(0)
s_barrier
ds_read_b128 v[190:193], v224 offset:0
ds_read_b128 v[194:197], v224 offset:1024
ds_read_b128 v[198:201], v224 offset:2048
ds_read_b128 v[202:205], v224 offset:3072
s_waitcnt lgkmcnt(3)
v_pk_add_f32 v[64:65], v[64:65], v[190:191]
v_pk_add_f32 v[66:67], v[66:67], v[192:193]
s_waitcnt lgkmcnt(2)
v_pk_add_f32 v[72:73], v[72:73], v[194:195]
v_pk_add_f32 v[74:75], v[74:75], v[196:197]
s_waitcnt lgkmcnt(1)
v_pk_add_f32 v[144:145], v[144:145], v[198:199]
v_pk_add_f32 v[146:147], v[146:147], v[200:201]
s_waitcnt lgkmcnt(0)
v_pk_add_f32 v[152:153], v[152:153], v[202:203]
v_pk_add_f32 v[154:155], v[154:155], v[204:205]
s_cmp_eq_u32 s59, 1
s_cbranch_scc1 KM_e2
s_cmp_eq_u32 s59, 2
s_cbranch_scc1 KM_d
s_or_b32 s29, s24, s20
s_cmp_lg_u32 s29, 0
s_cbranch_scc1 KM_nodc
v_cmp_gt_u32 vcc, 32, v1
s_nop 1
v_cndmask_b32 v65, v65, 0, vcc
v_cndmask_b32 v145, v145, 0, vcc
KM_nodc:
v_pk_mul_f32 v[206:207], v[64:65], v[242:243] op_sel_hi:[1,0]
v_pk_mul_f32 v[214:215], v[144:145], v[242:243] op_sel_hi:[1,0]
v_pk_mul_f32 v[208:209], v[66:67], v[242:243] op_sel_hi:[1,0]
v_pk_mul_f32 v[216:217], v[146:147], v[242:243] op_sel_hi:[1,0]
v_pk_mul_f32 v[210:211], v[72:73], v[242:243] op_sel_hi:[1,0]
v_pk_mul_f32 v[218:219], v[152:153], v[242:243] op_sel_hi:[1,0]
v_pk_mul_f32 v[212:213], v[74:75], v[242:243] op_sel_hi:[1,0]
v_pk_mul_f32 v[220:221], v[154:155], v[242:243] op_sel_hi:[1,0]
v_pk_fma_f32 v[206:207], v[144:145], v[242:243], v[206:207] op_sel:[0,1,0] op_sel_hi:[1,1,1] neg_lo:[1,0,0] neg_hi:[1,0,0]
v_pk_fma_f32 v[214:215], v[64:65], v[242:243], v[214:215] op_sel:[0,1,0] op_sel_hi:[1,1,1]
v_pk_fma_f32 v[208:209], v[146:147], v[242:243], v[208:209] op_sel:[0,1,0] op_sel_hi:[1,1,1] neg_lo:[1,0,0] neg_hi:[1,0,0]
v_pk_fma_f32 v[216:217], v[66:67], v[242:243], v[216:217] op_sel:[0,1,0] op_sel_hi:[1,1,1]
v_pk_fma_f32 v[210:211], v[152:153], v[242:243], v[210:211] op_sel:[0,1,0] op_sel_hi:[1,1,1] neg_lo:[1,0,0] neg_hi:[1,0,0]
v_pk_fma_f32 v[218:219], v[72:73], v[242:243], v[218:219] op_sel:[0,1,0] op_sel_hi:[1,1,1]
v_pk_fma_f32 v[212:213], v[154:155], v[242:243], v[212:213] op_sel:[0,1,0] op_sel_hi:[1,1,1] neg_lo:[1,0,0] neg_hi:[1,0,0]
v_pk_fma_f32 v[220:221], v[74:75], v[242:243], v[220:221] op_sel:[0,1,0] op_sel_hi:[1,1,1]
v_cvt_pk_bf16_f32 v190, v206, v207
v_cvt_pk_bf16_f32 v191, v208, v209
v_cvt_pk_bf16_f32 v192, v210, v211
v_cvt_pk_bf16_f32 v193, v212, v213
v_cvt_pk_bf16_f32 v194, v214, v215
v_cvt_pk_bf16_f32 v195, v216, v217
v_cvt_pk_bf16_f32 v196, v218, v219
v_cvt_pk_bf16_f32 v197, v220, v221
buffer_store_dwordx4 v[190:193], v244, s[4:7], s36 offen sc1
buffer_store_dwordx4 v[194:197], v244, s[4:7], s36 offen offset:1024 sc1
s_branch KM_en
KM_d:
v_lshrrev_b32 v244, 1, v1
s_lshl_b32 s28, s24, 8
s_lshl_b32 s29, s22, 7
s_add_u32 s28, s28, s29
s_lshl_b32 s29, s21, 5
s_add_u32 s28, s28, s29
s_add_u32 s28, s28, 2129920
s_mov_b32 s37, 20609024
s_mov_b32 exec_lo, 1
s_mov_b32 exec_hi, 1
buffer_store_dwordx4 v[64:67], v244, s[4:7], s28 offen sc1
buffer_store_dwordx4 v[72:75], v244, s[4:7], s28 offen offset:64 sc1
s_mov_b64 exec, -1
s_branch KM_en
KM_e2:
v_cvt_pk_bf16_f32 v206, v64, v65
v_cvt_pk_bf16_f32 v207, v66, v67
v_cvt_pk_bf16_f32 v208, v72, v73
v_cvt_pk_bf16_f32 v209, v74, v75
v_cvt_pk_bf16_f32 v210, v144, v145
v_cvt_pk_bf16_f32 v211, v146, v147
v_cvt_pk_bf16_f32 v212, v152, v153
v_cvt_pk_bf16_f32 v213, v154, v155
buffer_store_dwordx4 v[206:209], v230, s[4:7], s36 offen sc1
buffer_store_dwordx4 v[210:213], v230, s[4:7], s36 offen offset:2048 sc1
KM_en:
s_add_u32 s8, s4, 19922944
s_addc_u32 s9, s5, 0
s_mov_b32 s10, 114688
s_mov_b32 s11, 0x20000
s_add_u32 s12, s4, 20037632
s_addc_u32 s13, s5, 0
s_mov_b32 s14, 114688
s_mov_b32 s15, 0x20000
s_mov_b32 s36, 0
s_lshl_b32 s30, s24, 12
s_add_u32 s58, s58, s30
s_mov_b32 s39, s58
s_lshl_b32 s30, s24, 10
s_and_b32 s31, s2, 7
s_lshl_b32 s31, s31, 7
s_add_u32 s30, s30, s31
s_add_u32 s30, s30, 20594688
v_mul_u32_u24 v246, 7168, v1
v_add_u32 v246, s30, v246
v_mov_b32 v247, 56
v_mul_f32 v162, 0x3a000000, v160
v_mul_f32 v161, 0x41000000, v163
v_mul_f32 v161, v161, v162
v_cos_f32 v128, v161
v_sin_f32 v136, v161
v_add_f32 v161, v161, v162
v_cos_f32 v129, v161
v_sin_f32 v137, v161
v_add_f32 v161, v161, v162
v_cos_f32 v130, v161
v_sin_f32 v138, v161
v_add_f32 v161, v161, v162
v_cos_f32 v131, v161
v_sin_f32 v139, v161
v_add_f32 v161, v161, v162
v_cos_f32 v132, v161
v_sin_f32 v140, v161
v_add_f32 v161, v161, v162
v_cos_f32 v133, v161
v_sin_f32 v141, v161
v_add_f32 v161, v161, v162
v_cos_f32 v134, v161
v_sin_f32 v142, v161
v_add_f32 v161, v161, v162
v_cos_f32 v135, v161
v_sin_f32 v143, v161
v_bfe_u32 v162, v3, 1, 2
s_lshl_b32 s28, s20, 10
s_add_u32 s28, s28, 131072
v_lshlrev_b32 v165, 6, v3
v_add_u32 v165, s28, v165
v_xor_b32 v186, v4, v162
v_lshl_add_u32 v186, v186, 4, v165
v_and_b32 v184, 1, v4
v_lshlrev_b32 v184, 1, v184
v_xor_b32 v184, v184, v162
v_lshl_add_u32 v184, v184, 4, v165
v_lshrrev_b32 v162, 1, v4
v_lshl_add_u32 v184, v162, 3, v184
v_xor_b32 v185, 16, v184
v_lshrrev_b32 v162, 2, v1
v_lshlrev_b32 v187, 6, v162
v_bfe_u32 v162, v1, 3, 2
v_bfe_u32 v165, v1, 1, 1
v_xor_b32 v162, v162, v165
v_lshl_add_u32 v187, v162, 4, v187
v_and_b32 v162, 1, v1
v_lshl_add_u32 v187, v162, 3, v187
v_add_u32 v187, 131072, v187
v_xor_b32 v188, 32, v187
v_lshrrev_b32 v162, 1, v3
v_mul_u32_u24 v162, 57344, v162
v_and_b32 v165, 1, v3
v_lshl_add_u32 v165, v4, 1, v165
s_and_b32 s28, s2, 3
s_lshl_b32 s28, s28, 1
v_xor_b32 v165, s28, v165
v_lshl_add_u32 v189, v165, 4, v162
v_mov_b32 v162, 0x4227c5ac
s_waitcnt vmcnt(3)
v_fma_f32 v16, v16, s32, v162
v_fma_f32 v17, v17, s32, v162
v_fma_f32 v18, v18, s32, v162
v_fma_f32 v19, v19, s32, v162
v_fma_f32 v20, v20, s32, v162
v_fma_f32 v21, v21, s32, v162
v_fma_f32 v22, v22, s32, v162
v_fma_f32 v23, v23, s32, v162
v_rsq_f32 v16, v16
v_rsq_f32 v17, v17
v_rsq_f32 v18, v18
v_rsq_f32 v19, v19
v_rsq_f32 v20, v20
v_rsq_f32 v21, v21
v_rsq_f32 v22, v22
v_rsq_f32 v23, v23
s_waitcnt vmcnt(2)
s_cmp_lg_u32 s59, 3
s_cbranch_scc1 cw_9
s_waitcnt vmcnt(0)
cw_9:
s_mov_b32 s33, 0
s_mov_b64 exec, 1
chk_10:
v_cmp_gt_u32 vcc, v251, v252
s_add_u32 s33, s33, 1
s_cbranch_vccz chk_10_d
s_cmp_gt_u32 s33, 32768
s_cbranch_scc1 chk_10_d
v_mov_b32 v252, 0
buffer_atomic_or v252, v250, s[4:7], 0 offen sc0 sc1
s_waitcnt vmcnt(0)
s_branch chk_10
chk_10_d:
s_mov_b64 exec, -1
s_lshl_b32 s33, s2, 2
s_add_u32 s33, s33, s20
s_lshl_b32 s33, s33, 11
s_add_u32 s33, s33, 13631488
buffer_load_dwordx4 v[72:75], v231, s[4:7], s33 offen
buffer_load_dwordx4 v[76:79], v231, s[4:7], s33 offen offset:1024
v_lshlrev_b32 v144, 16, v8
v_and_b32 v152, 0xffff0000, v8
v_lshlrev_b32 v145, 16, v9
v_and_b32 v153, 0xffff0000, v9
v_lshlrev_b32 v146, 16, v10
v_and_b32 v154, 0xffff0000, v10
v_lshlrev_b32 v147, 16, v11
v_and_b32 v155, 0xffff0000, v11
v_lshlrev_b32 v148, 16, v12
v_and_b32 v156, 0xffff0000, v12
v_lshlrev_b32 v149, 16, v13
v_and_b32 v157, 0xffff0000, v13
v_lshlrev_b32 v150, 16, v14
v_and_b32 v158, 0xffff0000, v14
v_lshlrev_b32 v151, 16, v15
v_and_b32 v159, 0xffff0000, v15
v_pk_mul_f32 v[24:25], v[16:17], v[144:145]
v_pk_mul_f32 v[32:33], v[16:17], v[152:153]
v_pk_mul_f32 v[26:27], v[18:19], v[146:147]
v_pk_mul_f32 v[34:35], v[18:19], v[154:155]
v_pk_mul_f32 v[28:29], v[20:21], v[148:149]
v_pk_mul_f32 v[36:37], v[20:21], v[156:157]
v_pk_mul_f32 v[30:31], v[22:23], v[150:151]
v_pk_mul_f32 v[38:39], v[22:23], v[158:159]
v_cvt_pk_bf16_f32 v64, v24, v25
v_cvt_pk_bf16_f32 v68, v32, v33
v_cvt_pk_bf16_f32 v65, v26, v27
v_cvt_pk_bf16_f32 v69, v34, v35
v_cvt_pk_bf16_f32 v66, v28, v29
v_cvt_pk_bf16_f32 v70, v36, v37
v_cvt_pk_bf16_f32 v67, v30, v31
v_cvt_pk_bf16_f32 v71, v38, v39
s_cmp_lg_u32 s2, 0
s_cbranch_scc1 nz_11
v_mov_b32 v68, 0
v_mov_b32 v69, 0
v_mov_b32 v70, 0
v_mov_b32 v71, 0
nz_11:
ds_write_b64 v184, v[64:65]
ds_write_b64 v185, v[66:67]
ds_write_b64 v184, v[68:69] offset:4096
ds_write_b64 v185, v[70:71] offset:4096
s_waitcnt lgkmcnt(0)
s_barrier
s_waitcnt vmcnt(2)
v_mov_b32 v5, 1
v_lshlrev_b32 v6, 7, v1
s_mov_b64 exec, 0xff
buffer_atomic_add v5, v6, s[4:7], s37 offen sc1
s_mov_b64 exec, -1
ds_read_b64_tr_b16 v[16:17], v187 offset:0
ds_read_b64_tr_b16 v[18:19], v187 offset:1024
ds_read_b64_tr_b16 v[20:21], v188 offset:0
ds_read_b64_tr_b16 v[22:23], v188 offset:1024
ds_read_b64_tr_b16 v[24:25], v187 offset:4096
ds_read_b64_tr_b16 v[26:27], v187 offset:5120
ds_read_b64_tr_b16 v[28:29], v188 offset:4096
ds_read_b64_tr_b16 v[30:31], v188 offset:5120
ds_read_b64_tr_b16 v[32:33], v187 offset:2048
ds_read_b64_tr_b16 v[34:35], v187 offset:3072
ds_read_b64_tr_b16 v[36:37], v188 offset:2048
ds_read_b64_tr_b16 v[38:39], v188 offset:3072
ds_read_b64_tr_b16 v[40:41], v187 offset:6144
ds_read_b64_tr_b16 v[42:43], v187 offset:7168
ds_read_b64_tr_b16 v[44:45], v188 offset:6144
ds_read_b64_tr_b16 v[46:47], v188 offset:7168
s_waitcnt lgkmcnt(12)
v_mfma_f32_16x16x32_bf16 v[48:51], v[16:19], v[80:83], 0
v_mfma_f32_16x16x32_bf16 v[56:59], v[16:19], v[96:99], 0
v_mfma_f32_16x16x32_bf16 v[52:55], v[20:23], v[80:83], 0
v_mfma_f32_16x16x32_bf16 v[60:63], v[20:23], v[96:99], 0
s_waitcnt lgkmcnt(8)
v_mfma_f32_16x16x32_bf16 v[48:51], v[24:27], v[88:91], v[48:51]
v_mfma_f32_16x16x32_bf16 v[56:59], v[24:27], v[80:83], v[56:59]
v_mfma_f32_16x16x32_bf16 v[52:55], v[28:31], v[88:91], v[52:55]
v_mfma_f32_16x16x32_bf16 v[60:63], v[28:31], v[80:83], v[60:63]
s_waitcnt lgkmcnt(4)
v_mfma_f32_16x16x32_bf16 v[48:51], v[32:35], v[84:87], v[48:51]
v_mfma_f32_16x16x32_bf16 v[56:59], v[32:35], v[100:103], v[56:59]
v_mfma_f32_16x16x32_bf16 v[52:55], v[36:39], v[84:87], v[52:55]
v_mfma_f32_16x16x32_bf16 v[60:63], v[36:39], v[100:103], v[60:63]
s_waitcnt lgkmcnt(0)
v_mfma_f32_16x16x32_bf16 v[48:51], v[40:43], v[92:95], v[48:51]
v_mfma_f32_16x16x32_bf16 v[56:59], v[40:43], v[84:87], v[56:59]
v_mfma_f32_16x16x32_bf16 v[52:55], v[44:47], v[92:95], v[52:55]
v_mfma_f32_16x16x32_bf16 v[60:63], v[44:47], v[84:87], v[60:63]
s_nop 4
v_pk_mul_f32 v[168:169], v[48:49], v[128:129]
v_pk_mul_f32 v[176:177], v[56:57], v[128:129]
v_pk_mul_f32 v[170:171], v[50:51], v[130:131]
v_pk_mul_f32 v[178:179], v[58:59], v[130:131]
v_pk_mul_f32 v[172:173], v[52:53], v[132:133]
v_pk_mul_f32 v[180:181], v[60:61], v[132:133]
v_pk_mul_f32 v[174:175], v[54:55], v[134:135]
v_pk_mul_f32 v[182:183], v[62:63], v[134:135]
v_pk_fma_f32 v[168:169], v[56:57], v[136:137], v[168:169] neg_lo:[0,0,0] neg_hi:[0,0,0]
v_pk_fma_f32 v[176:177], v[48:49], v[136:137], v[176:177] neg_lo:[1,0,0] neg_hi:[1,0,0]
v_pk_fma_f32 v[170:171], v[58:59], v[138:139], v[170:171] neg_lo:[0,0,0] neg_hi:[0,0,0]
v_pk_fma_f32 v[178:179], v[50:51], v[138:139], v[178:179] neg_lo:[1,0,0] neg_hi:[1,0,0]
v_pk_fma_f32 v[172:173], v[60:61], v[140:141], v[172:173] neg_lo:[0,0,0] neg_hi:[0,0,0]
v_pk_fma_f32 v[180:181], v[52:53], v[140:141], v[180:181] neg_lo:[1,0,0] neg_hi:[1,0,0]
v_pk_fma_f32 v[174:175], v[62:63], v[142:143], v[174:175] neg_lo:[0,0,0] neg_hi:[0,0,0]
v_pk_fma_f32 v[182:183], v[54:55], v[142:143], v[182:183] neg_lo:[1,0,0] neg_hi:[1,0,0]
v_cvt_pk_bf16_f32 v64, v168, v169
v_cvt_pk_bf16_f32 v68, v176, v177
v_cvt_pk_bf16_f32 v65, v170, v171
v_cvt_pk_bf16_f32 v69, v178, v179
v_cvt_pk_bf16_f32 v66, v172, v173
v_cvt_pk_bf16_f32 v70, v180, v181
v_cvt_pk_bf16_f32 v67, v174, v175
v_cvt_pk_bf16_f32 v71, v182, v183
s_nop 0
v_mfma_f32_16x16x32_bf16 v[48:51], v[104:107], v[64:67], 0
v_mfma_f32_16x16x32_bf16 v[56:59], v[104:107], v[68:71], 0
v_mfma_f32_16x16x32_bf16 v[52:55], v[108:111], v[64:67], 0
v_mfma_f32_16x16x32_bf16 v[60:63], v[108:111], v[68:71], 0
v_mfma_f32_16x16x32_bf16 v[48:51], v[112:115], v[68:71], v[48:51]
v_mfma_f32_16x16x32_bf16 v[56:59], v[120:123], v[64:67], v[56:59]
v_mfma_f32_16x16x32_bf16 v[52:55], v[116:119], v[68:71], v[52:55]
v_mfma_f32_16x16x32_bf16 v[60:63], v[124:127], v[64:67], v[60:63]
s_waitcnt vmcnt(1)
v_lshlrev_b32 v16, 16, v72
v_and_b32 v17, 0xffff0000, v72
v_lshlrev_b32 v24, 16, v76
v_and_b32 v25, 0xffff0000, v76
v_lshlrev_b32 v18, 16, v73
v_and_b32 v19, 0xffff0000, v73
v_lshlrev_b32 v26, 16, v77
v_and_b32 v27, 0xffff0000, v77
v_lshlrev_b32 v20, 16, v74
v_and_b32 v21, 0xffff0000, v74
v_lshlrev_b32 v28, 16, v78
v_and_b32 v29, 0xffff0000, v78
v_lshlrev_b32 v22, 16, v75
v_and_b32 v23, 0xffff0000, v75
v_lshlrev_b32 v30, 16, v79
v_and_b32 v31, 0xffff0000, v79
v_pk_mul_f32 v[168:169], v[48:49], v[16:17]
v_pk_mul_f32 v[176:177], v[56:57], v[16:17]
v_pk_mul_f32 v[170:171], v[50:51], v[18:19]
v_pk_mul_f32 v[178:179], v[58:59], v[18:19]
v_pk_mul_f32 v[172:173], v[52:53], v[20:21]
v_pk_mul_f32 v[180:181], v[60:61], v[20:21]
v_pk_mul_f32 v[174:175], v[54:55], v[22:23]
v_pk_mul_f32 v[182:183], v[62:63], v[22:23]
v_pk_fma_f32 v[168:169], v[56:57], v[24:25], v[168:169] neg_lo:[1,0,0] neg_hi:[1,0,0]
v_pk_fma_f32 v[176:177], v[48:49], v[24:25], v[176:177] neg_lo:[0,0,0] neg_hi:[0,0,0]
v_pk_fma_f32 v[170:171], v[58:59], v[26:27], v[170:171] neg_lo:[1,0,0] neg_hi:[1,0,0]
v_pk_fma_f32 v[178:179], v[50:51], v[26:27], v[178:179] neg_lo:[0,0,0] neg_hi:[0,0,0]
v_pk_fma_f32 v[172:173], v[60:61], v[28:29], v[172:173] neg_lo:[1,0,0] neg_hi:[1,0,0]
v_pk_fma_f32 v[180:181], v[52:53], v[28:29], v[180:181] neg_lo:[0,0,0] neg_hi:[0,0,0]
v_pk_fma_f32 v[174:175], v[62:63], v[30:31], v[174:175] neg_lo:[1,0,0] neg_hi:[1,0,0]
v_pk_fma_f32 v[182:183], v[54:55], v[30:31], v[182:183] neg_lo:[0,0,0] neg_hi:[0,0,0]
v_cvt_pk_bf16_f32 v64, v168, v169
v_cvt_pk_bf16_f32 v68, v176, v177
v_cvt_pk_bf16_f32 v65, v170, v171
v_cvt_pk_bf16_f32 v69, v178, v179
v_cvt_pk_bf16_f32 v66, v172, v173
v_cvt_pk_bf16_f32 v70, v180, v181
v_cvt_pk_bf16_f32 v67, v174, v175
v_cvt_pk_bf16_f32 v71, v182, v183
s_nop 0
v_mfma_f32_16x16x32_bf16 v[48:51], v[104:107], v[64:67], 0
v_mfma_f32_16x16x32_bf16 v[56:59], v[104:107], v[68:71], 0
v_mfma_f32_16x16x32_bf16 v[52:55], v[108:111], v[64:67], 0
v_mfma_f32_16x16x32_bf16 v[60:63], v[108:111], v[68:71], 0
v_mfma_f32_16x16x32_bf16 v[48:51], v[120:123], v[68:71], v[48:51]
v_mfma_f32_16x16x32_bf16 v[56:59], v[112:115], v[64:67], v[56:59]
v_mfma_f32_16x16x32_bf16 v[52:55], v[124:127], v[68:71], v[52:55]
v_mfma_f32_16x16x32_bf16 v[60:63], v[116:119], v[64:67], v[60:63]
s_nop 4
v_pk_mul_f32 v[168:169], v[48:49], v[128:129]
v_pk_mul_f32 v[176:177], v[56:57], v[128:129]
v_pk_mul_f32 v[170:171], v[50:51], v[130:131]
v_pk_mul_f32 v[178:179], v[58:59], v[130:131]
v_pk_mul_f32 v[172:173], v[52:53], v[132:133]
v_pk_mul_f32 v[180:181], v[60:61], v[132:133]
v_pk_mul_f32 v[174:175], v[54:55], v[134:135]
v_pk_mul_f32 v[182:183], v[62:63], v[134:135]
v_pk_fma_f32 v[168:169], v[56:57], v[136:137], v[168:169] neg_lo:[1,0,0] neg_hi:[1,0,0]
v_pk_fma_f32 v[176:177], v[48:49], v[136:137], v[176:177] neg_lo:[0,0,0] neg_hi:[0,0,0]
v_pk_fma_f32 v[170:171], v[58:59], v[138:139], v[170:171] neg_lo:[1,0,0] neg_hi:[1,0,0]
v_pk_fma_f32 v[178:179], v[50:51], v[138:139], v[178:179] neg_lo:[0,0,0] neg_hi:[0,0,0]
v_pk_fma_f32 v[172:173], v[60:61], v[140:141], v[172:173] neg_lo:[1,0,0] neg_hi:[1,0,0]
v_pk_fma_f32 v[180:181], v[52:53], v[140:141], v[180:181] neg_lo:[0,0,0] neg_hi:[0,0,0]
v_pk_fma_f32 v[174:175], v[62:63], v[142:143], v[174:175] neg_lo:[1,0,0] neg_hi:[1,0,0]
v_pk_fma_f32 v[182:183], v[54:55], v[142:143], v[182:183] neg_lo:[0,0,0] neg_hi:[0,0,0]
v_cvt_pk_bf16_f32 v64, v168, v169
v_cvt_pk_bf16_f32 v68, v176, v177
v_cvt_pk_bf16_f32 v65, v170, v171
v_cvt_pk_bf16_f32 v69, v178, v179
v_cvt_pk_bf16_f32 v66, v172, v173
v_cvt_pk_bf16_f32 v70, v180, v181
v_cvt_pk_bf16_f32 v67, v174, v175
v_cvt_pk_bf16_f32 v71, v182, v183
v_mov_b32 v248, 0
s_mov_b64 exec, 3
buffer_atomic_or v248, v246, s[4:7], 0 offen sc0 sc1
s_mov_b64 exec, -1
ds_write_b128 v186, v[64:67] offset:8192
ds_write_b128 v186, v[68:71] offset:12288
s_mul_i32 s28, s20, 458752
s_lshl_b32 s29, s2, 8
s_add_u32 s28, s28, s29
s_add_u32 s28, s28, 3145728
s_waitcnt lgkmcnt(0)
s_barrier
ds_read_b64_tr_b16 v[16:17], v187 offset:8192
ds_read_b64_tr_b16 v[18:19], v187 offset:9216
ds_read_b64_tr_b16 v[20:21], v188 offset:8192
ds_read_b64_tr_b16 v[22:23], v188 offset:9216
ds_read_b64_tr_b16 v[24:25], v187 offset:12288
ds_read_b64_tr_b16 v[26:27], v187 offset:13312
ds_read_b64_tr_b16 v[28:29], v188 offset:12288
ds_read_b64_tr_b16 v[30:31], v188 offset:13312
ds_read_b64_tr_b16 v[32:33], v187 offset:10240
ds_read_b64_tr_b16 v[34:35], v187 offset:11264
ds_read_b64_tr_b16 v[36:37], v188 offset:10240
ds_read_b64_tr_b16 v[38:39], v188 offset:11264
ds_read_b64_tr_b16 v[40:41], v187 offset:14336
ds_read_b64_tr_b16 v[42:43], v187 offset:15360
ds_read_b64_tr_b16 v[44:45], v188 offset:14336
ds_read_b64_tr_b16 v[46:47], v188 offset:15360
s_waitcnt lgkmcnt(12)
v_mfma_f32_16x16x32_bf16 v[48:51], v[16:19], v[80:83], 0
v_mfma_f32_16x16x32_bf16 v[56:59], v[16:19], v[88:91], 0
v_mfma_f32_16x16x32_bf16 v[52:55], v[20:23], v[80:83], 0
v_mfma_f32_16x16x32_bf16 v[60:63], v[20:23], v[88:91], 0
s_waitcnt lgkmcnt(8)
v_mfma_f32_16x16x32_bf16 v[48:51], v[24:27], v[96:99], v[48:51]
v_mfma_f32_16x16x32_bf16 v[56:59], v[24:27], v[80:83], v[56:59]
v_mfma_f32_16x16x32_bf16 v[52:55], v[28:31], v[96:99], v[52:55]
v_mfma_f32_16x16x32_bf16 v[60:63], v[28:31], v[80:83], v[60:63]
s_waitcnt lgkmcnt(4)
v_mfma_f32_16x16x32_bf16 v[48:51], v[32:35], v[84:87], v[48:51]
v_mfma_f32_16x16x32_bf16 v[56:59], v[32:35], v[92:95], v[56:59]
v_mfma_f32_16x16x32_bf16 v[52:55], v[36:39], v[84:87], v[52:55]
v_mfma_f32_16x16x32_bf16 v[60:63], v[36:39], v[92:95], v[60:63]
s_waitcnt lgkmcnt(0)
v_mfma_f32_16x16x32_bf16 v[48:51], v[40:43], v[100:103], v[48:51]
v_mfma_f32_16x16x32_bf16 v[56:59], v[40:43], v[84:87], v[56:59]
v_mfma_f32_16x16x32_bf16 v[52:55], v[44:47], v[100:103], v[52:55]
v_mfma_f32_16x16x32_bf16 v[60:63], v[44:47], v[84:87], v[60:63]
s_nop 4
v_add_f32 v144, v144, v48
v_fma_f32 v152, v56, s25, v152
v_add_f32 v145, v145, v49
v_fma_f32 v153, v57, s25, v153
v_add_f32 v146, v146, v50
v_fma_f32 v154, v58, s25, v154
v_add_f32 v147, v147, v51
v_fma_f32 v155, v59, s25, v155
v_add_f32 v148, v148, v52
v_fma_f32 v156, v60, s25, v156
v_add_f32 v149, v149, v53
v_fma_f32 v157, v61, s25, v157
v_add_f32 v150, v150, v54
v_fma_f32 v158, v62, s25, v158
v_add_f32 v151, v151, v55
v_fma_f32 v159, v63, s25, v159
v_cvt_pk_bf16_f32 v64, v144, v145
v_cvt_pk_bf16_f32 v68, v152, v153
v_cvt_pk_bf16_f32 v65, v146, v147
v_cvt_pk_bf16_f32 v69, v154, v155
v_cvt_pk_bf16_f32 v66, v148, v149
v_cvt_pk_bf16_f32 v70, v156, v157
v_cvt_pk_bf16_f32 v67, v150, v151
v_cvt_pk_bf16_f32 v71, v158, v159
buffer_store_dwordx4 v[64:67], v189, s[4:7], s28 offen sc1
buffer_store_dwordx4 v[68:71], v189, s[4:7], s28 offen offset:128 sc1
s_mov_b32 s33, 0
s_mov_b64 exec, 3
s_waitcnt vmcnt(2)
chk_12:
v_cmp_gt_u32 vcc, v247, v248
s_add_u32 s33, s33, 1
s_cbranch_vccz chk_12_d
s_cmp_gt_u32 s33, 32768
s_cbranch_scc1 chk_12_d
v_mov_b32 v248, 0
buffer_atomic_or v248, v246, s[4:7], 0 offen sc0 sc1
s_waitcnt vmcnt(0)
s_branch chk_12
chk_12_d:
s_mov_b64 exec, -1
buffer_load_dwordx4 a[0:3], v231, s[4:7], s26 offen offset:0
buffer_load_dwordx4 a[4:7], v231, s[4:7], s26 offen offset:1024
buffer_load_dwordx4 a[8:11], v231, s[4:7], s26 offen offset:2048
buffer_load_dwordx4 a[12:15], v231, s[4:7], s26 offen offset:3072
s_add_u32 s26, s26, 4096
buffer_load_dwordx4 a[16:19], v231, s[4:7], s26 offen offset:0
buffer_load_dwordx4 a[20:23], v231, s[4:7], s26 offen offset:1024
v_mov_b32 v8, v232
v_mov_b32 v9, v233
v_mov_b32 v10, v234
v_lshlrev_b32 v8, 16, v8
v_lshlrev_b32 v9, 16, v9
v_lshlrev_b32 v10, 16, v10
v_mul_f32 v10, 0x3fb8aa3b, v10
v_exp_f32 v10, v10
s_nop 0
v_cvt_pk_bf16_f32 v10, v10, v10
v_lshlrev_b32 v10, 16, v10
v_mul_f32 v12, v10, v8
v_mul_f32 v12, 0x3fb8aa3b, v12
v_exp_f32 v12, v12
v_mul_f32 v13, v10, v9
v_mul_f32 v13, 0x3e22f983, v13
v_fract_f32 v13, v13
v_cos_f32 v190, v13
v_sin_f32 v206, v13
v_mul_f32 v190, v190, v12
v_mul_f32 v206, v206, v12
v_lshlrev_b32 v228, 16, v228
v_mul_f32 v228, 0.5, v228
v_mul_f32 v191, v190, v190
v_mul_f32 v207, v190, v206
v_fma_f32 v191, -v206, v206, v191
v_fmac_f32 v207, v206, v190
v_mul_f32 v192, v190, v191
v_mul_f32 v208, v190, v207
v_fma_f32 v192, -v206, v207, v192
v_fmac_f32 v208, v206, v191
v_mul_f32 v193, v191, v191
v_mul_f32 v209, v191, v207
v_fma_f32 v193, -v207, v207, v193
v_fmac_f32 v209, v207, v191
v_mul_f32 v194, v191, v192
v_mul_f32 v210, v191, v208
v_fma_f32 v194, -v207, v208, v194
v_fmac_f32 v210, v207, v192
v_mul_f32 v195, v192, v192
v_mul_f32 v211, v192, v208
v_fma_f32 v195, -v208, v208, v195
v_fmac_f32 v211, v208, v192
v_mul_f32 v196, v192, v193
v_mul_f32 v212, v192, v209
v_fma_f32 v196, -v208, v209, v196
v_fmac_f32 v212, v208, v193
v_mul_f32 v197, v193, v193
v_mul_f32 v213, v193, v209
v_fma_f32 v197, -v209, v209, v197
v_fmac_f32 v213, v209, v193
v_mul_f32 v198, v193, v194
v_mul_f32 v214, v193, v210
v_fma_f32 v198, -v209, v210, v198
v_fmac_f32 v214, v209, v194
v_mul_f32 v199, v194, v194
v_mul_f32 v215, v194, v210
v_fma_f32 v199, -v210, v210, v199
v_fmac_f32 v215, v210, v194
v_mul_f32 v200, v194, v195
v_mul_f32 v216, v194, v211
v_fma_f32 v200, -v210, v211, v200
v_fmac_f32 v216, v210, v195
v_mul_f32 v201, v195, v195
v_mul_f32 v217, v195, v211
v_fma_f32 v201, -v211, v211, v201
v_fmac_f32 v217, v211, v195
v_mul_f32 v202, v195, v196
v_mul_f32 v218, v195, v212
v_fma_f32 v202, -v211, v212, v202
v_fmac_f32 v218, v211, v196
v_mul_f32 v203, v196, v196
v_mul_f32 v219, v196, v212
v_fma_f32 v203, -v212, v212, v203
v_fmac_f32 v219, v212, v196
v_mul_f32 v204, v196, v197
v_mul_f32 v220, v196, v213
v_fma_f32 v204, -v212, v213, v204
v_fmac_f32 v220, v212, v197
v_mul_f32 v205, v197, v197
v_mul_f32 v221, v197, v213
v_fma_f32 v205, -v213, v213, v205
v_fmac_f32 v221, v213, v197
v_mul_f32 v14, v205, v205
v_mul_f32 v15, v205, v221
v_fma_f32 v14, -v221, v221, v14
v_fmac_f32 v15, v221, v205
v_mul_f32 v16, v14, v205
v_mul_f32 v17, v14, v221
v_fma_f32 v16, -v15, v221, v16
v_fmac_f32 v17, v15, v205
v_mul_f32 v18, v14, v14
v_mul_f32 v19, v14, v15
v_fma_f32 v18, -v15, v15, v18
v_fmac_f32 v19, v15, v14
v_mul_f32 v20, v18, v18
v_mul_f32 v21, v18, v19
v_fma_f32 v20, -v19, v19, v20
v_fmac_f32 v21, v19, v18
v_mul_f32 v22, v20, v18
v_mul_f32 v23, v20, v19
v_fma_f32 v22, -v21, v19, v22
v_fmac_f32 v23, v21, v18
v_mul_f32 v226, v20, v20
v_mul_f32 v227, v20, v21
v_fma_f32 v226, -v21, v21, v226
v_fmac_f32 v227, v21, v20
v_cndmask_b32 v222, 1.0, v205, s[44:45]
v_cndmask_b32 v222, v222, v14, s[46:47]
v_cndmask_b32 v222, v222, v16, s[48:49]
v_cndmask_b32 v223, 0, v221, s[44:45]
v_cndmask_b32 v223, v223, v15, s[46:47]
v_cndmask_b32 v223, v223, v17, s[48:49]
v_cndmask_b32 v224, 1.0, v18, s[44:45]
v_cndmask_b32 v224, v224, v20, s[46:47]
v_cndmask_b32 v224, v224, v22, s[48:49]
v_cndmask_b32 v225, 0, v19, s[44:45]
v_cndmask_b32 v225, v225, v21, s[46:47]
v_cndmask_b32 v225, v225, v23, s[48:49]
buffer_load_dwordx4 a[24:27], v231, s[4:7], s26 offen offset:2048
buffer_load_dwordx4 a[28:31], v231, s[4:7], s26 offen offset:3072
s_add_u32 s26, s26, 4096
v_lshrrev_b32 v156, 2, v1
v_lshlrev_b32 v100, 7, v156
v_bfe_u32 v156, v1, 3, 2
v_lshl_add_u32 v100, v156, 5, v100
v_and_b32 v156, 3, v1
v_lshl_add_u32 v100, v156, 3, v100
v_xor_b32 v101, 32, v100
v_xor_b32 v102, 64, v100
v_xor_b32 v103, 0x60, v100
s_lshl_b32 s29, s20, 5
v_xor_b32 v104, s29, v100
s_and_b32 s29, s2, 15
s_lshl_b32 s29, s29, 7
s_add_u32 s29, s29, 20480000
s_waitcnt vmcnt(8)
s_barrier
s_cmp_lg_u32 s20, 0
s_cbranch_scc1 sig_13
v_mov_b32 v5, 1
v_mul_u32_u24 v6, 2048, v1
s_mov_b32 exec_lo, 65535
s_mov_b32 exec_hi, 0
buffer_atomic_add v5, v6, s[4:7], s29 offen sc1
s_mov_b64 exec, -1
sig_13:
s_cmp_lg_u32 s20, 0
s_cbranch_scc1 pi_14
s_and_b32 s28, s2, 15
s_mul_i32 s29, s28, 2048
s_add_u32 s29, s29, 20480000
v_and_b32 v5, 15, v1
v_lshlrev_b32 v5, 7, v5
v_add_u32 v5, s29, v5
v_mov_b32 v6, 14
s_mov_b32 s50, 65535
s_mov_b32 s51, 0
v_mov_b32 v2, 0
s_mov_b64 exec, s[50:51]
buffer_atomic_or v2, v5, s[4:7], 0 offen sc0 sc1
s_mov_b64 exec, -1
pi_14:
buffer_load_dwordx4 a[32:35], v231, s[4:7], s26 offen offset:0
buffer_load_dwordx4 a[36:39], v231, s[4:7], s26 offen offset:1024
buffer_load_dwordx4 a[40:43], v231, s[4:7], s26 offen offset:2048
buffer_load_dwordx4 a[44:47], v231, s[4:7], s26 offen offset:3072
s_add_u32 s26, s26, 4096
s_cmp_lg_u32 s20, 0
s_cbranch_scc1 poll_15_d
s_mov_b32 s28, 0
s_mov_b64 exec, s[50:51]
s_waitcnt vmcnt(4)
poll_15:
v_cmp_gt_u32 vcc, v6, v2
s_add_u32 s28, s28, 1
s_and_b64 exec, vcc, vcc
s_cbranch_scc0 poll_15_d
s_cmp_gt_u32 s28, 32768
s_cbranch_scc1 poll_15_d
v_mov_b32 v2, 0
buffer_atomic_or v2, v5, s[4:7], 0 offen sc0 sc1
s_waitcnt vmcnt(0)
s_branch poll_15
poll_15_d:
s_mov_b64 exec, -1
s_barrier
s_mov_b32 s34, s27
s_mov_b32 s35, s58
s_mov_b32 s3, s26
SC_redo0:
s_mov_b32 s26, s3
s_mov_b32 s27, s34
s_mov_b32 s58, s35
s_lshl_b32 s29, s20, 10
s_mov_b32 m0, s29
s_mul_i32 s30, s23, 57344
s_add_u32 s30, s30, s29
s_add_u32 s30, s30, 3145728
buffer_load_dwordx4 v231, s[4:7], s30 offen sc1 lds
s_add_u32 m0, m0, 4096
s_add_u32 s30, s30, 4096
buffer_load_dwordx4 v231, s[4:7], s30 offen sc1 lds
s_add_u32 m0, m0, 4096
s_add_u32 s30, s30, 4096
buffer_load_dwordx4 v231, s[4:7], s30 offen sc1 lds
s_add_u32 m0, m0, 4096
s_add_u32 s30, s30, 4096
buffer_load_dwordx4 v231, s[4:7], s30 offen sc1 lds
s_add_u32 m0, m0, 4096
s_add_u32 s30, s30, 4096
buffer_load_dwordx4 v231, s[4:7], s30 offen sc1 lds
s_add_u32 m0, m0, 4096
s_add_u32 s30, s30, 4096
buffer_load_dwordx4 v231, s[4:7], s30 offen sc1 lds
s_add_u32 m0, m0, 4096
s_add_u32 s30, s30, 4096
buffer_load_dwordx4 v231, s[4:7], s30 offen sc1 lds
s_add_u32 m0, m0, 4096
s_add_u32 s30, s30, 4096
buffer_load_dwordx4 v231, s[4:7], s30 offen sc1 lds
s_add_u32 m0, m0, 4096
s_add_u32 s30, s30, 4096
buffer_load_dwordx4 v231, s[4:7], s30 offen sc1 lds
s_add_u32 m0, m0, 4096
s_add_u32 s30, s30, 4096
buffer_load_dwordx4 v231, s[4:7], s30 offen sc1 lds
s_add_u32 m0, m0, 4096
s_add_u32 s30, s30, 4096
buffer_load_dwordx4 v231, s[4:7], s30 offen sc1 lds
s_add_u32 m0, m0, 4096
s_add_u32 s30, s30, 4096
buffer_load_dwordx4 v231, s[4:7], s30 offen sc1 lds
s_add_u32 m0, m0, 4096
s_add_u32 s30, s30, 4096
buffer_load_dwordx4 v231, s[4:7], s30 offen sc1 lds
s_add_u32 m0, m0, 4096
s_add_u32 s30, s30, 4096
buffer_load_dwordx4 v231, s[4:7], s30 offen sc1 lds
s_and_b32 s28, s2, 15
s_lshl_b32 s28, s28, 2
s_add_u32 s28, s28, s20
s_lshl_b32 s28, s28, 7
s_add_u32 s28, s28, 20627456
v_mov_b32 v170, s28
v_mov_b32 v171, 28
s_waitcnt vmcnt(12)
s_barrier
ds_read_b64_tr_b16 v[60:61], v100 offset:0
ds_read_b64_tr_b16 v[62:63], v100 offset:2048
ds_read_b64_tr_b16 v[64:65], v101 offset:0
ds_read_b64_tr_b16 v[66:67], v101 offset:2048
ds_read_b64_tr_b16 v[68:69], v102 offset:0
ds_read_b64_tr_b16 v[70:71], v102 offset:2048
ds_read_b64_tr_b16 v[72:73], v103 offset:0
ds_read_b64_tr_b16 v[74:75], v103 offset:2048
ds_read_b64_tr_b16 v[76:77], v104 offset:0
ds_read_b64_tr_b16 v[78:79], v104 offset:2048
s_waitcnt lgkmcnt(8)
v_mfma_f32_16x16x32_bf16 v[8:11], v[60:63], a[0:3], 0
ds_read_b64_tr_b16 v[80:81], v100 offset:4096
v_mfma_f32_16x16x32_bf16 v[24:27], v[60:63], a[4:7], 0
ds_read_b64_tr_b16 v[82:83], v100 offset:6144
s_waitcnt lgkmcnt(8)
v_mfma_f32_16x16x32_bf16 v[12:15], v[64:67], a[0:3], 0
ds_read_b64_tr_b16 v[84:85], v101 offset:4096
v_mfma_f32_16x16x32_bf16 v[28:31], v[64:67], a[4:7], 0
ds_read_b64_tr_b16 v[86:87], v101 offset:6144
buffer_load_dwordx4 a[48:51], v231, s[4:7], s26 offen offset:0
s_waitcnt lgkmcnt(8)
v_mfma_f32_16x16x32_bf16 v[16:19], v[68:71], a[0:3], 0
ds_read_b64_tr_b16 v[88:89], v102 offset:4096
v_mfma_f32_16x16x32_bf16 v[32:35], v[68:71], a[4:7], 0
ds_read_b64_tr_b16 v[90:91], v102 offset:6144
s_waitcnt lgkmcnt(8)
v_mfma_f32_16x16x32_bf16 v[20:23], v[72:75], a[0:3], 0
ds_read_b64_tr_b16 v[92:93], v103 offset:4096
v_mfma_f32_16x16x32_bf16 v[36:39], v[72:75], a[4:7], 0
ds_read_b64_tr_b16 v[94:95], v103 offset:6144
buffer_load_dwordx4 a[52:55], v231, s[4:7], s26 offen offset:1024
s_waitcnt lgkmcnt(8)
v_mfma_f32_16x16x32_bf16 v[56:59], v[76:79], v[76:79], 0
ds_read_b64_tr_b16 v[96:97], v104 offset:4096
ds_read_b64_tr_b16 v[98:99], v104 offset:6144
s_waitcnt vmcnt(12)
s_barrier
s_waitcnt lgkmcnt(8)
v_mfma_f32_16x16x32_bf16 v[8:11], v[80:83], a[8:11], v[8:11]
ds_read_b64_tr_b16 v[60:61], v100 offset:8192
v_mfma_f32_16x16x32_bf16 v[24:27], v[80:83], a[12:15], v[24:27]
ds_read_b64_tr_b16 v[62:63], v100 offset:10240
s_waitcnt lgkmcnt(8)
v_mfma_f32_16x16x32_bf16 v[12:15], v[84:87], a[8:11], v[12:15]
ds_read_b64_tr_b16 v[64:65], v101 offset:8192
v_mfma_f32_16x16x32_bf16 v[28:31], v[84:87], a[12:15], v[28:31]
ds_read_b64_tr_b16 v[66:67], v101 offset:10240
buffer_load_dwordx4 a[56:59], v231, s[4:7], s26 offen offset:2048
s_waitcnt lgkmcnt(8)
v_mfma_f32_16x16x32_bf16 v[16:19], v[88:91], a[8:11], v[16:19]
ds_read_b64_tr_b16 v[68:69], v102 offset:8192
v_mfma_f32_16x16x32_bf16 v[32:35], v[88:91], a[12:15], v[32:35]
ds_read_b64_tr_b16 v[70:71], v102 offset:10240
s_waitcnt lgkmcnt(8)
v_mfma_f32_16x16x32_bf16 v[20:23], v[92:95], a[8:11], v[20:23]
ds_read_b64_tr_b16 v[72:73], v103 offset:8192
v_mfma_f32_16x16x32_bf16 v[36:39], v[92:95], a[12:15], v[36:39]
ds_read_b64_tr_b16 v[74:75], v103 offset:10240
buffer_load_dwordx4 a[60:63], v231, s[4:7], s26 offen offset:3072
s_add_u32 s26, s26, 4096
s_waitcnt lgkmcnt(8)
v_mfma_f32_16x16x32_bf16 v[56:59], v[96:99], v[96:99], v[56:59]
ds_read_b64_tr_b16 v[76:77], v104 offset:8192
ds_read_b64_tr_b16 v[78:79], v104 offset:10240
s_waitcnt lgkmcnt(8)
v_mfma_f32_16x16x32_bf16 v[8:11], v[60:63], a[16:19], v[8:11]
ds_read_b64_tr_b16 v[80:81], v100 offset:12288
v_mfma_f32_16x16x32_bf16 v[24:27], v[60:63], a[20:23], v[24:27]
ds_read_b64_tr_b16 v[82:83], v100 offset:14336
s_waitcnt lgkmcnt(8)
v_mfma_f32_16x16x32_bf16 v[12:15], v[64:67], a[16:19], v[12:15]
ds_read_b64_tr_b16 v[84:85], v101 offset:12288
v_mfma_f32_16x16x32_bf16 v[28:31], v[64:67], a[20:23], v[28:31]
ds_read_b64_tr_b16 v[86:87], v101 offset:14336
buffer_load_dwordx4 a[64:67], v231, s[4:7], s26 offen offset:0
s_waitcnt lgkmcnt(8)
v_mfma_f32_16x16x32_bf16 v[16:19], v[68:71], a[16:19], v[16:19]
ds_read_b64_tr_b16 v[88:89], v102 offset:12288
v_mfma_f32_16x16x32_bf16 v[32:35], v[68:71], a[20:23], v[32:35]
ds_read_b64_tr_b16 v[90:91], v102 offset:14336
s_waitcnt lgkmcnt(8)
v_mfma_f32_16x16x32_bf16 v[20:23], v[72:75], a[16:19], v[20:23]
ds_read_b64_tr_b16 v[92:93], v103 offset:12288
v_mfma_f32_16x16x32_bf16 v[36:39], v[72:75], a[20:23], v[36:39]
ds_read_b64_tr_b16 v[94:95], v103 offset:14336
buffer_load_dwordx4 a[68:71], v231, s[4:7], s26 offen offset:1024
s_waitcnt lgkmcnt(8)
v_mfma_f32_16x16x32_bf16 v[56:59], v[76:79], v[76:79], v[56:59]
ds_read_b64_tr_b16 v[96:97], v104 offset:12288
ds_read_b64_tr_b16 v[98:99], v104 offset:14336
s_waitcnt vmcnt(11)
s_barrier
s_waitcnt lgkmcnt(8)
v_mfma_f32_16x16x32_bf16 v[8:11], v[80:83], a[24:27], v[8:11]
ds_read_b64_tr_b16 v[60:61], v100 offset:16384
v_mfma_f32_16x16x32_bf16 v[24:27], v[80:83], a[28:31], v[24:27]
ds_read_b64_tr_b16 v[62:63], v100 offset:18432
s_waitcnt lgkmcnt(8)
v_mfma_f32_16x16x32_bf16 v[12:15], v[84:87], a[24:27], v[12:15]
ds_read_b64_tr_b16 v[64:65], v101 offset:16384
v_mfma_f32_16x16x32_bf16 v[28:31], v[84:87], a[28:31], v[28:31]
ds_read_b64_tr_b16 v[66:67], v101 offset:18432
buffer_load_dwordx4 a[72:75], v231, s[4:7], s26 offen offset:2048
s_waitcnt lgkmcnt(8)
v_mfma_f32_16x16x32_bf16 v[16:19], v[88:91], a[24:27], v[16:19]
ds_read_b64_tr_b16 v[68:69], v102 offset:16384
v_mfma_f32_16x16x32_bf16 v[32:35], v[88:91], a[28:31], v[32:35]
ds_read_b64_tr_b16 v[70:71], v102 offset:18432
s_waitcnt lgkmcnt(8)
v_mfma_f32_16x16x32_bf16 v[20:23], v[92:95], a[24:27], v[20:23]
ds_read_b64_tr_b16 v[72:73], v103 offset:16384
v_mfma_f32_16x16x32_bf16 v[36:39], v[92:95], a[28:31], v[36:39]
ds_read_b64_tr_b16 v[74:75], v103 offset:18432
buffer_load_dwordx4 a[76:79], v231, s[4:7], s26 offen offset:3072
s_add_u32 s26, s26, 4096
s_waitcnt lgkmcnt(8)
v_mfma_f32_16x16x32_bf16 v[56:59], v[96:99], v[96:99], v[56:59]
ds_read_b64_tr_b16 v[76:77], v104 offset:16384
ds_read_b64_tr_b16 v[78:79], v104 offset:18432
s_waitcnt lgkmcnt(8)
v_mfma_f32_16x16x32_bf16 v[8:11], v[60:63], a[32:35], v[8:11]
ds_read_b64_tr_b16 v[80:81], v100 offset:20480
v_mfma_f32_16x16x32_bf16 v[24:27], v[60:63], a[36:39], v[24:27]
ds_read_b64_tr_b16 v[82:83], v100 offset:22528
s_waitcnt lgkmcnt(8)
v_mfma_f32_16x16x32_bf16 v[12:15], v[64:67], a[32:35], v[12:15]
ds_read_b64_tr_b16 v[84:85], v101 offset:20480
v_mfma_f32_16x16x32_bf16 v[28:31], v[64:67], a[36:39], v[28:31]
ds_read_b64_tr_b16 v[86:87], v101 offset:22528
buffer_load_dwordx4 a[80:83], v231, s[4:7], s26 offen offset:0
s_waitcnt lgkmcnt(8)
v_mfma_f32_16x16x32_bf16 v[16:19], v[68:71], a[32:35], v[16:19]
ds_read_b64_tr_b16 v[88:89], v102 offset:20480
v_mfma_f32_16x16x32_bf16 v[32:35], v[68:71], a[36:39], v[32:35]
ds_read_b64_tr_b16 v[90:91], v102 offset:22528
s_waitcnt lgkmcnt(8)
v_mfma_f32_16x16x32_bf16 v[20:23], v[72:75], a[32:35], v[20:23]
ds_read_b64_tr_b16 v[92:93], v103 offset:20480
v_mfma_f32_16x16x32_bf16 v[36:39], v[72:75], a[36:39], v[36:39]
ds_read_b64_tr_b16 v[94:95], v103 offset:22528
buffer_load_dwordx4 a[84:87], v231, s[4:7], s26 offen offset:1024
s_waitcnt lgkmcnt(8)
v_mfma_f32_16x16x32_bf16 v[56:59], v[76:79], v[76:79], v[56:59]
ds_read_b64_tr_b16 v[96:97], v104 offset:20480
ds_read_b64_tr_b16 v[98:99], v104 offset:22528
v_mov_b32 v172, 0
s_mov_b64 exec, 1
buffer_atomic_or v172, v170, s[4:7], 0 offen sc0 sc1
s_mov_b64 exec, -1
s_waitcnt lgkmcnt(8)
v_mfma_f32_16x16x32_bf16 v[8:11], v[80:83], a[40:43], v[8:11]
ds_read_b64_tr_b16 v[60:61], v100 offset:24576
v_mfma_f32_16x16x32_bf16 v[24:27], v[80:83], a[44:47], v[24:27]
ds_read_b64_tr_b16 v[62:63], v100 offset:26624
s_waitcnt lgkmcnt(8)
v_mfma_f32_16x16x32_bf16 v[12:15], v[84:87], a[40:43], v[12:15]
ds_read_b64_tr_b16 v[64:65], v101 offset:24576
v_mfma_f32_16x16x32_bf16 v[28:31], v[84:87], a[44:47], v[28:31]
ds_read_b64_tr_b16 v[66:67], v101 offset:26624
buffer_load_dwordx4 a[88:91], v231, s[4:7], s26 offen offset:2048
s_waitcnt lgkmcnt(8)
v_mfma_f32_16x16x32_bf16 v[16:19], v[88:91], a[40:43], v[16:19]
ds_read_b64_tr_b16 v[68:69], v102 offset:24576
v_mfma_f32_16x16x32_bf16 v[32:35], v[88:91], a[44:47], v[32:35]
ds_read_b64_tr_b16 v[70:71], v102 offset:26624
s_waitcnt lgkmcnt(8)
v_mfma_f32_16x16x32_bf16 v[20:23], v[92:95], a[40:43], v[20:23]
ds_read_b64_tr_b16 v[72:73], v103 offset:24576
v_mfma_f32_16x16x32_bf16 v[36:39], v[92:95], a[44:47], v[36:39]
ds_read_b64_tr_b16 v[74:75], v103 offset:26624
buffer_load_dwordx4 a[92:95], v231, s[4:7], s26 offen offset:3072
s_add_u32 s26, s26, 4096
s_waitcnt lgkmcnt(8)
v_mfma_f32_16x16x32_bf16 v[56:59], v[96:99], v[96:99], v[56:59]
ds_read_b64_tr_b16 v[76:77], v104 offset:24576
ds_read_b64_tr_b16 v[78:79], v104 offset:26624
s_waitcnt vmcnt(11)
s_waitcnt lgkmcnt(8)
v_mfma_f32_16x16x32_bf16 v[8:11], v[60:63], a[48:51], v[8:11]
ds_read_b64_tr_b16 v[80:81], v100 offset:28672
v_mfma_f32_16x16x32_bf16 v[24:27], v[60:63], a[52:55], v[24:27]
ds_read_b64_tr_b16 v[82:83], v100 offset:30720
s_waitcnt lgkmcnt(8)
v_mfma_f32_16x16x32_bf16 v[12:15], v[64:67], a[48:51], v[12:15]
ds_read_b64_tr_b16 v[84:85], v101 offset:28672
v_mfma_f32_16x16x32_bf16 v[28:31], v[64:67], a[52:55], v[28:31]
ds_read_b64_tr_b16 v[86:87], v101 offset:30720
buffer_load_dwordx4 a[96:99], v231, s[4:7], s26 offen offset:0
s_waitcnt lgkmcnt(8)
v_mfma_f32_16x16x32_bf16 v[16:19], v[68:71], a[48:51], v[16:19]
ds_read_b64_tr_b16 v[88:89], v102 offset:28672
v_mfma_f32_16x16x32_bf16 v[32:35], v[68:71], a[52:55], v[32:35]
ds_read_b64_tr_b16 v[90:91], v102 offset:30720
s_waitcnt lgkmcnt(8)
v_mfma_f32_16x16x32_bf16 v[20:23], v[72:75], a[48:51], v[20:23]
ds_read_b64_tr_b16 v[92:93], v103 offset:28672
v_mfma_f32_16x16x32_bf16 v[36:39], v[72:75], a[52:55], v[36:39]
ds_read_b64_tr_b16 v[94:95], v103 offset:30720
buffer_load_dwordx4 a[100:103], v231, s[4:7], s26 offen offset:1024
s_waitcnt lgkmcnt(8)
v_mfma_f32_16x16x32_bf16 v[56:59], v[76:79], v[76:79], v[56:59]
ds_read_b64_tr_b16 v[96:97], v104 offset:28672
ds_read_b64_tr_b16 v[98:99], v104 offset:30720
s_waitcnt vmcnt(11)
s_waitcnt lgkmcnt(8)
v_mfma_f32_16x16x32_bf16 v[8:11], v[80:83], a[56:59], v[8:11]
ds_read_b64_tr_b16 v[60:61], v100 offset:32768
v_mfma_f32_16x16x32_bf16 v[24:27], v[80:83], a[60:63], v[24:27]
ds_read_b64_tr_b16 v[62:63], v100 offset:34816
s_waitcnt lgkmcnt(8)
v_mfma_f32_16x16x32_bf16 v[12:15], v[84:87], a[56:59], v[12:15]
ds_read_b64_tr_b16 v[64:65], v101 offset:32768
v_mfma_f32_16x16x32_bf16 v[28:31], v[84:87], a[60:63], v[28:31]
ds_read_b64_tr_b16 v[66:67], v101 offset:34816
buffer_load_dwordx4 a[104:107], v231, s[4:7], s26 offen offset:2048
s_waitcnt lgkmcnt(8)
v_mfma_f32_16x16x32_bf16 v[16:19], v[88:91], a[56:59], v[16:19]
ds_read_b64_tr_b16 v[68:69], v102 offset:32768
v_mfma_f32_16x16x32_bf16 v[32:35], v[88:91], a[60:63], v[32:35]
ds_read_b64_tr_b16 v[70:71], v102 offset:34816
s_waitcnt lgkmcnt(8)
v_mfma_f32_16x16x32_bf16 v[20:23], v[92:95], a[56:59], v[20:23]
ds_read_b64_tr_b16 v[72:73], v103 offset:32768
v_mfma_f32_16x16x32_bf16 v[36:39], v[92:95], a[60:63], v[36:39]
ds_read_b64_tr_b16 v[74:75], v103 offset:34816
buffer_load_dwordx4 a[108:111], v231, s[4:7], s26 offen offset:3072
s_add_u32 s26, s26, 4096
s_waitcnt lgkmcnt(8)
v_mfma_f32_16x16x32_bf16 v[56:59], v[96:99], v[96:99], v[56:59]
ds_read_b64_tr_b16 v[76:77], v104 offset:32768
ds_read_b64_tr_b16 v[78:79], v104 offset:34816
s_barrier
s_waitcnt vmcnt(11)
s_waitcnt lgkmcnt(8)
v_mfma_f32_16x16x32_bf16 v[8:11], v[60:63], a[64:67], v[8:11]
ds_read_b64_tr_b16 v[80:81], v100 offset:36864
v_mfma_f32_16x16x32_bf16 v[24:27], v[60:63], a[68:71], v[24:27]
ds_read_b64_tr_b16 v[82:83], v100 offset:38912
s_waitcnt lgkmcnt(8)
v_mfma_f32_16x16x32_bf16 v[12:15], v[64:67], a[64:67], v[12:15]
ds_read_b64_tr_b16 v[84:85], v101 offset:36864
v_mfma_f32_16x16x32_bf16 v[28:31], v[64:67], a[68:71], v[28:31]
ds_read_b64_tr_b16 v[86:87], v101 offset:38912
buffer_load_dwordx4 a[168:171], v230, s[4:7], s58 offen offset:0
s_waitcnt lgkmcnt(8)
v_mfma_f32_16x16x32_bf16 v[16:19], v[68:71], a[64:67], v[16:19]
ds_read_b64_tr_b16 v[88:89], v102 offset:36864
v_mfma_f32_16x16x32_bf16 v[32:35], v[68:71], a[68:71], v[32:35]
ds_read_b64_tr_b16 v[90:91], v102 offset:38912
s_waitcnt lgkmcnt(8)
v_mfma_f32_16x16x32_bf16 v[20:23], v[72:75], a[64:67], v[20:23]
ds_read_b64_tr_b16 v[92:93], v103 offset:36864
v_mfma_f32_16x16x32_bf16 v[36:39], v[72:75], a[68:71], v[36:39]
ds_read_b64_tr_b16 v[94:95], v103 offset:38912
buffer_load_dwordx4 a[172:175], v230, s[4:7], s58 offen offset:1024
s_waitcnt lgkmcnt(8)
v_mfma_f32_16x16x32_bf16 v[56:59], v[76:79], v[76:79], v[56:59]
ds_read_b64_tr_b16 v[96:97], v104 offset:36864
ds_read_b64_tr_b16 v[98:99], v104 offset:38912
s_mov_b32 s33, 0
s_mov_b64 exec, 1
s_waitcnt vmcnt(8)
chk_16:
v_cmp_gt_u32 vcc, v171, v172
s_add_u32 s33, s33, 1
s_cbranch_vccz chk_16_d
s_cmp_gt_u32 s33, 32768
s_cbranch_scc1 chk_16_d
v_mov_b32 v172, 0
buffer_atomic_or v172, v170, s[4:7], 0 offen sc0 sc1
s_waitcnt vmcnt(0)
s_branch chk_16
chk_16_d:
s_mov_b64 exec, -1
s_waitcnt lgkmcnt(8)
v_mfma_f32_16x16x32_bf16 v[8:11], v[80:83], a[72:75], v[8:11]
ds_read_b64_tr_b16 v[60:61], v100 offset:40960
v_mfma_f32_16x16x32_bf16 v[24:27], v[80:83], a[76:79], v[24:27]
ds_read_b64_tr_b16 v[62:63], v100 offset:43008
s_waitcnt lgkmcnt(8)
v_mfma_f32_16x16x32_bf16 v[12:15], v[84:87], a[72:75], v[12:15]
ds_read_b64_tr_b16 v[64:65], v101 offset:40960
v_mfma_f32_16x16x32_bf16 v[28:31], v[84:87], a[76:79], v[28:31]
ds_read_b64_tr_b16 v[66:67], v101 offset:43008
buffer_load_dwordx4 a[112:115], v231, s[4:7], s27 offen offset:0
s_waitcnt lgkmcnt(8)
v_mfma_f32_16x16x32_bf16 v[16:19], v[88:91], a[72:75], v[16:19]
ds_read_b64_tr_b16 v[68:69], v102 offset:40960
v_mfma_f32_16x16x32_bf16 v[32:35], v[88:91], a[76:79], v[32:35]
ds_read_b64_tr_b16 v[70:71], v102 offset:43008
s_waitcnt lgkmcnt(8)
v_mfma_f32_16x16x32_bf16 v[20:23], v[92:95], a[72:75], v[20:23]
ds_read_b64_tr_b16 v[72:73], v103 offset:40960
v_mfma_f32_16x16x32_bf16 v[36:39], v[92:95], a[76:79], v[36:39]
ds_read_b64_tr_b16 v[74:75], v103 offset:43008
buffer_load_dwordx4 a[116:119], v231, s[4:7], s27 offen offset:1024
s_waitcnt lgkmcnt(8)
v_mfma_f32_16x16x32_bf16 v[56:59], v[96:99], v[96:99], v[56:59]
ds_read_b64_tr_b16 v[76:77], v104 offset:40960
ds_read_b64_tr_b16 v[78:79], v104 offset:43008
s_waitcnt lgkmcnt(8)
v_mfma_f32_16x16x32_bf16 v[8:11], v[60:63], a[80:83], v[8:11]
ds_read_b64_tr_b16 v[80:81], v100 offset:45056
v_mfma_f32_16x16x32_bf16 v[24:27], v[60:63], a[84:87], v[24:27]
ds_read_b64_tr_b16 v[82:83], v100 offset:47104
s_waitcnt lgkmcnt(8)
v_mfma_f32_16x16x32_bf16 v[12:15], v[64:67], a[80:83], v[12:15]
ds_read_b64_tr_b16 v[84:85], v101 offset:45056
v_mfma_f32_16x16x32_bf16 v[28:31], v[64:67], a[84:87], v[28:31]
ds_read_b64_tr_b16 v[86:87], v101 offset:47104
buffer_load_dwordx4 a[120:123], v231, s[4:7], s27 offen offset:2048
s_waitcnt lgkmcnt(8)
v_mfma_f32_16x16x32_bf16 v[16:19], v[68:71], a[80:83], v[16:19]
ds_read_b64_tr_b16 v[88:89], v102 offset:45056
v_mfma_f32_16x16x32_bf16 v[32:35], v[68:71], a[84:87], v[32:35]
ds_read_b64_tr_b16 v[90:91], v102 offset:47104
s_waitcnt lgkmcnt(8)
v_mfma_f32_16x16x32_bf16 v[20:23], v[72:75], a[80:83], v[20:23]
ds_read_b64_tr_b16 v[92:93], v103 offset:45056
v_mfma_f32_16x16x32_bf16 v[36:39], v[72:75], a[84:87], v[36:39]
ds_read_b64_tr_b16 v[94:95], v103 offset:47104
buffer_load_dwordx4 a[124:127], v231, s[4:7], s27 offen offset:3072
s_add_u32 s27, s27, 4096
s_waitcnt lgkmcnt(8)
v_mfma_f32_16x16x32_bf16 v[56:59], v[76:79], v[76:79], v[56:59]
ds_read_b64_tr_b16 v[96:97], v104 offset:45056
ds_read_b64_tr_b16 v[98:99], v104 offset:47104
s_waitcnt vmcnt(10)
s_waitcnt lgkmcnt(8)
v_mfma_f32_16x16x32_bf16 v[8:11], v[80:83], a[88:91], v[8:11]
ds_read_b64_tr_b16 v[60:61], v100 offset:49152
v_mfma_f32_16x16x32_bf16 v[24:27], v[80:83], a[92:95], v[24:27]
ds_read_b64_tr_b16 v[62:63], v100 offset:51200
s_waitcnt lgkmcnt(8)
v_mfma_f32_16x16x32_bf16 v[12:15], v[84:87], a[88:91], v[12:15]
ds_read_b64_tr_b16 v[64:65], v101 offset:49152
v_mfma_f32_16x16x32_bf16 v[28:31], v[84:87], a[92:95], v[28:31]
ds_read_b64_tr_b16 v[66:67], v101 offset:51200
buffer_load_dwordx4 a[128:131], v231, s[4:7], s27 offen offset:0
s_waitcnt lgkmcnt(8)
v_mfma_f32_16x16x32_bf16 v[16:19], v[88:91], a[88:91], v[16:19]
ds_read_b64_tr_b16 v[68:69], v102 offset:49152
v_mfma_f32_16x16x32_bf16 v[32:35], v[88:91], a[92:95], v[32:35]
ds_read_b64_tr_b16 v[70:71], v102 offset:51200
s_waitcnt lgkmcnt(8)
v_mfma_f32_16x16x32_bf16 v[20:23], v[92:95], a[88:91], v[20:23]
ds_read_b64_tr_b16 v[72:73], v103 offset:49152
v_mfma_f32_16x16x32_bf16 v[36:39], v[92:95], a[92:95], v[36:39]
ds_read_b64_tr_b16 v[74:75], v103 offset:51200
buffer_load_dwordx4 a[132:135], v231, s[4:7], s27 offen offset:1024
s_waitcnt lgkmcnt(8)
v_mfma_f32_16x16x32_bf16 v[56:59], v[96:99], v[96:99], v[56:59]
ds_read_b64_tr_b16 v[76:77], v104 offset:49152
ds_read_b64_tr_b16 v[78:79], v104 offset:51200
s_waitcnt vmcnt(10)
s_waitcnt lgkmcnt(8)
v_mfma_f32_16x16x32_bf16 v[8:11], v[60:63], a[96:99], v[8:11]
ds_read_b64_tr_b16 v[80:81], v100 offset:53248
v_mfma_f32_16x16x32_bf16 v[24:27], v[60:63], a[100:103], v[24:27]
ds_read_b64_tr_b16 v[82:83], v100 offset:55296
s_waitcnt lgkmcnt(8)
v_mfma_f32_16x16x32_bf16 v[12:15], v[64:67], a[96:99], v[12:15]
ds_read_b64_tr_b16 v[84:85], v101 offset:53248
v_mfma_f32_16x16x32_bf16 v[28:31], v[64:67], a[100:103], v[28:31]
ds_read_b64_tr_b16 v[86:87], v101 offset:55296
buffer_load_dwordx4 a[136:139], v231, s[4:7], s27 offen offset:2048
s_waitcnt lgkmcnt(8)
v_mfma_f32_16x16x32_bf16 v[16:19], v[68:71], a[96:99], v[16:19]
ds_read_b64_tr_b16 v[88:89], v102 offset:53248
v_mfma_f32_16x16x32_bf16 v[32:35], v[68:71], a[100:103], v[32:35]
ds_read_b64_tr_b16 v[90:91], v102 offset:55296
s_waitcnt lgkmcnt(8)
v_mfma_f32_16x16x32_bf16 v[20:23], v[72:75], a[96:99], v[20:23]
ds_read_b64_tr_b16 v[92:93], v103 offset:53248
v_mfma_f32_16x16x32_bf16 v[36:39], v[72:75], a[100:103], v[36:39]
ds_read_b64_tr_b16 v[94:95], v103 offset:55296
buffer_load_dwordx4 a[140:143], v231, s[4:7], s27 offen offset:3072
s_add_u32 s27, s27, 4096
s_waitcnt lgkmcnt(8)
v_mfma_f32_16x16x32_bf16 v[56:59], v[76:79], v[76:79], v[56:59]
ds_read_b64_tr_b16 v[96:97], v104 offset:53248
ds_read_b64_tr_b16 v[98:99], v104 offset:55296
s_waitcnt vmcnt(10)
s_waitcnt lgkmcnt(8)
v_mfma_f32_16x16x32_bf16 v[8:11], v[80:83], a[104:107], v[8:11]
v_mfma_f32_16x16x32_bf16 v[24:27], v[80:83], a[108:111], v[24:27]
s_waitcnt lgkmcnt(6)
v_mfma_f32_16x16x32_bf16 v[12:15], v[84:87], a[104:107], v[12:15]
v_mfma_f32_16x16x32_bf16 v[28:31], v[84:87], a[108:111], v[28:31]
buffer_load_dwordx4 a[144:147], v231, s[4:7], s27 offen offset:0
s_waitcnt lgkmcnt(4)
v_mfma_f32_16x16x32_bf16 v[16:19], v[88:91], a[104:107], v[16:19]
v_mfma_f32_16x16x32_bf16 v[32:35], v[88:91], a[108:111], v[32:35]
s_waitcnt lgkmcnt(2)
v_mfma_f32_16x16x32_bf16 v[20:23], v[92:95], a[104:107], v[20:23]
v_mfma_f32_16x16x32_bf16 v[36:39], v[92:95], a[108:111], v[36:39]
buffer_load_dwordx4 a[148:151], v231, s[4:7], s27 offen offset:1024
s_waitcnt lgkmcnt(0)
v_mfma_f32_16x16x32_bf16 v[56:59], v[96:99], v[96:99], v[56:59]
v_and_b32 v159, 3, v1
v_lshlrev_b32 v158, 3, v4
v_lshl_add_u32 v158, v159, 1, v158
s_lshl_b32 s28, s20, 5
v_add_u32 v158, s28, v158
ds_read_u16 v156, v158 offset:128
v_cmp_eq_u32 s[50:51], 1, v159
v_cmp_eq_u32 s[52:53], 2, v159
v_cmp_eq_u32 s[54:55], 3, v159
v_lshlrev_b32 v158, 6, v4
v_lshl_add_u32 v158, v159, 2, v158
s_lshl_b32 s28, s20, 4
v_add_u32 v158, s28, v158
v_lshrrev_b32 v160, 2, v3
v_cmp_eq_u32 vcc, v160, v4
v_cndmask_b32 v157, v56, v57, s[50:51]
v_cndmask_b32 v157, v157, v58, s[52:53]
v_cndmask_b32 v157, v157, v59, s[54:55]
s_waitcnt lgkmcnt(0)
v_lshlrev_b32 v156, 16, v156
v_fma_f32 v157, -v156, v156, v157
v_max_f32 v157, 0, v157
v_mov_b32 v160, 0x3627c5ac
v_fmac_f32 v160, 0x3a124925, v157
v_rsq_f32 v160, v160
v_mul_f32 v156, 0x3d41848f, v156
s_and_saveexec_b64 s[56:57], vcc
ds_write2st64_b32 v158, v160, v156 offset0:224 offset1:225
s_mov_b64 exec, s[56:57]
v_lshlrev_b32 v158, 6, v4
s_waitcnt lgkmcnt(0)
s_barrier
ds_read_b128 v[106:109], v158 offset:57344
ds_read_b128 v[110:113], v158 offset:57360
ds_read_b128 v[114:117], v158 offset:57376
ds_read_b128 v[118:121], v158 offset:57392
s_waitcnt lgkmcnt(3)
v_pk_mul_f32 v[8:9], v[8:9], v[106:107]
v_pk_mul_f32 v[24:25], v[24:25], v[106:107]
v_pk_mul_f32 v[10:11], v[10:11], v[108:109]
v_pk_mul_f32 v[26:27], v[26:27], v[108:109]
v_fmac_f32 v9, v190, v8
v_fmac_f32 v25, v190, v24
v_fma_f32 v9, -v206, v24, v9
v_fmac_f32 v25, v206, v8
v_fmac_f32 v10, v190, v9
v_fmac_f32 v26, v190, v25
v_fma_f32 v10, -v206, v25, v10
v_fmac_f32 v26, v206, v9
v_fmac_f32 v11, v190, v10
v_fmac_f32 v27, v190, v26
v_fma_f32 v11, -v206, v26, v11
v_fmac_f32 v27, v206, v10
buffer_load_dwordx4 a[152:155], v231, s[4:7], s27 offen offset:2048
s_waitcnt lgkmcnt(2)
v_pk_mul_f32 v[12:13], v[12:13], v[110:111]
v_pk_mul_f32 v[28:29], v[28:29], v[110:111]
v_pk_mul_f32 v[14:15], v[14:15], v[112:113]
v_pk_mul_f32 v[30:31], v[30:31], v[112:113]
v_fmac_f32 v12, v190, v11
v_fmac_f32 v28, v190, v27
v_fma_f32 v12, -v206, v27, v12
v_fmac_f32 v28, v206, v11
v_fmac_f32 v13, v190, v12
v_fmac_f32 v29, v190, v28
v_fma_f32 v13, -v206, v28, v13
v_fmac_f32 v29, v206, v12
v_fmac_f32 v14, v190, v13
v_fmac_f32 v30, v190, v29
v_fma_f32 v14, -v206, v29, v14
v_fmac_f32 v30, v206, v13
v_fmac_f32 v15, v190, v14
v_fmac_f32 v31, v190, v30
v_fma_f32 v15, -v206, v30, v15
v_fmac_f32 v31, v206, v14
buffer_load_dwordx4 a[156:159], v231, s[4:7], s27 offen offset:3072
s_add_u32 s27, s27, 4096
s_waitcnt lgkmcnt(1)
v_pk_mul_f32 v[16:17], v[16:17], v[114:115]
v_pk_mul_f32 v[32:33], v[32:33], v[114:115]
v_pk_mul_f32 v[18:19], v[18:19], v[116:117]
v_pk_mul_f32 v[34:35], v[34:35], v[116:117]
v_fmac_f32 v16, v190, v15
v_fmac_f32 v32, v190, v31
v_fma_f32 v16, -v206, v31, v16
v_fmac_f32 v32, v206, v15
v_fmac_f32 v17, v190, v16
v_fmac_f32 v33, v190, v32
v_fma_f32 v17, -v206, v32, v17
v_fmac_f32 v33, v206, v16
v_fmac_f32 v18, v190, v17
v_fmac_f32 v34, v190, v33
v_fma_f32 v18, -v206, v33, v18
v_fmac_f32 v34, v206, v17
v_fmac_f32 v19, v190, v18
v_fmac_f32 v35, v190, v34
v_fma_f32 v19, -v206, v34, v19
v_fmac_f32 v35, v206, v18
buffer_load_dwordx4 a[160:163], v231, s[4:7], s27 offen offset:0
s_waitcnt lgkmcnt(0)
v_pk_mul_f32 v[20:21], v[20:21], v[118:119]
v_pk_mul_f32 v[36:37], v[36:37], v[118:119]
v_pk_mul_f32 v[22:23], v[22:23], v[120:121]
v_pk_mul_f32 v[38:39], v[38:39], v[120:121]
v_fmac_f32 v20, v190, v19
v_fmac_f32 v36, v190, v35
v_fma_f32 v20, -v206, v35, v20
v_fmac_f32 v36, v206, v19
v_fmac_f32 v21, v190, v20
v_fmac_f32 v37, v190, v36
v_fma_f32 v21, -v206, v36, v21
v_fmac_f32 v37, v206, v20
v_fmac_f32 v22, v190, v21
v_fmac_f32 v38, v190, v37
v_fma_f32 v22, -v206, v37, v22
v_fmac_f32 v38, v206, v21
v_fmac_f32 v23, v190, v22
v_fmac_f32 v39, v190, v38
v_fma_f32 v23, -v206, v38, v23
v_fmac_f32 v39, v206, v22
buffer_load_dwordx4 a[164:167], v231, s[4:7], s27 offen offset:1024
v_mov_b32 v156, v23
v_mov_b32 v157, v23
v_mov_b32 v160, v39
v_mov_b32 v161, v39
s_lshl_b32 s28, s24, 2
s_add_u32 s28, s28, s20
s_lshl_b32 s28, s28, 7
s_mul_i32 s33, s23, 3584
s_add_u32 s33, s33, s28
v_permlane16_swap_b32 v156, v157
v_permlane16_swap_b32 v160, v161
v_mov_b32 v158, v156
v_mov_b32 v164, v157
v_mov_b32 v162, v160
v_mov_b32 v165, v161
v_lshlrev_b32 v166, 3, v3
v_permlane32_swap_b32 v156, v158
v_permlane32_swap_b32 v157, v164
v_permlane32_swap_b32 v160, v162
v_permlane32_swap_b32 v161, v165
v_fmac_f32 v157, v205, v156
v_fmac_f32 v161, v205, v160
v_fma_f32 v157, -v221, v160, v157
v_fmac_f32 v161, v221, v156
v_fmac_f32 v158, v205, v157
v_fmac_f32 v162, v205, v161
v_fma_f32 v158, -v221, v161, v158
v_fmac_f32 v162, v221, v157
v_fmac_f32 v164, v205, v158
v_fmac_f32 v165, v205, v162
v_fma_f32 v164, -v221, v162, v164
v_fmac_f32 v165, v221, v158
s_mov_b64 exec, 0xffff
buffer_store_dwordx2 v[164:165], v166, s[8:11], s33 offen sc1
s_mov_b64 exec, -1
v_add_u32 v176, 16384, v170
v_mov_b32 v177, 32
v_cndmask_b32 v154, 0, v156, s[44:45]
v_cndmask_b32 v154, v154, v157, s[46:47]
v_cndmask_b32 v154, v154, v158, s[48:49]
v_cndmask_b32 v155, 0, v160, s[44:45]
v_cndmask_b32 v155, v155, v161, s[46:47]
v_cndmask_b32 v155, v155, v162, s[48:49]
v_mul_u32_u24 v159, 3584, v4
v_sub_u32 v168, v166, v159
s_sub_u32 s33, s33, 3584
v_add_u32 v168, s33, v168
v_subrev_u32 v169, 14336, v168
v_subrev_u32 v170, 28672, v168
v_subrev_u32 v171, 43008, v168
v_subrev_u32 v172, 57344, v168
v_subrev_u32 v173, 71680, v168
v_subrev_u32 v174, 86016, v168
v_subrev_u32 v175, 100352, v168
s_waitcnt vmcnt(1)
ds_read_b64_tr_b16 v[60:61], v100 offset:0
ds_read_b64_tr_b16 v[62:63], v100 offset:2048
ds_read_b64_tr_b16 v[64:65], v101 offset:0
ds_read_b64_tr_b16 v[66:67], v101 offset:2048
ds_read_b64_tr_b16 v[68:69], v102 offset:0
ds_read_b64_tr_b16 v[70:71], v102 offset:2048
ds_read_b64_tr_b16 v[72:73], v103 offset:0
ds_read_b64_tr_b16 v[74:75], v103 offset:2048
s_waitcnt lgkmcnt(6)
v_mfma_f32_16x16x32_bf16 v[40:43], v[60:63], a[112:115], 0
ds_read_b64_tr_b16 v[80:81], v100 offset:4096
ds_read_b64_tr_b16 v[82:83], v100 offset:6144
s_waitcnt lgkmcnt(6)
v_mfma_f32_16x16x32_bf16 v[44:47], v[64:67], a[112:115], 0
ds_read_b64_tr_b16 v[84:85], v101 offset:4096
ds_read_b64_tr_b16 v[86:87], v101 offset:6144
s_waitcnt lgkmcnt(6)
v_mfma_f32_16x16x32_bf16 v[48:51], v[68:71], a[112:115], 0
ds_read_b64_tr_b16 v[88:89], v102 offset:4096
ds_read_b64_tr_b16 v[90:91], v102 offset:6144
s_waitcnt lgkmcnt(6)
v_mfma_f32_16x16x32_bf16 v[52:55], v[72:75], a[112:115], 0
ds_read_b64_tr_b16 v[92:93], v103 offset:4096
ds_read_b64_tr_b16 v[94:95], v103 offset:6144
buffer_load_dwordx4 a[176:179], v230, s[4:7], s58 offen offset:2048
s_waitcnt lgkmcnt(6)
v_mfma_f32_16x16x32_bf16 v[40:43], v[80:83], a[116:119], v[40:43]
ds_read_b64_tr_b16 v[60:61], v100 offset:8192
ds_read_b64_tr_b16 v[62:63], v100 offset:10240
s_waitcnt lgkmcnt(6)
v_mfma_f32_16x16x32_bf16 v[44:47], v[84:87], a[116:119], v[44:47]
ds_read_b64_tr_b16 v[64:65], v101 offset:8192
ds_read_b64_tr_b16 v[66:67], v101 offset:10240
s_waitcnt lgkmcnt(6)
v_mfma_f32_16x16x32_bf16 v[48:51], v[88:91], a[116:119], v[48:51]
ds_read_b64_tr_b16 v[68:69], v102 offset:8192
ds_read_b64_tr_b16 v[70:71], v102 offset:10240
s_waitcnt lgkmcnt(6)
v_mfma_f32_16x16x32_bf16 v[52:55], v[92:95], a[116:119], v[52:55]
ds_read_b64_tr_b16 v[72:73], v103 offset:8192
ds_read_b64_tr_b16 v[74:75], v103 offset:10240
buffer_load_dwordx4 a[180:183], v230, s[4:7], s58 offen offset:3072
s_lshl_b32 s59, s24, 12
s_sub_u32 s58, s39, s59
s_cmp_eq_u32 s58, s39
s_cselect_b32 s59, 4096, 0
s_add_u32 s58, s58, s59
s_waitcnt lgkmcnt(6)
v_mfma_f32_16x16x32_bf16 v[40:43], v[60:63], a[120:123], v[40:43]
ds_read_b64_tr_b16 v[80:81], v100 offset:12288
ds_read_b64_tr_b16 v[82:83], v100 offset:14336
s_waitcnt lgkmcnt(6)
v_mfma_f32_16x16x32_bf16 v[44:47], v[64:67], a[120:123], v[44:47]
ds_read_b64_tr_b16 v[84:85], v101 offset:12288
ds_read_b64_tr_b16 v[86:87], v101 offset:14336
s_waitcnt lgkmcnt(6)
v_mfma_f32_16x16x32_bf16 v[48:51], v[68:71], a[120:123], v[48:51]
ds_read_b64_tr_b16 v[88:89], v102 offset:12288
ds_read_b64_tr_b16 v[90:91], v102 offset:14336
s_waitcnt lgkmcnt(6)
v_mfma_f32_16x16x32_bf16 v[52:55], v[72:75], a[120:123], v[52:55]
ds_read_b64_tr_b16 v[92:93], v103 offset:12288
ds_read_b64_tr_b16 v[94:95], v103 offset:14336
buffer_load_dwordx4 a[184:187], v230, s[4:7], s58 offen offset:0
s_waitcnt lgkmcnt(6)
v_mfma_f32_16x16x32_bf16 v[40:43], v[80:83], a[124:127], v[40:43]
ds_read_b64_tr_b16 v[60:61], v100 offset:16384
ds_read_b64_tr_b16 v[62:63], v100 offset:18432
s_waitcnt lgkmcnt(6)
v_mfma_f32_16x16x32_bf16 v[44:47], v[84:87], a[124:127], v[44:47]
ds_read_b64_tr_b16 v[64:65], v101 offset:16384
ds_read_b64_tr_b16 v[66:67], v101 offset:18432
s_waitcnt lgkmcnt(6)
v_mfma_f32_16x16x32_bf16 v[48:51], v[88:91], a[124:127], v[48:51]
ds_read_b64_tr_b16 v[68:69], v102 offset:16384
ds_read_b64_tr_b16 v[70:71], v102 offset:18432
s_waitcnt lgkmcnt(6)
v_mfma_f32_16x16x32_bf16 v[52:55], v[92:95], a[124:127], v[52:55]
ds_read_b64_tr_b16 v[72:73], v103 offset:16384
ds_read_b64_tr_b16 v[74:75], v103 offset:18432
buffer_load_dwordx4 a[188:191], v230, s[4:7], s58 offen offset:1024
s_waitcnt lgkmcnt(6)
v_mfma_f32_16x16x32_bf16 v[40:43], v[60:63], a[128:131], v[40:43]
ds_read_b64_tr_b16 v[80:81], v100 offset:20480
ds_read_b64_tr_b16 v[82:83], v100 offset:22528
s_waitcnt lgkmcnt(6)
v_mfma_f32_16x16x32_bf16 v[44:47], v[64:67], a[128:131], v[44:47]
ds_read_b64_tr_b16 v[84:85], v101 offset:20480
ds_read_b64_tr_b16 v[86:87], v101 offset:22528
s_waitcnt lgkmcnt(6)
v_mfma_f32_16x16x32_bf16 v[48:51], v[68:71], a[128:131], v[48:51]
ds_read_b64_tr_b16 v[88:89], v102 offset:20480
ds_read_b64_tr_b16 v[90:91], v102 offset:22528
s_waitcnt lgkmcnt(6)
v_mfma_f32_16x16x32_bf16 v[52:55], v[72:75], a[128:131], v[52:55]
ds_read_b64_tr_b16 v[92:93], v103 offset:20480
ds_read_b64_tr_b16 v[94:95], v103 offset:22528
buffer_load_dwordx4 a[192:195], v230, s[4:7], s58 offen offset:2048
s_waitcnt lgkmcnt(6)
v_mfma_f32_16x16x32_bf16 v[40:43], v[80:83], a[132:135], v[40:43]
ds_read_b64_tr_b16 v[60:61], v100 offset:24576
ds_read_b64_tr_b16 v[62:63], v100 offset:26624
s_waitcnt lgkmcnt(6)
v_mfma_f32_16x16x32_bf16 v[44:47], v[84:87], a[132:135], v[44:47]
ds_read_b64_tr_b16 v[64:65], v101 offset:24576
ds_read_b64_tr_b16 v[66:67], v101 offset:26624
s_waitcnt lgkmcnt(6)
v_mfma_f32_16x16x32_bf16 v[48:51], v[88:91], a[132:135], v[48:51]
ds_read_b64_tr_b16 v[68:69], v102 offset:24576
ds_read_b64_tr_b16 v[70:71], v102 offset:26624
s_waitcnt lgkmcnt(6)
v_mfma_f32_16x16x32_bf16 v[52:55], v[92:95], a[132:135], v[52:55]
ds_read_b64_tr_b16 v[72:73], v103 offset:24576
ds_read_b64_tr_b16 v[74:75], v103 offset:26624
buffer_load_dwordx4 a[196:199], v230, s[4:7], s58 offen offset:3072
s_add_u32 s58, s58, 4096
s_cmp_eq_u32 s58, s39
s_cselect_b32 s59, 4096, 0
s_add_u32 s58, s58, s59
s_waitcnt lgkmcnt(6)
v_mfma_f32_16x16x32_bf16 v[40:43], v[60:63], a[136:139], v[40:43]
ds_read_b64_tr_b16 v[80:81], v100 offset:28672
ds_read_b64_tr_b16 v[82:83], v100 offset:30720
s_waitcnt lgkmcnt(6)
v_mfma_f32_16x16x32_bf16 v[44:47], v[64:67], a[136:139], v[44:47]
ds_read_b64_tr_b16 v[84:85], v101 offset:28672
ds_read_b64_tr_b16 v[86:87], v101 offset:30720
s_waitcnt lgkmcnt(6)
v_mfma_f32_16x16x32_bf16 v[48:51], v[68:71], a[136:139], v[48:51]
ds_read_b64_tr_b16 v[88:89], v102 offset:28672
ds_read_b64_tr_b16 v[90:91], v102 offset:30720
s_waitcnt lgkmcnt(6)
v_mfma_f32_16x16x32_bf16 v[52:55], v[72:75], a[136:139], v[52:55]
ds_read_b64_tr_b16 v[92:93], v103 offset:28672
ds_read_b64_tr_b16 v[94:95], v103 offset:30720
buffer_load_dwordx4 a[200:203], v230, s[4:7], s58 offen offset:0
s_waitcnt lgkmcnt(6)
v_mfma_f32_16x16x32_bf16 v[40:43], v[80:83], a[140:143], v[40:43]
ds_read_b64_tr_b16 v[60:61], v100 offset:32768
ds_read_b64_tr_b16 v[62:63], v100 offset:34816
s_waitcnt lgkmcnt(6)
v_mfma_f32_16x16x32_bf16 v[44:47], v[84:87], a[140:143], v[44:47]
ds_read_b64_tr_b16 v[64:65], v101 offset:32768
ds_read_b64_tr_b16 v[66:67], v101 offset:34816
s_waitcnt lgkmcnt(6)
v_mfma_f32_16x16x32_bf16 v[48:51], v[88:91], a[140:143], v[48:51]
ds_read_b64_tr_b16 v[68:69], v102 offset:32768
ds_read_b64_tr_b16 v[70:71], v102 offset:34816
s_waitcnt lgkmcnt(6)
v_mfma_f32_16x16x32_bf16 v[52:55], v[92:95], a[140:143], v[52:55]
ds_read_b64_tr_b16 v[72:73], v103 offset:32768
ds_read_b64_tr_b16 v[74:75], v103 offset:34816
buffer_load_dwordx4 a[204:207], v230, s[4:7], s58 offen offset:1024
s_waitcnt lgkmcnt(6)
v_mfma_f32_16x16x32_bf16 v[40:43], v[60:63], a[144:147], v[40:43]
ds_read_b64_tr_b16 v[80:81], v100 offset:36864
ds_read_b64_tr_b16 v[82:83], v100 offset:38912
s_waitcnt lgkmcnt(6)
v_mfma_f32_16x16x32_bf16 v[44:47], v[64:67], a[144:147], v[44:47]
ds_read_b64_tr_b16 v[84:85], v101 offset:36864
ds_read_b64_tr_b16 v[86:87], v101 offset:38912
s_waitcnt lgkmcnt(6)
v_mfma_f32_16x16x32_bf16 v[48:51], v[68:71], a[144:147], v[48:51]
ds_read_b64_tr_b16 v[88:89], v102 offset:36864
ds_read_b64_tr_b16 v[90:91], v102 offset:38912
s_waitcnt lgkmcnt(6)
v_mfma_f32_16x16x32_bf16 v[52:55], v[72:75], a[144:147], v[52:55]
ds_read_b64_tr_b16 v[92:93], v103 offset:36864
ds_read_b64_tr_b16 v[94:95], v103 offset:38912
buffer_load_dwordx2 v[138:139], v168, s[8:11], 0 offen sc1
buffer_load_dwordx2 v[140:141], v169, s[8:11], 0 offen sc1
buffer_load_dwordx2 v[142:143], v170, s[8:11], 0 offen sc1
buffer_load_dwordx2 v[144:145], v171, s[8:11], 0 offen sc1
buffer_load_dwordx2 v[146:147], v172, s[8:11], 0 offen sc1
buffer_load_dwordx2 v[148:149], v173, s[8:11], 0 offen sc1
buffer_load_dwordx2 v[150:151], v174, s[8:11], 0 offen sc1
buffer_load_dwordx2 v[152:153], v175, s[8:11], 0 offen sc1
s_waitcnt lgkmcnt(6)
v_mfma_f32_16x16x32_bf16 v[40:43], v[80:83], a[148:151], v[40:43]
ds_read_b64_tr_b16 v[60:61], v100 offset:40960
ds_read_b64_tr_b16 v[62:63], v100 offset:43008
s_waitcnt lgkmcnt(6)
v_mfma_f32_16x16x32_bf16 v[44:47], v[84:87], a[148:151], v[44:47]
ds_read_b64_tr_b16 v[64:65], v101 offset:40960
ds_read_b64_tr_b16 v[66:67], v101 offset:43008
s_waitcnt lgkmcnt(6)
v_mfma_f32_16x16x32_bf16 v[48:51], v[88:91], a[148:151], v[48:51]
ds_read_b64_tr_b16 v[68:69], v102 offset:40960
ds_read_b64_tr_b16 v[70:71], v102 offset:43008
s_waitcnt lgkmcnt(6)
v_mfma_f32_16x16x32_bf16 v[52:55], v[92:95], a[148:151], v[52:55]
ds_read_b64_tr_b16 v[72:73], v103 offset:40960
ds_read_b64_tr_b16 v[74:75], v103 offset:43008
buffer_load_dwordx4 a[208:211], v230, s[4:7], s58 offen offset:2048
s_waitcnt lgkmcnt(6)
v_mfma_f32_16x16x32_bf16 v[40:43], v[60:63], a[152:155], v[40:43]
ds_read_b64_tr_b16 v[80:81], v100 offset:45056
ds_read_b64_tr_b16 v[82:83], v100 offset:47104
s_waitcnt lgkmcnt(6)
v_mfma_f32_16x16x32_bf16 v[44:47], v[64:67], a[152:155], v[44:47]
ds_read_b64_tr_b16 v[84:85], v101 offset:45056
ds_read_b64_tr_b16 v[86:87], v101 offset:47104
s_waitcnt lgkmcnt(6)
v_mfma_f32_16x16x32_bf16 v[48:51], v[68:71], a[152:155], v[48:51]
ds_read_b64_tr_b16 v[88:89], v102 offset:45056
ds_read_b64_tr_b16 v[90:91], v102 offset:47104
s_waitcnt lgkmcnt(6)
v_mfma_f32_16x16x32_bf16 v[52:55], v[72:75], a[152:155], v[52:55]
ds_read_b64_tr_b16 v[92:93], v103 offset:45056
ds_read_b64_tr_b16 v[94:95], v103 offset:47104
buffer_load_dwordx4 a[212:215], v230, s[4:7], s58 offen offset:3072
s_add_u32 s58, s58, 4096
s_cmp_eq_u32 s58, s39
s_cselect_b32 s59, 4096, 0
s_add_u32 s58, s58, s59
s_waitcnt lgkmcnt(6)
v_mfma_f32_16x16x32_bf16 v[40:43], v[80:83], a[156:159], v[40:43]
ds_read_b64_tr_b16 v[60:61], v100 offset:49152
ds_read_b64_tr_b16 v[62:63], v100 offset:51200
s_waitcnt lgkmcnt(6)
v_mfma_f32_16x16x32_bf16 v[44:47], v[84:87], a[156:159], v[44:47]
ds_read_b64_tr_b16 v[64:65], v101 offset:49152
ds_read_b64_tr_b16 v[66:67], v101 offset:51200
s_waitcnt lgkmcnt(6)
v_mfma_f32_16x16x32_bf16 v[48:51], v[88:91], a[156:159], v[48:51]
ds_read_b64_tr_b16 v[68:69], v102 offset:49152
ds_read_b64_tr_b16 v[70:71], v102 offset:51200
s_waitcnt lgkmcnt(6)
v_mfma_f32_16x16x32_bf16 v[52:55], v[92:95], a[156:159], v[52:55]
ds_read_b64_tr_b16 v[72:73], v103 offset:49152
ds_read_b64_tr_b16 v[74:75], v103 offset:51200
buffer_load_dwordx4 a[216:219], v230, s[4:7], s58 offen offset:0
s_waitcnt lgkmcnt(6)
v_mfma_f32_16x16x32_bf16 v[40:43], v[60:63], a[160:163], v[40:43]
ds_read_b64_tr_b16 v[80:81], v100 offset:53248
ds_read_b64_tr_b16 v[82:83], v100 offset:55296
s_waitcnt lgkmcnt(6)
v_mfma_f32_16x16x32_bf16 v[44:47], v[64:67], a[160:163], v[44:47]
ds_read_b64_tr_b16 v[84:85], v101 offset:53248
ds_read_b64_tr_b16 v[86:87], v101 offset:55296
s_waitcnt lgkmcnt(6)
v_mfma_f32_16x16x32_bf16 v[48:51], v[68:71], a[160:163], v[48:51]
ds_read_b64_tr_b16 v[88:89], v102 offset:53248
ds_read_b64_tr_b16 v[90:91], v102 offset:55296
s_waitcnt lgkmcnt(6)
v_mfma_f32_16x16x32_bf16 v[52:55], v[72:75], a[160:163], v[52:55]
ds_read_b64_tr_b16 v[92:93], v103 offset:53248
ds_read_b64_tr_b16 v[94:95], v103 offset:55296
buffer_load_dwordx4 a[220:223], v230, s[4:7], s58 offen offset:1024
s_waitcnt lgkmcnt(6)
v_mfma_f32_16x16x32_bf16 v[40:43], v[80:83], a[164:167], v[40:43]
s_waitcnt lgkmcnt(4)
v_mfma_f32_16x16x32_bf16 v[44:47], v[84:87], a[164:167], v[44:47]
s_waitcnt lgkmcnt(2)
v_mfma_f32_16x16x32_bf16 v[48:51], v[88:91], a[164:167], v[48:51]
s_waitcnt lgkmcnt(0)
v_mfma_f32_16x16x32_bf16 v[52:55], v[92:95], a[164:167], v[52:55]
buffer_load_dwordx4 a[224:227], v230, s[4:7], s58 offen offset:2048
v_mov_b32 v178, 0
s_mov_b64 exec, 1
buffer_atomic_or v178, v176, s[4:7], 0 offen sc0 sc1
s_mov_b64 exec, -1
s_lshl_b32 s28, s24, 2
s_add_u32 s28, s28, s20
s_lshl_b32 s28, s28, 11
v_lshlrev_b32 v159, 7, v3
v_add_u32 v159, s28, v159
v_bfe_u32 v160, v3, 1, 2
v_lshl_add_u32 v159, v160, 5, v159
v_lshl_add_u32 v159, v4, 3, v159
ds_read_b64 v[60:61], v159
v_xor_b32 v160, 32, v159
ds_read_b64 v[62:63], v160
v_xor_b32 v160, 64, v159
ds_read_b64 v[64:65], v160
v_xor_b32 v160, 96, v159
ds_read_b64 v[66:67], v160
v_lshlrev_b32 v159, 12, v4
v_lshl_add_u32 v159, v3, 2, v159
s_lshl_b32 s28, s20, 6
s_add_u32 s28, s28, 114688
v_add_u32 v159, s28, v159
s_waitcnt lgkmcnt(0)
v_lshlrev_b32 v68, 16, v60
v_fmac_f32 v68, v106, v40
ds_write_b32 v159, v68 offset:0
v_and_b32 v69, 0xffff0000, v60
v_fmac_f32 v69, v107, v41
v_xor_b32 v160, 16, v159
ds_write_b32 v160, v69 offset:256
buffer_load_dwordx4 a[228:231], v230, s[4:7], s58 offen offset:3072
s_add_u32 s58, s58, 4096
s_cmp_eq_u32 s58, s39
s_cselect_b32 s59, 4096, 0
s_add_u32 s58, s58, s59
v_lshlrev_b32 v70, 16, v61
v_fmac_f32 v70, v108, v42
v_xor_b32 v160, 32, v159
ds_write_b32 v160, v70 offset:512
v_and_b32 v71, 0xffff0000, v61
v_fmac_f32 v71, v109, v43
v_xor_b32 v160, 48, v159
ds_write_b32 v160, v71 offset:768
v_lshlrev_b32 v72, 16, v62
v_fmac_f32 v72, v110, v44
v_xor_b32 v160, 64, v159
ds_write_b32 v160, v72 offset:1024
v_and_b32 v73, 0xffff0000, v62
v_fmac_f32 v73, v111, v45
v_xor_b32 v160, 80, v159
ds_write_b32 v160, v73 offset:1280
buffer_load_dwordx4 a[232:235], v230, s[4:7], s58 offen offset:0
v_lshlrev_b32 v74, 16, v63
v_fmac_f32 v74, v112, v46
v_xor_b32 v160, 96, v159
ds_write_b32 v160, v74 offset:1536
v_and_b32 v75, 0xffff0000, v63
v_fmac_f32 v75, v113, v47
v_xor_b32 v160, 112, v159
ds_write_b32 v160, v75 offset:1792
v_lshlrev_b32 v76, 16, v64
v_fmac_f32 v76, v114, v48
v_xor_b32 v160, 128, v159
ds_write_b32 v160, v76 offset:2048
v_and_b32 v77, 0xffff0000, v64
v_fmac_f32 v77, v115, v49
v_xor_b32 v160, 144, v159
ds_write_b32 v160, v77 offset:2304
buffer_load_dwordx4 a[236:239], v230, s[4:7], s58 offen offset:1024
v_lshlrev_b32 v78, 16, v65
v_fmac_f32 v78, v116, v50
v_xor_b32 v160, 160, v159
ds_write_b32 v160, v78 offset:2560
v_and_b32 v79, 0xffff0000, v65
v_fmac_f32 v79, v117, v51
v_xor_b32 v160, 176, v159
ds_write_b32 v160, v79 offset:2816
v_lshlrev_b32 v80, 16, v66
v_fmac_f32 v80, v118, v52
v_xor_b32 v160, 192, v159
ds_write_b32 v160, v80 offset:3072
v_and_b32 v81, 0xffff0000, v66
v_fmac_f32 v81, v119, v53
v_xor_b32 v160, 208, v159
ds_write_b32 v160, v81 offset:3328
buffer_load_dwordx4 a[240:243], v230, s[4:7], s58 offen offset:2048
v_lshlrev_b32 v82, 16, v67
v_fmac_f32 v82, v120, v54
v_xor_b32 v160, 224, v159
ds_write_b32 v160, v82 offset:3584
v_and_b32 v83, 0xffff0000, v67
v_fmac_f32 v83, v121, v55
v_xor_b32 v160, 240, v159
ds_write_b32 v160, v83 offset:3840
v_lshlrev_b32 v160, 6, v3
v_lshl_add_u32 v160, v4, 4, v160
s_lshl_b32 s29, s24, 2
s_add_u32 s29, s29, s20
s_lshl_b32 s29, s29, 10
s_mul_i32 s30, s23, 114688
s_add_u32 s29, s29, s30
s_add_u32 s29, s29, 5242880
s_add_u32 s30, s29, 28672
s_add_u32 s31, s29, 57344
s_add_u32 s32, s29, 86016
s_mov_b32 s28, 0
s_waitcnt vmcnt(10)
lb_17:
v_max3_u32 v156, v138, v139, v140
v_max3_u32 v156, v156, v141, v142
v_max3_u32 v156, v156, v143, v144
v_max3_u32 v156, v156, v145, v146
v_max3_u32 v156, v156, v147, v148
v_max3_u32 v156, v156, v149, v150
v_max3_u32 v156, v156, v151, v152
v_max_u32 v156, v156, v153
v_cmp_eq_u32 vcc, -1, v156
s_cbranch_vccz lb_17_r
s_add_u32 s28, s28, 1
s_cmp_gt_u32 s28, 32768
s_cbranch_scc1 lb_17_r
buffer_load_dwordx2 v[138:139], v168, s[8:11], 0 offen sc1
buffer_load_dwordx2 v[140:141], v169, s[8:11], 0 offen sc1
buffer_load_dwordx2 v[142:143], v170, s[8:11], 0 offen sc1
buffer_load_dwordx2 v[144:145], v171, s[8:11], 0 offen sc1
buffer_load_dwordx2 v[146:147], v172, s[8:11], 0 offen sc1
buffer_load_dwordx2 v[148:149], v173, s[8:11], 0 offen sc1
buffer_load_dwordx2 v[150:151], v174, s[8:11], 0 offen sc1
buffer_load_dwordx2 v[152:153], v175, s[8:11], 0 offen sc1
s_waitcnt vmcnt(0)
s_branch lb_17
lb_17_r:
v_fmac_f32 v150, v226, v152
v_fmac_f32 v151, v226, v153
v_fma_f32 v150, -v227, v153, v150
v_fmac_f32 v151, v227, v152
v_fmac_f32 v148, v226, v150
v_fmac_f32 v149, v226, v151
v_fma_f32 v148, -v227, v151, v148
v_fmac_f32 v149, v227, v150
v_fmac_f32 v146, v226, v148
v_fmac_f32 v147, v226, v149
v_fma_f32 v146, -v227, v149, v146
v_fmac_f32 v147, v227, v148
v_fmac_f32 v144, v226, v146
v_fmac_f32 v145, v226, v147
v_fma_f32 v144, -v227, v147, v144
v_fmac_f32 v145, v227, v146
v_fmac_f32 v142, v226, v144
v_fmac_f32 v143, v226, v145
v_fma_f32 v142, -v227, v145, v142
v_fmac_f32 v143, v227, v144
v_fmac_f32 v140, v226, v142
v_fmac_f32 v141, v226, v143
v_fma_f32 v140, -v227, v143, v140
v_fmac_f32 v141, v227, v142
v_fmac_f32 v138, v226, v140
v_fmac_f32 v139, v226, v141
v_fma_f32 v138, -v227, v141, v138
v_fmac_f32 v139, v227, v140
v_mul_f32 v156, v224, v138
v_mul_f32 v157, v224, v139
v_fma_f32 v156, -v225, v139, v156
v_fmac_f32 v157, v225, v138
v_mov_b32 v158, v156
v_mov_b32 v159, v157
s_nop 0
v_permlane16_swap_b32 v156, v158
v_permlane16_swap_b32 v157, v159
v_add_f32 v156, v156, v158
v_add_f32 v157, v157, v159
v_mov_b32 v158, v156
v_mov_b32 v159, v157
s_nop 0
v_permlane32_swap_b32 v156, v158
v_permlane32_swap_b32 v157, v159
v_add_f32 v156, v156, v158
v_add_f32 v157, v157, v159
v_fmac_f32 v154, v222, v156
v_fmac_f32 v155, v222, v157
v_fma_f32 v154, -v223, v157, v154
v_fmac_f32 v155, v223, v156
s_mov_b32 s33, 0
s_mov_b64 exec, 1
s_waitcnt vmcnt(4)
chk_18:
v_cmp_gt_u32 vcc, v177, v178
s_add_u32 s33, s33, 1
s_cbranch_vccz chk_18_d
s_cmp_gt_u32 s33, 32768
s_cbranch_scc1 chk_18_d
v_mov_b32 v178, 0
buffer_atomic_or v178, v176, s[4:7], 0 offen sc0 sc1
s_waitcnt vmcnt(0)
s_branch chk_18
chk_18_d:
s_mov_b64 exec, -1
s_cmp_lg_u32 s20, 0
s_cbranch_scc1 hint_19
s_lshl_b32 s59, s23, 7
s_add_u32 s59, s59, 20578304
v_mov_b32 v7, 0
v_mov_b32 v2, 1
s_mov_b32 exec_lo, 1
s_mov_b32 exec_hi, 0
buffer_atomic_add v2, v7, s[4:7], s59 offen sc1
s_mov_b64 exec, -1
hint_19:
v_pk_fma_f32 v[8:9], v[190:191], v[154:155], v[8:9] op_sel_hi:[1,0,1]
v_pk_fma_f32 v[24:25], v[190:191], v[154:155], v[24:25] op_sel:[0,1,0] op_sel_hi:[1,1,1]
v_pk_fma_f32 v[10:11], v[192:193], v[154:155], v[10:11] op_sel_hi:[1,0,1]
v_pk_fma_f32 v[26:27], v[192:193], v[154:155], v[26:27] op_sel:[0,1,0] op_sel_hi:[1,1,1]
v_pk_fma_f32 v[12:13], v[194:195], v[154:155], v[12:13] op_sel_hi:[1,0,1]
v_pk_fma_f32 v[28:29], v[194:195], v[154:155], v[28:29] op_sel:[0,1,0] op_sel_hi:[1,1,1]
v_pk_fma_f32 v[14:15], v[196:197], v[154:155], v[14:15] op_sel_hi:[1,0,1]
v_pk_fma_f32 v[30:31], v[196:197], v[154:155], v[30:31] op_sel:[0,1,0] op_sel_hi:[1,1,1]
v_pk_fma_f32 v[8:9], v[206:207], v[154:155], v[8:9] op_sel:[0,1,0] op_sel_hi:[1,1,1] neg_lo:[1,0,0] neg_hi:[1,0,0]
v_pk_fma_f32 v[24:25], v[206:207], v[154:155], v[24:25] op_sel_hi:[1,0,1]
v_pk_fma_f32 v[10:11], v[208:209], v[154:155], v[10:11] op_sel:[0,1,0] op_sel_hi:[1,1,1] neg_lo:[1,0,0] neg_hi:[1,0,0]
v_pk_fma_f32 v[26:27], v[208:209], v[154:155], v[26:27] op_sel_hi:[1,0,1]
v_pk_fma_f32 v[12:13], v[210:211], v[154:155], v[12:13] op_sel:[0,1,0] op_sel_hi:[1,1,1] neg_lo:[1,0,0] neg_hi:[1,0,0]
v_pk_fma_f32 v[28:29], v[210:211], v[154:155], v[28:29] op_sel_hi:[1,0,1]
v_pk_fma_f32 v[14:15], v[212:213], v[154:155], v[14:15] op_sel:[0,1,0] op_sel_hi:[1,1,1] neg_lo:[1,0,0] neg_hi:[1,0,0]
v_pk_fma_f32 v[30:31], v[212:213], v[154:155], v[30:31] op_sel_hi:[1,0,1]
v_cvt_pk_bf16_f32 v60, v8, v9
v_cvt_pk_bf16_f32 v68, -v24, -v25
v_cvt_pk_bf16_f32 v61, v10, v11
v_cvt_pk_bf16_f32 v69, -v26, -v27
v_cvt_pk_bf16_f32 v62, v12, v13
v_cvt_pk_bf16_f32 v70, -v28, -v29
v_cvt_pk_bf16_f32 v63, v14, v15
v_cvt_pk_bf16_f32 v71, -v30, -v31
buffer_store_dwordx4 v[60:63], v160, s[4:7], s29 offen sc1
buffer_store_dwordx4 v[68:71], v160, s[4:7], s30 offen sc1
v_pk_fma_f32 v[16:17], v[198:199], v[154:155], v[16:17] op_sel_hi:[1,0,1]
v_pk_fma_f32 v[32:33], v[198:199], v[154:155], v[32:33] op_sel:[0,1,0] op_sel_hi:[1,1,1]
v_pk_fma_f32 v[18:19], v[200:201], v[154:155], v[18:19] op_sel_hi:[1,0,1]
v_pk_fma_f32 v[34:35], v[200:201], v[154:155], v[34:35] op_sel:[0,1,0] op_sel_hi:[1,1,1]
v_pk_fma_f32 v[20:21], v[202:203], v[154:155], v[20:21] op_sel_hi:[1,0,1]
v_pk_fma_f32 v[36:37], v[202:203], v[154:155], v[36:37] op_sel:[0,1,0] op_sel_hi:[1,1,1]
v_pk_fma_f32 v[22:23], v[204:205], v[154:155], v[22:23] op_sel_hi:[1,0,1]
v_pk_fma_f32 v[38:39], v[204:205], v[154:155], v[38:39] op_sel:[0,1,0] op_sel_hi:[1,1,1]
v_pk_fma_f32 v[16:17], v[214:215], v[154:155], v[16:17] op_sel:[0,1,0] op_sel_hi:[1,1,1] neg_lo:[1,0,0] neg_hi:[1,0,0]
v_pk_fma_f32 v[32:33], v[214:215], v[154:155], v[32:33] op_sel_hi:[1,0,1]
v_pk_fma_f32 v[18:19], v[216:217], v[154:155], v[18:19] op_sel:[0,1,0] op_sel_hi:[1,1,1] neg_lo:[1,0,0] neg_hi:[1,0,0]
v_pk_fma_f32 v[34:35], v[216:217], v[154:155], v[34:35] op_sel_hi:[1,0,1]
v_pk_fma_f32 v[20:21], v[218:219], v[154:155], v[20:21] op_sel:[0,1,0] op_sel_hi:[1,1,1] neg_lo:[1,0,0] neg_hi:[1,0,0]
v_pk_fma_f32 v[36:37], v[218:219], v[154:155], v[36:37] op_sel_hi:[1,0,1]
v_pk_fma_f32 v[22:23], v[220:221], v[154:155], v[22:23] op_sel:[0,1,0] op_sel_hi:[1,1,1] neg_lo:[1,0,0] neg_hi:[1,0,0]
v_pk_fma_f32 v[38:39], v[220:221], v[154:155], v[38:39] op_sel_hi:[1,0,1]
v_cvt_pk_bf16_f32 v64, v16, v17
v_cvt_pk_bf16_f32 v72, -v32, -v33
v_cvt_pk_bf16_f32 v65, v18, v19
v_cvt_pk_bf16_f32 v73, -v34, -v35
v_cvt_pk_bf16_f32 v66, v20, v21
v_cvt_pk_bf16_f32 v74, -v36, -v37
v_cvt_pk_bf16_f32 v67, v22, v23
v_cvt_pk_bf16_f32 v75, -v38, -v39
buffer_store_dwordx4 v[64:67], v160, s[4:7], s31 offen sc1
buffer_store_dwordx4 v[72:75], v160, s[4:7], s32 offen sc1
s_waitcnt lgkmcnt(0)
s_lshl_b32 s31, s23, 7
s_add_u32 s31, s31, 20578304
s_lshl_b32 s29, s20, 10
v_add_u32 v160, s29, v160
v_add_u32 v161, 57344, v160
s_barrier
ds_write_b128 v160, v[60:63]
ds_write_b128 v160, v[68:71] offset:28672
ds_write_b128 v161, v[64:67]
ds_write_b128 v161, v[72:75] offset:28672
buffer_load_dwordx4 a[244:247], v230, s[4:7], s58 offen offset:3072
s_add_u32 s58, s58, 4096
s_cmp_eq_u32 s58, s39
s_cselect_b32 s59, 4096, 0
s_add_u32 s58, s58, s59
buffer_load_dwordx4 a[248:251], v230, s[4:7], s58 offen offset:0
s_lshl_b32 s28, s20, 4
v_add_u32 v7, s28, v3
v_cvt_f32_u32 v160, v7
v_cvt_f32_u32 v163, v4
v_mul_f32 v162, 0x3c800000, v160
v_mul_f32 v161, 4.0, v163
v_mul_f32 v161, v161, v162
v_mul_f32 v164, 0x41500000, v162
v_cos_f32 v168, v161
v_sin_f32 v176, v161
v_add_f32 v161, v161, v162
v_cos_f32 v169, v161
v_sin_f32 v177, v161
v_add_f32 v161, v161, v162
v_cos_f32 v170, v161
v_sin_f32 v178, v161
v_add_f32 v161, v161, v162
v_cos_f32 v171, v161
v_sin_f32 v179, v161
v_add_f32 v161, v161, v164
v_cos_f32 v172, v161
v_sin_f32 v180, v161
v_add_f32 v161, v161, v162
v_cos_f32 v173, v161
v_sin_f32 v181, v161
v_add_f32 v161, v161, v162
v_cos_f32 v174, v161
v_sin_f32 v182, v161
v_add_f32 v161, v161, v162
v_cos_f32 v175, v161
v_sin_f32 v183, v161
v_and_b32 v7, 1, v7
v_lshlrev_b32 v7, 15, v7
v_lshl_or_b32 v7, v7, 16, v7
v_cvt_pk_bf16_f32 v80, v168, v169
v_cvt_pk_bf16_f32 v88, v176, v177
v_cvt_pk_bf16_f32 v81, v170, v171
v_cvt_pk_bf16_f32 v89, v178, v179
v_cvt_pk_bf16_f32 v82, v172, v173
v_cvt_pk_bf16_f32 v90, v180, v181
v_cvt_pk_bf16_f32 v83, v174, v175
v_cvt_pk_bf16_f32 v91, v182, v183
v_xor_b32 v84, v7, v80
v_xor_b32 v92, v7, v88
v_xor_b32 v85, v7, v81
v_xor_b32 v93, v7, v89
v_xor_b32 v86, v7, v82
v_xor_b32 v94, v7, v90
v_xor_b32 v87, v7, v83
v_xor_b32 v95, v7, v91
v_xor_b32 v96, 0x80008000, v88
v_xor_b32 v97, 0x80008000, v89
v_xor_b32 v98, 0x80008000, v90
v_xor_b32 v99, 0x80008000, v91
v_xor_b32 v100, 0x80008000, v92
v_xor_b32 v101, 0x80008000, v93
v_xor_b32 v102, 0x80008000, v94
v_xor_b32 v103, 0x80008000, v95
v_bfe_u32 v76, v1, 2, 2
v_lshrrev_b32 v77, 5, v1
v_lshl_add_u32 v72, v77, 2, v76
v_lshlrev_b32 v72, 6, v72
v_bfe_u32 v76, v1, 4, 1
v_lshl_add_u32 v72, v76, 5, v72
v_and_b32 v76, 3, v1
v_lshl_add_u32 v72, v76, 3, v72
s_mul_i32 s29, s21, 28672
v_add_u32 v72, s29, v72
v_add_u32 v73, 57344, v72
s_lshl_b32 s29, s20, 12
s_add_u32 s29, s29, 114688
s_xor_b32 s30, s29, 4096
v_add_u32 v74, s29, v231
v_add_u32 v75, s30, v231
s_lshl_b32 s29, s21, 1
s_lshl_b32 s30, s22, 3
s_add_u32 s29, s29, s30
v_add_u32 v77, s29, v77
v_and_b32 v76, 7, v1
v_xor_b32 v77, v77, v76
v_lshlrev_b32 v76, 8, v76
v_lshl_add_u32 v78, v77, 4, v76
v_bfe_u32 v76, v1, 3, 2
v_lshl_add_u32 v78, v76, 12, v78
v_add_u32 v78, 114688, v78
s_mul_i32 s38, s21, 57344
s_mul_i32 s29, s22, 28672
s_add_u32 s38, s38, s29
s_mul_i32 s29, s23, 114688
s_add_u32 s37, s38, s29
s_add_u32 s37, s37, 5242880
s_cmp_lg_u32 s20, 0
s_cbranch_scc1 pi_20
v_mov_b32 v5, s31
v_mov_b32 v6, 7
s_mov_b64 s[50:51], 1
s_and_b32 s28, s2, 15
s_lshl_b32 s28, s28, 7
s_add_u32 s28, s28, 20590592
v_writelane_b32 v5, s28, 1
v_writelane_b32 v6, 21, 1
s_add_u32 s28, s28, 4294963200
v_writelane_b32 v5, s28, 2
v_writelane_b32 v6, 11, 2
s_mov_b64 s[50:51], 7
v_mov_b32 v2, 0
s_mov_b64 exec, s[50:51]
buffer_atomic_or v2, v5, s[4:7], 0 offen sc0 sc1
s_mov_b64 exec, -1
pi_20:
s_waitcnt lgkmcnt(0)
s_barrier
ds_read_b128 v[144:147], v78 offset:0
v_xor_b32 v76, 64, v78
ds_read_b128 v[148:151], v76 offset:0
v_xor_b32 v76, 128, v78
ds_read_b128 v[152:155], v76 offset:2048
v_xor_b32 v76, 192, v78
ds_read_b128 v[156:159], v76 offset:2048
ds_read_b64_tr_b16 v[40:41], v72 offset:0
ds_read_b64_tr_b16 v[42:43], v72 offset:512
ds_read_b64_tr_b16 v[44:45], v73 offset:0
ds_read_b64_tr_b16 v[46:47], v73 offset:512
ds_read_b64_tr_b16 v[48:49], v72 offset:1024
ds_read_b64_tr_b16 v[50:51], v72 offset:1536
ds_read_b64_tr_b16 v[52:53], v73 offset:1024
ds_read_b64_tr_b16 v[54:55], v73 offset:1536
s_waitcnt lgkmcnt(6)
v_mfma_f32_32x32x16_bf16 v[8:23], a[168:171], v[40:43], 0
ds_read_b64_tr_b16 v[56:57], v72 offset:2048
ds_read_b64_tr_b16 v[58:59], v72 offset:2560
s_waitcnt lgkmcnt(6)
v_mfma_f32_32x32x16_bf16 v[24:39], a[168:171], v[44:47], 0
ds_read_b64_tr_b16 v[60:61], v73 offset:2048
ds_read_b64_tr_b16 v[62:63], v73 offset:2560
s_waitcnt lgkmcnt(6)
v_mfma_f32_32x32x16_bf16 v[8:23], a[172:175], v[48:51], v[8:23]
ds_read_b64_tr_b16 v[64:65], v72 offset:3072
ds_read_b64_tr_b16 v[66:67], v72 offset:3584
s_waitcnt lgkmcnt(6)
v_mfma_f32_32x32x16_bf16 v[24:39], a[172:175], v[52:55], v[24:39]
ds_read_b64_tr_b16 v[68:69], v73 offset:3072
ds_read_b64_tr_b16 v[70:71], v73 offset:3584
s_waitcnt lgkmcnt(6)
v_mfma_f32_32x32x16_bf16 v[8:23], a[176:179], v[56:59], v[8:23]
s_waitcnt lgkmcnt(4)
v_mfma_f32_32x32x16_bf16 v[24:39], a[176:179], v[60:63], v[24:39]
s_waitcnt lgkmcnt(2)
v_mfma_f32_32x32x16_bf16 v[8:23], a[180:183], v[64:67], v[8:23]
s_waitcnt lgkmcnt(0)
v_mfma_f32_32x32x16_bf16 v[24:39], a[180:183], v[68:71], v[24:39]
buffer_load_dwordx4 a[252:255], v230, s[4:7], s58 offen offset:1024
buffer_load_dwordx4 v[232:235], v230, s[4:7], s58 offen offset:2048
buffer_load_dwordx4 v[236:239], v230, s[4:7], s58 offen offset:3072
s_add_u32 s58, s58, 4096
s_cmp_eq_u32 s58, s39
s_cselect_b32 s59, 4096, 0
s_add_u32 s58, s58, s59
buffer_load_dwordx4 v[240:243], v230, s[4:7], s58 offen offset:0
buffer_load_dwordx4 v[244:247], v230, s[4:7], s58 offen offset:1024
buffer_load_dwordx4 v[248:251], v230, s[4:7], s58 offen offset:2048
buffer_load_dwordx4 v[252:255], v230, s[4:7], s58 offen offset:3072
s_cmp_lg_u32 s20, 0
s_cbranch_scc1 poll_21_d
s_mov_b32 s28, 0
s_mov_b64 exec, s[50:51]
s_waitcnt vmcnt(7)
poll_21:
v_cmp_gt_u32 vcc, v6, v2
s_add_u32 s28, s28, 1
s_and_b64 exec, vcc, vcc
s_cbranch_scc0 poll_21_d
s_cmp_gt_u32 s28, 32768
s_cbranch_scc1 poll_21_d
v_mov_b32 v2, 0
buffer_atomic_or v2, v5, s[4:7], 0 offen sc0 sc1
s_waitcnt vmcnt(0)
s_branch poll_21
poll_21_d:
s_mov_b64 exec, -1
s_barrier
s_add_u32 s27, s27, 389120
s_mov_b32 s34, s27
PJ_dma0:
s_lshl_b32 s33, s24, 12
s_add_u32 s33, s33, s37
s_lshl_b32 s59, s24, 12
s_sub_u32 s32, s33, s59
s_cmp_eq_u32 s32, s33
s_cselect_b32 s59, 4096, 0
s_add_u32 s32, s32, s59
s_add_u32 m0, s38, 4096
s_mov_b32 s27, s34
buffer_load_dwordx4 v231, s[4:7], s32 offen offset:0 sc1 lds
buffer_load_dwordx4 v231, s[4:7], s32 offen offset:1024 sc1 lds
buffer_load_dwordx4 v231, s[4:7], s32 offen offset:2048 sc1 lds
buffer_load_dwordx4 v231, s[4:7], s32 offen offset:3072 sc1 lds
s_add_u32 m0, m0, 4096
s_add_u32 s32, s32, 4096
s_cmp_eq_u32 s32, s33
s_cselect_b32 s59, 4096, 0
s_add_u32 s32, s32, s59
buffer_load_dwordx4 v231, s[4:7], s32 offen offset:0 sc1 lds
buffer_load_dwordx4 v231, s[4:7], s32 offen offset:1024 sc1 lds
buffer_load_dwordx4 v231, s[4:7], s32 offen offset:2048 sc1 lds
buffer_load_dwordx4 v231, s[4:7], s32 offen offset:3072 sc1 lds
s_add_u32 m0, m0, 4096
s_add_u32 s32, s32, 4096
s_cmp_eq_u32 s32, s33
s_cselect_b32 s59, 4096, 0
s_add_u32 s32, s32, s59
buffer_load_dwordx4 v231, s[4:7], s32 offen offset:0 sc1 lds
buffer_load_dwordx4 v231, s[4:7], s32 offen offset:1024 sc1 lds
buffer_load_dwordx4 v231, s[4:7], s32 offen offset:2048 sc1 lds
buffer_load_dwordx4 v231, s[4:7], s32 offen offset:3072 sc1 lds
s_add_u32 m0, m0, 4096
s_add_u32 s32, s32, 4096
s_cmp_eq_u32 s32, s33
s_cselect_b32 s59, 4096, 0
s_add_u32 s32, s32, s59
buffer_load_dwordx4 v231, s[4:7], s32 offen offset:0 sc1 lds
v_lshrrev_b32 v7, 2, v3
v_lshlrev_b32 v7, 3, v7
v_and_or_b32 v7, v3, 3, v7
v_add_u32 v7, 0, v7
v_cvt_f32_u32 v162, v7
v_mul_f32 v162, 0x3d000000, v162
v_mul_f32 v161, 0x41000000, v163
v_mul_f32 v161, v161, v162
v_cos_f32 v168, v161
v_sin_f32 v176, v161
v_add_f32 v161, v161, v162
v_cos_f32 v169, v161
v_sin_f32 v177, v161
v_add_f32 v161, v161, v162
v_cos_f32 v170, v161
v_sin_f32 v178, v161
v_add_f32 v161, v161, v162
v_cos_f32 v171, v161
v_sin_f32 v179, v161
v_add_f32 v161, v161, v162
v_cos_f32 v172, v161
v_sin_f32 v180, v161
v_add_f32 v161, v161, v162
v_cos_f32 v173, v161
v_sin_f32 v181, v161
v_add_f32 v161, v161, v162
v_cos_f32 v174, v161
v_sin_f32 v182, v161
v_add_f32 v161, v161, v162
v_cos_f32 v175, v161
v_sin_f32 v183, v161
v_cvt_pk_bf16_f32 v104, v168, v169
v_cvt_pk_bf16_f32 v112, v176, v177
v_cvt_pk_bf16_f32 v105, v170, v171
v_cvt_pk_bf16_f32 v113, v178, v179
v_cvt_pk_bf16_f32 v106, v172, v173
v_cvt_pk_bf16_f32 v114, v180, v181
v_cvt_pk_bf16_f32 v107, v174, v175
v_cvt_pk_bf16_f32 v115, v182, v183
v_lshrrev_b32 v7, 2, v3
v_lshlrev_b32 v7, 3, v7
v_and_or_b32 v7, v3, 3, v7
v_add_u32 v7, 4, v7
v_cvt_f32_u32 v162, v7
v_mul_f32 v162, 0x3d000000, v162
v_mul_f32 v161, 0x41000000, v163
v_mul_f32 v161, v161, v162
v_cos_f32 v168, v161
v_sin_f32 v176, v161
v_add_f32 v161, v161, v162
v_cos_f32 v169, v161
v_sin_f32 v177, v161
v_add_f32 v161, v161, v162
v_cos_f32 v170, v161
v_sin_f32 v178, v161
v_add_f32 v161, v161, v162
v_cos_f32 v171, v161
v_sin_f32 v179, v161
v_add_f32 v161, v161, v162
v_cos_f32 v172, v161
v_sin_f32 v180, v161
v_add_f32 v161, v161, v162
v_cos_f32 v173, v161
v_sin_f32 v181, v161
v_add_f32 v161, v161, v162
v_cos_f32 v174, v161
v_sin_f32 v182, v161
v_add_f32 v161, v161, v162
v_cos_f32 v175, v161
v_sin_f32 v183, v161
v_cvt_pk_bf16_f32 v108, v168, v169
v_cvt_pk_bf16_f32 v116, v176, v177
v_cvt_pk_bf16_f32 v109, v170, v171
v_cvt_pk_bf16_f32 v117, v178, v179
v_cvt_pk_bf16_f32 v110, v172, v173
s_waitcnt vmcnt(9)
s_barrier
ds_read_b64_tr_b16 v[40:41], v72 offset:4096
ds_read_b64_tr_b16 v[42:43], v72 offset:4608
ds_read_b64_tr_b16 v[44:45], v73 offset:4096
ds_read_b64_tr_b16 v[46:47], v73 offset:4608
ds_read_b64_tr_b16 v[48:49], v72 offset:5120
ds_read_b64_tr_b16 v[50:51], v72 offset:5632
ds_read_b64_tr_b16 v[52:53], v73 offset:5120
ds_read_b64_tr_b16 v[54:55], v73 offset:5632
s_waitcnt lgkmcnt(6)
v_mfma_f32_32x32x16_bf16 v[8:23], a[184:187], v[40:43], v[8:23]
ds_read_b64_tr_b16 v[56:57], v72 offset:6144
ds_read_b64_tr_b16 v[58:59], v72 offset:6656
buffer_load_dwordx4 v231, s[4:7], s32 offen offset:1024 sc1 lds
v_cvt_pk_bf16_f32 v118, v180, v181
v_cvt_pk_bf16_f32 v111, v174, v175
s_waitcnt lgkmcnt(6)
v_mfma_f32_32x32x16_bf16 v[24:39], a[184:187], v[44:47], v[24:39]
ds_read_b64_tr_b16 v[60:61], v73 offset:6144
ds_read_b64_tr_b16 v[62:63], v73 offset:6656
v_cvt_pk_bf16_f32 v119, v182, v183
v_xor_b32 v120, 0x80008000, v112
s_waitcnt lgkmcnt(6)
v_mfma_f32_32x32x16_bf16 v[8:23], a[188:191], v[48:51], v[8:23]
ds_read_b64_tr_b16 v[64:65], v72 offset:7168
ds_read_b64_tr_b16 v[66:67], v72 offset:7680
buffer_load_dwordx4 v231, s[4:7], s32 offen offset:2048 sc1 lds
v_xor_b32 v121, 0x80008000, v113
v_xor_b32 v122, 0x80008000, v114
s_waitcnt lgkmcnt(6)
v_mfma_f32_32x32x16_bf16 v[24:39], a[188:191], v[52:55], v[24:39]
ds_read_b64_tr_b16 v[68:69], v73 offset:7168
ds_read_b64_tr_b16 v[70:71], v73 offset:7680
v_xor_b32 v123, 0x80008000, v115
v_xor_b32 v124, 0x80008000, v116
s_waitcnt vmcnt(7)
s_barrier
s_waitcnt lgkmcnt(6)
v_mfma_f32_32x32x16_bf16 v[8:23], a[192:195], v[56:59], v[8:23]
ds_read_b64_tr_b16 v[40:41], v72 offset:8192
ds_read_b64_tr_b16 v[42:43], v72 offset:8704
buffer_load_dwordx4 v231, s[4:7], s32 offen offset:3072 sc1 lds
s_add_u32 m0, m0, 4096
s_add_u32 s32, s32, 4096
s_cmp_eq_u32 s32, s33
s_cselect_b32 s59, 4096, 0
s_add_u32 s32, s32, s59
v_xor_b32 v125, 0x80008000, v117
v_xor_b32 v126, 0x80008000, v118
s_waitcnt lgkmcnt(6)
v_mfma_f32_32x32x16_bf16 v[24:39], a[192:195], v[60:63], v[24:39]
ds_read_b64_tr_b16 v[44:45], v73 offset:8192
ds_read_b64_tr_b16 v[46:47], v73 offset:8704
v_xor_b32 v127, 0x80008000, v119
v_mul_f32 v162, 0x3a000000, v160
s_waitcnt lgkmcnt(6)
v_mfma_f32_32x32x16_bf16 v[8:23], a[196:199], v[64:67], v[8:23]
ds_read_b64_tr_b16 v[48:49], v72 offset:9216
ds_read_b64_tr_b16 v[50:51], v72 offset:9728
buffer_load_dwordx4 v231, s[4:7], s32 offen offset:0 sc1 lds
v_mul_f32 v161, 0x41000000, v163
v_mul_f32 v161, v161, v162
s_waitcnt lgkmcnt(6)
v_mfma_f32_32x32x16_bf16 v[24:39], a[196:199], v[68:71], v[24:39]
ds_read_b64_tr_b16 v[52:53], v73 offset:9216
ds_read_b64_tr_b16 v[54:55], v73 offset:9728
v_cos_f32 v128, v161
v_sin_f32 v136, v161
s_waitcnt lgkmcnt(6)
v_mfma_f32_32x32x16_bf16 v[8:23], a[200:203], v[40:43], v[8:23]
ds_read_b64_tr_b16 v[56:57], v72 offset:10240
ds_read_b64_tr_b16 v[58:59], v72 offset:10752
buffer_load_dwordx4 v231, s[4:7], s32 offen offset:1024 sc1 lds
v_add_f32 v161, v161, v162
v_cos_f32 v129, v161
s_waitcnt lgkmcnt(6)
v_mfma_f32_32x32x16_bf16 v[24:39], a[200:203], v[44:47], v[24:39]
ds_read_b64_tr_b16 v[60:61], v73 offset:10240
ds_read_b64_tr_b16 v[62:63], v73 offset:10752
v_sin_f32 v137, v161
v_add_f32 v161, v161, v162
s_waitcnt lgkmcnt(6)
v_mfma_f32_32x32x16_bf16 v[8:23], a[204:207], v[48:51], v[8:23]
ds_read_b64_tr_b16 v[64:65], v72 offset:11264
ds_read_b64_tr_b16 v[66:67], v72 offset:11776
buffer_load_dwordx4 v231, s[4:7], s32 offen offset:2048 sc1 lds
v_cos_f32 v130, v161
v_sin_f32 v138, v161
s_waitcnt lgkmcnt(6)
v_mfma_f32_32x32x16_bf16 v[24:39], a[204:207], v[52:55], v[24:39]
ds_read_b64_tr_b16 v[68:69], v73 offset:11264
ds_read_b64_tr_b16 v[70:71], v73 offset:11776
v_add_f32 v161, v161, v162
v_cos_f32 v131, v161
s_waitcnt vmcnt(7)
s_barrier
s_waitcnt lgkmcnt(6)
v_mfma_f32_32x32x16_bf16 v[8:23], a[208:211], v[56:59], v[8:23]
ds_read_b64_tr_b16 v[40:41], v72 offset:12288
ds_read_b64_tr_b16 v[42:43], v72 offset:12800
buffer_load_dwordx4 v231, s[4:7], s32 offen offset:3072 sc1 lds
s_add_u32 m0, m0, 4096
s_add_u32 s32, s32, 4096
s_cmp_eq_u32 s32, s33
s_cselect_b32 s59, 4096, 0
s_add_u32 s32, s32, s59
v_sin_f32 v139, v161
v_add_f32 v161, v161, v162
s_waitcnt lgkmcnt(6)
v_mfma_f32_32x32x16_bf16 v[24:39], a[208:211], v[60:63], v[24:39]
ds_read_b64_tr_b16 v[44:45], v73 offset:12288
ds_read_b64_tr_b16 v[46:47], v73 offset:12800
v_cos_f32 v132, v161
v_sin_f32 v140, v161
s_waitcnt lgkmcnt(6)
v_mfma_f32_32x32x16_bf16 v[8:23], a[212:215], v[64:67], v[8:23]
ds_read_b64_tr_b16 v[48:49], v72 offset:13312
ds_read_b64_tr_b16 v[50:51], v72 offset:13824
buffer_load_dwordx4 v231, s[4:7], s32 offen offset:0 sc1 lds
v_add_f32 v161, v161, v162
v_cos_f32 v133, v161
s_waitcnt lgkmcnt(6)
v_mfma_f32_32x32x16_bf16 v[24:39], a[212:215], v[68:71], v[24:39]
ds_read_b64_tr_b16 v[52:53], v73 offset:13312
ds_read_b64_tr_b16 v[54:55], v73 offset:13824
v_sin_f32 v141, v161
v_add_f32 v161, v161, v162
s_waitcnt lgkmcnt(6)
v_mfma_f32_32x32x16_bf16 v[8:23], a[216:219], v[40:43], v[8:23]
ds_read_b64_tr_b16 v[56:57], v72 offset:14336
ds_read_b64_tr_b16 v[58:59], v72 offset:14848
buffer_load_dwordx4 v231, s[4:7], s32 offen offset:1024 sc1 lds
v_cos_f32 v134, v161
v_sin_f32 v142, v161
s_waitcnt lgkmcnt(6)
v_mfma_f32_32x32x16_bf16 v[24:39], a[216:219], v[44:47], v[24:39]
ds_read_b64_tr_b16 v[60:61], v73 offset:14336
ds_read_b64_tr_b16 v[62:63], v73 offset:14848
v_add_f32 v161, v161, v162
v_cos_f32 v135, v161
s_waitcnt lgkmcnt(6)
v_mfma_f32_32x32x16_bf16 v[8:23], a[220:223], v[48:51], v[8:23]
ds_read_b64_tr_b16 v[64:65], v72 offset:15360
ds_read_b64_tr_b16 v[66:67], v72 offset:15872
buffer_load_dwordx4 v231, s[4:7], s32 offen offset:2048 sc1 lds
v_sin_f32 v143, v161
v_bfe_u32 v162, v3, 1, 2
s_waitcnt lgkmcnt(6)
v_mfma_f32_32x32x16_bf16 v[24:39], a[220:223], v[52:55], v[24:39]
ds_read_b64_tr_b16 v[68:69], v73 offset:15360
ds_read_b64_tr_b16 v[70:71], v73 offset:15872
s_lshl_b32 s28, s20, 10
s_add_u32 s28, s28, 131072
s_waitcnt vmcnt(7)
s_barrier
s_waitcnt lgkmcnt(6)
v_mfma_f32_32x32x16_bf16 v[8:23], a[224:227], v[56:59], v[8:23]
ds_read_b64_tr_b16 v[40:41], v72 offset:16384
ds_read_b64_tr_b16 v[42:43], v72 offset:16896
buffer_load_dwordx4 v231, s[4:7], s32 offen offset:3072 sc1 lds
v_lshlrev_b32 v165, 6, v3
v_add_u32 v165, s28, v165
s_waitcnt lgkmcnt(6)
v_mfma_f32_32x32x16_bf16 v[24:39], a[224:227], v[60:63], v[24:39]
ds_read_b64_tr_b16 v[44:45], v73 offset:16384
ds_read_b64_tr_b16 v[46:47], v73 offset:16896
v_xor_b32 v186, v4, v162
v_lshl_add_u32 v186, v186, 4, v165
s_waitcnt lgkmcnt(6)
v_mfma_f32_32x32x16_bf16 v[8:23], a[228:231], v[64:67], v[8:23]
ds_read_b64_tr_b16 v[48:49], v72 offset:17408
ds_read_b64_tr_b16 v[50:51], v72 offset:17920
buffer_load_dwordx4 a[112:115], v231, s[4:7], s27 offen offset:0
v_and_b32 v184, 1, v4
v_lshlrev_b32 v184, 1, v184
s_waitcnt lgkmcnt(6)
v_mfma_f32_32x32x16_bf16 v[24:39], a[228:231], v[68:71], v[24:39]
ds_read_b64_tr_b16 v[52:53], v73 offset:17408
ds_read_b64_tr_b16 v[54:55], v73 offset:17920
v_xor_b32 v184, v184, v162
v_lshl_add_u32 v184, v184, 4, v165
s_waitcnt lgkmcnt(6)
v_mfma_f32_32x32x16_bf16 v[8:23], a[232:235], v[40:43], v[8:23]
ds_read_b64_tr_b16 v[56:57], v72 offset:18432
ds_read_b64_tr_b16 v[58:59], v72 offset:18944
buffer_load_dwordx4 a[116:119], v231, s[4:7], s27 offen offset:1024
v_lshrrev_b32 v162, 1, v4
v_lshl_add_u32 v184, v162, 3, v184
s_waitcnt lgkmcnt(6)
v_mfma_f32_32x32x16_bf16 v[24:39], a[232:235], v[44:47], v[24:39]
ds_read_b64_tr_b16 v[60:61], v73 offset:18432
ds_read_b64_tr_b16 v[62:63], v73 offset:18944
v_xor_b32 v185, 16, v184
v_lshrrev_b32 v162, 2, v1
s_waitcnt lgkmcnt(6)
v_mfma_f32_32x32x16_bf16 v[8:23], a[236:239], v[48:51], v[8:23]
ds_read_b64_tr_b16 v[64:65], v72 offset:19456
ds_read_b64_tr_b16 v[66:67], v72 offset:19968
buffer_load_dwordx4 a[120:123], v231, s[4:7], s27 offen offset:2048
v_lshlrev_b32 v187, 6, v162
v_bfe_u32 v162, v1, 3, 2
s_waitcnt lgkmcnt(6)
v_mfma_f32_32x32x16_bf16 v[24:39], a[236:239], v[52:55], v[24:39]
ds_read_b64_tr_b16 v[68:69], v73 offset:19456
ds_read_b64_tr_b16 v[70:71], v73 offset:19968
v_bfe_u32 v165, v1, 1, 1
v_xor_b32 v162, v162, v165
s_waitcnt vmcnt(7)
s_barrier
s_waitcnt lgkmcnt(6)
v_mfma_f32_32x32x16_bf16 v[8:23], a[240:243], v[56:59], v[8:23]
ds_read_b64_tr_b16 v[40:41], v72 offset:20480
ds_read_b64_tr_b16 v[42:43], v72 offset:20992
buffer_load_dwordx4 a[124:127], v231, s[4:7], s27 offen offset:3072
s_add_u32 s27, s27, 4096
v_lshl_add_u32 v187, v162, 4, v187
v_and_b32 v162, 1, v1
s_waitcnt lgkmcnt(6)
v_mfma_f32_32x32x16_bf16 v[24:39], a[240:243], v[60:63], v[24:39]
ds_read_b64_tr_b16 v[44:45], v73 offset:20480
ds_read_b64_tr_b16 v[46:47], v73 offset:20992
v_lshl_add_u32 v187, v162, 3, v187
v_add_u32 v187, 131072, v187
s_waitcnt lgkmcnt(6)
v_mfma_f32_32x32x16_bf16 v[8:23], a[244:247], v[64:67], v[8:23]
ds_read_b64_tr_b16 v[48:49], v72 offset:21504
ds_read_b64_tr_b16 v[50:51], v72 offset:22016
buffer_load_dwordx4 a[128:131], v231, s[4:7], s27 offen offset:0
v_xor_b32 v188, 32, v187
v_lshrrev_b32 v162, 1, v3
s_waitcnt lgkmcnt(6)
v_mfma_f32_32x32x16_bf16 v[24:39], a[244:247], v[68:71], v[24:39]
ds_read_b64_tr_b16 v[52:53], v73 offset:21504
ds_read_b64_tr_b16 v[54:55], v73 offset:22016
v_mul_u32_u24 v162, 57344, v162
v_and_b32 v165, 1, v3
s_waitcnt lgkmcnt(6)
v_mfma_f32_32x32x16_bf16 v[8:23], a[248:251], v[40:43], v[8:23]
ds_read_b64_tr_b16 v[56:57], v72 offset:22528
ds_read_b64_tr_b16 v[58:59], v72 offset:23040
buffer_load_dwordx4 a[132:135], v231, s[4:7], s27 offen offset:1024
v_lshl_add_u32 v165, v4, 1, v165
s_and_b32 s28, s2, 3
s_waitcnt lgkmcnt(6)
v_mfma_f32_32x32x16_bf16 v[24:39], a[248:251], v[44:47], v[24:39]
ds_read_b64_tr_b16 v[60:61], v73 offset:22528
ds_read_b64_tr_b16 v[62:63], v73 offset:23040
s_lshl_b32 s28, s28, 1
v_xor_b32 v165, s28, v165
s_waitcnt lgkmcnt(6)
v_mfma_f32_32x32x16_bf16 v[8:23], a[252:255], v[48:51], v[8:23]
ds_read_b64_tr_b16 v[64:65], v72 offset:23552
ds_read_b64_tr_b16 v[66:67], v72 offset:24064
buffer_load_dwordx4 a[136:139], v231, s[4:7], s27 offen offset:2048
v_lshl_add_u32 v189, v165, 4, v162
v_and_b32 v78, 7, v1
s_waitcnt lgkmcnt(6)
v_mfma_f32_32x32x16_bf16 v[24:39], a[252:255], v[52:55], v[24:39]
ds_read_b64_tr_b16 v[68:69], v73 offset:23552
ds_read_b64_tr_b16 v[70:71], v73 offset:24064
v_bfe_u32 v6, v1, 3, 2
v_lshl_add_u32 v78, v6, 4, v78
s_waitcnt vmcnt(7)
s_barrier
s_waitcnt lgkmcnt(6)
v_mfma_f32_32x32x16_bf16 v[8:23], v[232:235], v[56:59], v[8:23]
ds_read_b64_tr_b16 v[40:41], v72 offset:24576
ds_read_b64_tr_b16 v[42:43], v72 offset:25088
buffer_load_dwordx4 a[140:143], v231, s[4:7], s27 offen offset:3072
s_add_u32 s27, s27, 4096
v_lshlrev_b32 v78, 2, v78
v_lshrrev_b32 v6, 5, v1
s_waitcnt lgkmcnt(6)
v_mfma_f32_32x32x16_bf16 v[24:39], v[232:235], v[60:63], v[24:39]
ds_read_b64_tr_b16 v[44:45], v73 offset:24576
ds_read_b64_tr_b16 v[46:47], v73 offset:25088
v_lshl_add_u32 v79, v6, 9, v78
v_lshl_add_u32 v78, v6, 5, v78
s_waitcnt lgkmcnt(6)
v_mfma_f32_32x32x16_bf16 v[8:23], v[236:239], v[64:67], v[8:23]
ds_read_b64_tr_b16 v[48:49], v72 offset:25600
ds_read_b64_tr_b16 v[50:51], v72 offset:26112
buffer_load_dwordx4 a[144:147], v231, s[4:7], s27 offen offset:0
s_lshl_b32 s28, s22, 12
s_lshl_b32 s29, s21, 10
s_waitcnt lgkmcnt(6)
v_mfma_f32_32x32x16_bf16 v[24:39], v[236:239], v[68:71], v[24:39]
ds_read_b64_tr_b16 v[52:53], v73 offset:25600
ds_read_b64_tr_b16 v[54:55], v73 offset:26112
s_add_u32 s28, s28, s29
v_add_u32 v79, s28, v79
s_waitcnt lgkmcnt(6)
v_mfma_f32_32x32x16_bf16 v[8:23], v[240:243], v[40:43], v[8:23]
ds_read_b64_tr_b16 v[56:57], v72 offset:26624
ds_read_b64_tr_b16 v[58:59], v72 offset:27136
buffer_load_dwordx4 a[148:151], v231, s[4:7], s27 offen offset:1024
s_lshl_b32 s28, s20, 8
v_add_u32 v78, s28, v78
s_waitcnt lgkmcnt(6)
v_mfma_f32_32x32x16_bf16 v[24:39], v[240:243], v[44:47], v[24:39]
ds_read_b64_tr_b16 v[60:61], v73 offset:26624
ds_read_b64_tr_b16 v[62:63], v73 offset:27136
v_lshlrev_b32 v5, 13, v4
v_lshl_add_u32 v5, v3, 4, v5
s_waitcnt lgkmcnt(6)
v_mfma_f32_32x32x16_bf16 v[8:23], v[244:247], v[48:51], v[8:23]
ds_read_b64_tr_b16 v[64:65], v72 offset:27648
ds_read_b64_tr_b16 v[66:67], v72 offset:28160
buffer_load_dwordx4 a[152:155], v231, s[4:7], s27 offen offset:2048
s_lshl_b32 s28, s20, 11
v_add_u32 v6, s28, v231
s_waitcnt lgkmcnt(6)
v_mfma_f32_32x32x16_bf16 v[24:39], v[244:247], v[52:55], v[24:39]
ds_read_b64_tr_b16 v[68:69], v73 offset:27648
ds_read_b64_tr_b16 v[70:71], v73 offset:28160
s_lshl_b32 s28, s24, 2
s_add_u32 s28, s28, s20
s_waitcnt lgkmcnt(6)
v_mfma_f32_32x32x16_bf16 v[8:23], v[248:251], v[56:59], v[8:23]
buffer_load_dwordx4 a[156:159], v231, s[4:7], s27 offen offset:3072
s_add_u32 s27, s27, 4096
s_lshl_b32 s28, s28, 16
s_lshl_b32 s29, s23, 8
s_waitcnt lgkmcnt(4)
v_mfma_f32_32x32x16_bf16 v[24:39], v[248:251], v[60:63], v[24:39]
s_add_u32 s28, s28, s29
s_add_u32 s28, s28, 9437184
s_waitcnt lgkmcnt(2)
v_mfma_f32_32x32x16_bf16 v[8:23], v[252:255], v[64:67], v[8:23]
buffer_load_dwordx4 a[160:163], v231, s[4:7], s27 offen offset:0
s_add_u32 s30, s28, 32768
s_add_u32 s29, s29, 20619264
s_waitcnt lgkmcnt(0)
v_mfma_f32_32x32x16_bf16 v[24:39], v[252:255], v[68:71], v[24:39]
buffer_load_dwordx4 a[164:167], v231, s[4:7], s27 offen offset:1024
s_nop 5
ds_write_b128 v74, v[12:15] offset:0
ds_write_b128 v74, v[20:23] offset:1024
s_nop 2
ds_write_b128 v74, v[28:31] offset:2048
ds_write_b128 v74, v[36:39] offset:3072
s_waitcnt lgkmcnt(0)
s_barrier
ds_read_b128 v[40:43], v75 offset:0
ds_read_b128 v[44:47], v75 offset:1024
ds_read_b128 v[48:51], v75 offset:2048
ds_read_b128 v[52:55], v75 offset:3072
s_waitcnt lgkmcnt(3)
v_pk_add_f32 v[8:9], v[8:9], v[40:41]
v_pk_add_f32 v[10:11], v[10:11], v[42:43]
s_waitcnt lgkmcnt(2)
v_pk_add_f32 v[16:17], v[16:17], v[44:45]
v_pk_add_f32 v[18:19], v[18:19], v[46:47]
s_waitcnt lgkmcnt(1)
v_pk_add_f32 v[24:25], v[24:25], v[48:49]
v_pk_add_f32 v[26:27], v[26:27], v[50:51]
s_waitcnt lgkmcnt(0)
v_pk_add_f32 v[32:33], v[32:33], v[52:53]
v_pk_add_f32 v[34:35], v[34:35], v[54:55]
v_cmp_u_f32 vcc, v8, v24
s_cbranch_vccz ok_22
s_add_u32 s36, s36, 1
s_cmp_gt_u32 s36, 256
s_cbranch_scc1 ok_22
s_waitcnt vmcnt(0) lgkmcnt(0)
s_barrier
s_branch PJ_redo0
ok_22:
v_pk_add_f32 v[8:9], v[8:9], v[144:145]
v_pk_add_f32 v[10:11], v[10:11], v[146:147]
v_pk_add_f32 v[16:17], v[16:17], v[148:149]
v_pk_add_f32 v[18:19], v[18:19], v[150:151]
v_pk_add_f32 v[24:25], v[24:25], v[152:153]
v_pk_add_f32 v[26:27], v[26:27], v[154:155]
v_pk_add_f32 v[32:33], v[32:33], v[156:157]
v_pk_add_f32 v[34:35], v[34:35], v[158:159]
s_cmp_lg_u32 s20, 0
s_cbranch_scc1 hint_23
s_and_b32 s59, s2, 15
s_lshl_b32 s59, s59, 7
s_add_u32 s59, s59, 20512768
v_mul_u32_u24 v7, 2048, v1
v_mov_b32 v2, 1
s_mov_b32 exec_lo, 65535
s_mov_b32 exec_hi, 0
buffer_atomic_add v2, v7, s[4:7], s59 offen sc1
s_mov_b64 exec, -1
hint_23:
v_cvt_pk_bf16_f32 v56, v8, v9
ds_write_b32 v79, v56 offset:0
v_cvt_pk_bf16_f32 v57, v10, v11
ds_write_b32 v79, v57 offset:256
v_cvt_pk_bf16_f32 v58, v16, v17
ds_write_b32 v79, v58 offset:2048
v_cvt_pk_bf16_f32 v59, v18, v19
ds_write_b32 v79, v59 offset:2304
v_cvt_pk_bf16_f32 v60, v24, v25
ds_write_b32 v79, v60 offset:32
v_cvt_pk_bf16_f32 v61, v26, v27
ds_write_b32 v79, v61 offset:288
v_cvt_pk_bf16_f32 v62, v32, v33
ds_write_b32 v79, v62 offset:2080
v_cvt_pk_bf16_f32 v63, v34, v35
ds_write_b32 v79, v63 offset:2336
s_or_b32 s31, s24, s20
s_cmp_lg_u32 s31, 0
s_cbranch_scc1 nodc_24
v_cmp_gt_u32 vcc, 32, v1
s_nop 1
v_cndmask_b32 v9, v9, 0, vcc
v_cndmask_b32 v25, v25, 0, vcc
nodc_24:
v_mul_f32 v64, v8, v8
v_mul_f32 v65, v24, v24
v_fmac_f32 v64, v9, v9
v_fmac_f32 v65, v25, v25
v_fmac_f32 v64, v10, v10
v_fmac_f32 v65, v26, v26
v_fmac_f32 v64, v11, v11
v_fmac_f32 v65, v27, v27
v_fmac_f32 v64, v16, v16
v_fmac_f32 v65, v32, v32
v_fmac_f32 v64, v17, v17
v_fmac_f32 v65, v33, v33
v_fmac_f32 v64, v18, v18
v_fmac_f32 v65, v34, v34
v_fmac_f32 v64, v19, v19
v_fmac_f32 v65, v35, v35
s_nop 1
v_permlane32_swap_b32 v64, v65
v_add_f32 v64, v64, v65
ds_write_b32 v78, v64 offset:8192
v_lshlrev_b32 v78, 2, v1
s_waitcnt lgkmcnt(0)
s_barrier
ds_read_b128 v[8:11], v6
ds_read_b128 v[12:15], v6 offset:1024
s_cmp_lg_u32 s20, 1
s_cbranch_scc1 ssq_25
ds_read2st64_b32 v[56:57], v78 offset0:32 offset1:33
ds_read2st64_b32 v[58:59], v78 offset0:34 offset1:35
s_waitcnt lgkmcnt(0)
v_pk_add_f32 v[56:57], v[56:57], v[58:59]
v_add_f32 v56, v56, v57
v_cvt_pk_bf16_f32 v56, v56, 1.0
buffer_atomic_pk_add_bf16 v56, v78, s[4:7], s29 offen sc1
ssq_25:
s_waitcnt lgkmcnt(1)
buffer_store_dwordx4 v[8:11], v5, s[4:7], s28 offen sc1
s_waitcnt lgkmcnt(0)
buffer_store_dwordx4 v[12:15], v5, s[4:7], s30 offen sc1
s_lshl_b32 s30, s2, 2
s_add_u32 s30, s30, s20
s_lshl_b32 s30, s30, 11
s_add_u32 s30, s30, 13631488
buffer_load_dwordx4 v[72:75], v231, s[4:7], s30 offen
buffer_load_dwordx4 v[76:79], v231, s[4:7], s30 offen offset:1024
s_add_u32 s39, s39, 802816
s_mov_b32 s58, s39
buffer_load_dwordx4 a[168:171], v231, s[4:7], s58 offen offset:0
buffer_load_dwordx4 a[172:175], v231, s[4:7], s58 offen offset:1024
buffer_load_dwordx4 a[176:179], v231, s[4:7], s58 offen offset:2048
buffer_load_dwordx4 a[180:183], v231, s[4:7], s58 offen offset:3072
s_lshl_b32 s59, s24, 12
s_sub_u32 s58, s39, s59
s_cmp_eq_u32 s58, s39
s_cselect_b32 s59, 4096, 0
s_add_u32 s58, s58, s59
buffer_load_dwordx4 a[184:187], v231, s[4:7], s58 offen offset:0
buffer_load_dwordx4 a[188:191], v231, s[4:7], s58 offen offset:1024
buffer_load_dwordx4 a[192:195], v231, s[4:7], s58 offen offset:2048
s_cmp_lg_u32 s20, 0
s_cbranch_scc1 pi_26
s_and_b32 s28, s2, 15
s_mul_i32 s29, s28, 2048
s_add_u32 s29, s29, 20512768
v_and_b32 v5, 15, v1
v_lshlrev_b32 v5, 7, v5
v_add_u32 v5, s29, v5
v_mov_b32 v6, 14
s_mov_b32 s50, 131071
s_mov_b32 s51, 0
s_lshl_b32 s29, s28, 7
s_add_u32 s29, s29, 20652032
v_mov_b32 v7, s29
v_cmp_lt_u32 vcc, 15, v1
s_nop 1
v_cndmask_b32 v5, v5, v7, vcc
v_cndmask_b32 v6, v6, 11, vcc
v_mov_b32 v2, 0
s_mov_b64 exec, s[50:51]
buffer_atomic_or v2, v5, s[4:7], 0 offen sc0 sc1
s_mov_b64 exec, -1
pi_26:
s_cmp_lg_u32 s20, 0
s_cbranch_scc1 poll_27_d
s_mov_b32 s28, 0
s_mov_b64 exec, s[50:51]
s_waitcnt vmcnt(0)
poll_27:
v_cmp_gt_u32 vcc, v6, v2
s_add_u32 s28, s28, 1
s_and_b64 exec, vcc, vcc
s_cbranch_scc0 poll_27_d
s_cmp_gt_u32 s28, 32768
s_cbranch_scc1 poll_27_d
v_mov_b32 v2, 0
buffer_atomic_or v2, v5, s[4:7], 0 offen sc0 sc1
s_waitcnt vmcnt(0)
s_branch poll_27
poll_27_d:
s_mov_b64 exec, -1
s_barrier
v_lshlrev_b32 v5, 7, v3
v_lshl_add_u32 v5, v4, 4, v5
s_lshl_b32 s28, s20, 11
v_add_u32 v5, s28, v5
s_lshl_b32 s29, s2, 13
s_add_u32 s29, s29, 9437184
s_mov_b32 s30, 20619264
s_mov_b32 s31, 0x40e00000
s_mov_b32 s32, 0x46124925
v_mov_b32 v162, 0x4227c5ac
s_mov_b32 s28, 0
cp_28:
buffer_load_dwordx4 v[16:19], v5, s[4:7], s30 offen sc1
buffer_load_dwordx4 v[20:23], v5, s[4:7], s30 offen offset:64 sc1
cp_28_z:
buffer_load_dwordx4 v[8:11], v5, s[4:7], s29 offen sc1
buffer_load_dwordx4 v[12:15], v5, s[4:7], s29 offen offset:64 sc1
s_add_u32 s28, s28, 1
s_waitcnt vmcnt(2)
v_min3_u32 v7, v16, v17, v18
v_min3_u32 v6, v19, v20, v21
v_min3_u32 v7, v7, v22, v23
v_min_u32 v7, v7, v6
v_cmp_gt_u32 s[50:51], s31, v7
v_lshlrev_b32 v16, 16, v16
v_fma_f32 v16, v16, s32, v162
v_lshlrev_b32 v17, 16, v17
v_fma_f32 v17, v17, s32, v162
v_lshlrev_b32 v18, 16, v18
v_fma_f32 v18, v18, s32, v162
v_lshlrev_b32 v19, 16, v19
v_fma_f32 v19, v19, s32, v162
v_lshlrev_b32 v20, 16, v20
v_fma_f32 v20, v20, s32, v162
v_lshlrev_b32 v21, 16, v21
v_fma_f32 v21, v21, s32, v162
v_lshlrev_b32 v22, 16, v22
v_fma_f32 v22, v22, s32, v162
v_lshlrev_b32 v23, 16, v23
v_fma_f32 v23, v23, s32, v162
v_rsq_f32 v16, v16
v_rsq_f32 v17, v17
v_rsq_f32 v18, v18
v_rsq_f32 v19, v19
v_rsq_f32 v20, v20
v_rsq_f32 v21, v21
v_rsq_f32 v22, v22
v_rsq_f32 v23, v23
s_waitcnt vmcnt(0)
v_max3_u32 v7, v8, v9, v10
v_max3_u32 v6, v11, v12, v13
v_max3_u32 v7, v7, v14, v15
v_max_u32 v7, v7, v6
v_cmp_eq_u32 vcc, -1, v7
s_nop 0
s_or_b64 vcc, vcc, s[50:51]
s_and_b64 exec, vcc, vcc
s_cbranch_scc0 cp_28_d
s_cmp_le_u32 s28, 32768
s_cbranch_scc1 cp_28
cp_28_d:
s_mov_b64 exec, -1
v_lshlrev_b32 v144, 16, v8
v_and_b32 v152, 0xffff0000, v8
v_lshlrev_b32 v145, 16, v9
v_and_b32 v153, 0xffff0000, v9
v_lshlrev_b32 v146, 16, v10
v_and_b32 v154, 0xffff0000, v10
v_lshlrev_b32 v147, 16, v11
v_and_b32 v155, 0xffff0000, v11
v_lshlrev_b32 v148, 16, v12
v_and_b32 v156, 0xffff0000, v12
v_lshlrev_b32 v149, 16, v13
v_and_b32 v157, 0xffff0000, v13
v_lshlrev_b32 v150, 16, v14
v_and_b32 v158, 0xffff0000, v14
v_lshlrev_b32 v151, 16, v15
v_and_b32 v159, 0xffff0000, v15
v_pk_mul_f32 v[24:25], v[16:17], v[144:145]
v_pk_mul_f32 v[32:33], v[16:17], v[152:153]
v_pk_mul_f32 v[26:27], v[18:19], v[146:147]
v_pk_mul_f32 v[34:35], v[18:19], v[154:155]
v_pk_mul_f32 v[28:29], v[20:21], v[148:149]
v_pk_mul_f32 v[36:37], v[20:21], v[156:157]
v_pk_mul_f32 v[30:31], v[22:23], v[150:151]
v_pk_mul_f32 v[38:39], v[22:23], v[158:159]
v_cvt_pk_bf16_f32 v64, v24, v25
v_cvt_pk_bf16_f32 v68, v32, v33
v_cvt_pk_bf16_f32 v65, v26, v27
v_cvt_pk_bf16_f32 v69, v34, v35
v_cvt_pk_bf16_f32 v66, v28, v29
v_cvt_pk_bf16_f32 v70, v36, v37
v_cvt_pk_bf16_f32 v67, v30, v31
v_cvt_pk_bf16_f32 v71, v38, v39
s_cmp_lg_u32 s2, 0
s_cbranch_scc1 nz_29
v_mov_b32 v68, 0
v_mov_b32 v69, 0
v_mov_b32 v70, 0
v_mov_b32 v71, 0
nz_29:
ds_write_b64 v184, v[64:65]
ds_write_b64 v185, v[66:67]
ds_write_b64 v184, v[68:69] offset:4096
ds_write_b64 v185, v[70:71] offset:4096
buffer_load_dwordx4 a[196:199], v231, s[4:7], s58 offen offset:3072
s_add_u32 s58, s58, 4096
s_cmp_eq_u32 s58, s39
s_cselect_b32 s59, 4096, 0
s_add_u32 s58, s58, s59
buffer_load_dwordx4 a[200:203], v231, s[4:7], s58 offen offset:0
s_waitcnt lgkmcnt(0)
s_barrier
ds_read_b64_tr_b16 v[16:17], v187 offset:0
ds_read_b64_tr_b16 v[18:19], v187 offset:1024
ds_read_b64_tr_b16 v[20:21], v188 offset:0
ds_read_b64_tr_b16 v[22:23], v188 offset:1024
ds_read_b64_tr_b16 v[24:25], v187 offset:4096
ds_read_b64_tr_b16 v[26:27], v187 offset:5120
ds_read_b64_tr_b16 v[28:29], v188 offset:4096
ds_read_b64_tr_b16 v[30:31], v188 offset:5120
ds_read_b64_tr_b16 v[32:33], v187 offset:2048
ds_read_b64_tr_b16 v[34:35], v187 offset:3072
ds_read_b64_tr_b16 v[36:37], v188 offset:2048
ds_read_b64_tr_b16 v[38:39], v188 offset:3072
ds_read_b64_tr_b16 v[40:41], v187 offset:6144
ds_read_b64_tr_b16 v[42:43], v187 offset:7168
ds_read_b64_tr_b16 v[44:45], v188 offset:6144
ds_read_b64_tr_b16 v[46:47], v188 offset:7168
buffer_load_dwordx4 a[204:207], v231, s[4:7], s58 offen offset:1024
buffer_load_dwordx4 a[208:211], v231, s[4:7], s58 offen offset:2048
s_waitcnt lgkmcnt(12)
v_mfma_f32_16x16x32_bf16 v[48:51], v[16:19], v[80:83], 0
v_mfma_f32_16x16x32_bf16 v[56:59], v[16:19], v[96:99], 0
v_mfma_f32_16x16x32_bf16 v[52:55], v[20:23], v[80:83], 0
v_mfma_f32_16x16x32_bf16 v[60:63], v[20:23], v[96:99], 0
s_waitcnt lgkmcnt(8)
v_mfma_f32_16x16x32_bf16 v[48:51], v[24:27], v[88:91], v[48:51]
v_mfma_f32_16x16x32_bf16 v[56:59], v[24:27], v[80:83], v[56:59]
v_mfma_f32_16x16x32_bf16 v[52:55], v[28:31], v[88:91], v[52:55]
v_mfma_f32_16x16x32_bf16 v[60:63], v[28:31], v[80:83], v[60:63]
s_waitcnt lgkmcnt(4)
v_mfma_f32_16x16x32_bf16 v[48:51], v[32:35], v[84:87], v[48:51]
v_mfma_f32_16x16x32_bf16 v[56:59], v[32:35], v[100:103], v[56:59]
v_mfma_f32_16x16x32_bf16 v[52:55], v[36:39], v[84:87], v[52:55]
v_mfma_f32_16x16x32_bf16 v[60:63], v[36:39], v[100:103], v[60:63]
s_waitcnt lgkmcnt(0)
v_mfma_f32_16x16x32_bf16 v[48:51], v[40:43], v[92:95], v[48:51]
v_mfma_f32_16x16x32_bf16 v[56:59], v[40:43], v[84:87], v[56:59]
v_mfma_f32_16x16x32_bf16 v[52:55], v[44:47], v[92:95], v[52:55]
v_mfma_f32_16x16x32_bf16 v[60:63], v[44:47], v[84:87], v[60:63]
s_nop 4
v_pk_mul_f32 v[168:169], v[48:49], v[128:129]
v_pk_mul_f32 v[176:177], v[56:57], v[128:129]
v_pk_mul_f32 v[170:171], v[50:51], v[130:131]
v_pk_mul_f32 v[178:179], v[58:59], v[130:131]
v_pk_mul_f32 v[172:173], v[52:53], v[132:133]
v_pk_mul_f32 v[180:181], v[60:61], v[132:133]
v_pk_mul_f32 v[174:175], v[54:55], v[134:135]
v_pk_mul_f32 v[182:183], v[62:63], v[134:135]
v_pk_fma_f32 v[168:169], v[56:57], v[136:137], v[168:169] neg_lo:[0,0,0] neg_hi:[0,0,0]
v_pk_fma_f32 v[176:177], v[48:49], v[136:137], v[176:177] neg_lo:[1,0,0] neg_hi:[1,0,0]
v_pk_fma_f32 v[170:171], v[58:59], v[138:139], v[170:171] neg_lo:[0,0,0] neg_hi:[0,0,0]
v_pk_fma_f32 v[178:179], v[50:51], v[138:139], v[178:179] neg_lo:[1,0,0] neg_hi:[1,0,0]
v_pk_fma_f32 v[172:173], v[60:61], v[140:141], v[172:173] neg_lo:[0,0,0] neg_hi:[0,0,0]
v_pk_fma_f32 v[180:181], v[52:53], v[140:141], v[180:181] neg_lo:[1,0,0] neg_hi:[1,0,0]
v_pk_fma_f32 v[174:175], v[62:63], v[142:143], v[174:175] neg_lo:[0,0,0] neg_hi:[0,0,0]
v_pk_fma_f32 v[182:183], v[54:55], v[142:143], v[182:183] neg_lo:[1,0,0] neg_hi:[1,0,0]
buffer_load_dwordx4 a[212:215], v231, s[4:7], s58 offen offset:3072
s_add_u32 s58, s58, 4096
s_cmp_eq_u32 s58, s39
s_cselect_b32 s59, 4096, 0
s_add_u32 s58, s58, s59
buffer_load_dwordx4 a[216:219], v231, s[4:7], s58 offen offset:0
v_cvt_pk_bf16_f32 v64, v168, v169
v_cvt_pk_bf16_f32 v68, v176, v177
v_cvt_pk_bf16_f32 v65, v170, v171
v_cvt_pk_bf16_f32 v69, v178, v179
v_cvt_pk_bf16_f32 v66, v172, v173
v_cvt_pk_bf16_f32 v70, v180, v181
v_cvt_pk_bf16_f32 v67, v174, v175
v_cvt_pk_bf16_f32 v71, v182, v183
s_nop 0
v_mfma_f32_16x16x32_bf16 v[48:51], v[104:107], v[64:67], 0
v_mfma_f32_16x16x32_bf16 v[56:59], v[104:107], v[68:71], 0
v_mfma_f32_16x16x32_bf16 v[52:55], v[108:111], v[64:67], 0
v_mfma_f32_16x16x32_bf16 v[60:63], v[108:111], v[68:71], 0
v_mfma_f32_16x16x32_bf16 v[48:51], v[112:115], v[68:71], v[48:51]
v_mfma_f32_16x16x32_bf16 v[56:59], v[120:123], v[64:67], v[56:59]
v_mfma_f32_16x16x32_bf16 v[52:55], v[116:119], v[68:71], v[52:55]
v_mfma_f32_16x16x32_bf16 v[60:63], v[124:127], v[64:67], v[60:63]
buffer_load_dwordx4 a[220:223], v231, s[4:7], s58 offen offset:1024
buffer_load_dwordx4 a[224:227], v231, s[4:7], s58 offen offset:2048
v_lshlrev_b32 v16, 16, v72
v_and_b32 v17, 0xffff0000, v72
v_lshlrev_b32 v24, 16, v76
v_and_b32 v25, 0xffff0000, v76
v_lshlrev_b32 v18, 16, v73
v_and_b32 v19, 0xffff0000, v73
v_lshlrev_b32 v26, 16, v77
v_and_b32 v27, 0xffff0000, v77
v_lshlrev_b32 v20, 16, v74
v_and_b32 v21, 0xffff0000, v74
v_lshlrev_b32 v28, 16, v78
v_and_b32 v29, 0xffff0000, v78
v_lshlrev_b32 v22, 16, v75
v_and_b32 v23, 0xffff0000, v75
v_lshlrev_b32 v30, 16, v79
v_and_b32 v31, 0xffff0000, v79
v_pk_mul_f32 v[168:169], v[48:49], v[16:17]
v_pk_mul_f32 v[176:177], v[56:57], v[16:17]
v_pk_mul_f32 v[170:171], v[50:51], v[18:19]
v_pk_mul_f32 v[178:179], v[58:59], v[18:19]
v_pk_mul_f32 v[172:173], v[52:53], v[20:21]
v_pk_mul_f32 v[180:181], v[60:61], v[20:21]
v_pk_mul_f32 v[174:175], v[54:55], v[22:23]
v_pk_mul_f32 v[182:183], v[62:63], v[22:23]
v_pk_fma_f32 v[168:169], v[56:57], v[24:25], v[168:169] neg_lo:[1,0,0] neg_hi:[1,0,0]
v_pk_fma_f32 v[176:177], v[48:49], v[24:25], v[176:177] neg_lo:[0,0,0] neg_hi:[0,0,0]
v_pk_fma_f32 v[170:171], v[58:59], v[26:27], v[170:171] neg_lo:[1,0,0] neg_hi:[1,0,0]
v_pk_fma_f32 v[178:179], v[50:51], v[26:27], v[178:179] neg_lo:[0,0,0] neg_hi:[0,0,0]
v_pk_fma_f32 v[172:173], v[60:61], v[28:29], v[172:173] neg_lo:[1,0,0] neg_hi:[1,0,0]
v_pk_fma_f32 v[180:181], v[52:53], v[28:29], v[180:181] neg_lo:[0,0,0] neg_hi:[0,0,0]
v_pk_fma_f32 v[174:175], v[62:63], v[30:31], v[174:175] neg_lo:[1,0,0] neg_hi:[1,0,0]
v_pk_fma_f32 v[182:183], v[54:55], v[30:31], v[182:183] neg_lo:[0,0,0] neg_hi:[0,0,0]
buffer_load_dwordx4 a[228:231], v231, s[4:7], s58 offen offset:3072
s_add_u32 s58, s58, 4096
s_cmp_eq_u32 s58, s39
s_cselect_b32 s59, 4096, 0
s_add_u32 s58, s58, s59
buffer_load_dwordx4 a[232:235], v231, s[4:7], s58 offen offset:0
v_cvt_pk_bf16_f32 v64, v168, v169
v_cvt_pk_bf16_f32 v68, v176, v177
v_cvt_pk_bf16_f32 v65, v170, v171
v_cvt_pk_bf16_f32 v69, v178, v179
v_cvt_pk_bf16_f32 v66, v172, v173
v_cvt_pk_bf16_f32 v70, v180, v181
v_cvt_pk_bf16_f32 v67, v174, v175
v_cvt_pk_bf16_f32 v71, v182, v183
s_nop 0
v_mfma_f32_16x16x32_bf16 v[48:51], v[104:107], v[64:67], 0
v_mfma_f32_16x16x32_bf16 v[56:59], v[104:107], v[68:71], 0
v_mfma_f32_16x16x32_bf16 v[52:55], v[108:111], v[64:67], 0
v_mfma_f32_16x16x32_bf16 v[60:63], v[108:111], v[68:71], 0
v_mfma_f32_16x16x32_bf16 v[48:51], v[120:123], v[68:71], v[48:51]
v_mfma_f32_16x16x32_bf16 v[56:59], v[112:115], v[64:67], v[56:59]
v_mfma_f32_16x16x32_bf16 v[52:55], v[124:127], v[68:71], v[52:55]
v_mfma_f32_16x16x32_bf16 v[60:63], v[116:119], v[64:67], v[60:63]
buffer_load_dwordx4 a[236:239], v231, s[4:7], s58 offen offset:1024
buffer_load_dwordx4 a[240:243], v231, s[4:7], s58 offen offset:2048
s_nop 2
v_pk_mul_f32 v[168:169], v[48:49], v[128:129]
v_pk_mul_f32 v[176:177], v[56:57], v[128:129]
v_pk_mul_f32 v[170:171], v[50:51], v[130:131]
v_pk_mul_f32 v[178:179], v[58:59], v[130:131]
v_pk_mul_f32 v[172:173], v[52:53], v[132:133]
v_pk_mul_f32 v[180:181], v[60:61], v[132:133]
v_pk_mul_f32 v[174:175], v[54:55], v[134:135]
v_pk_mul_f32 v[182:183], v[62:63], v[134:135]
v_pk_fma_f32 v[168:169], v[56:57], v[136:137], v[168:169] neg_lo:[1,0,0] neg_hi:[1,0,0]
v_pk_fma_f32 v[176:177], v[48:49], v[136:137], v[176:177] neg_lo:[0,0,0] neg_hi:[0,0,0]
v_pk_fma_f32 v[170:171], v[58:59], v[138:139], v[170:171] neg_lo:[1,0,0] neg_hi:[1,0,0]
v_pk_fma_f32 v[178:179], v[50:51], v[138:139], v[178:179] neg_lo:[0,0,0] neg_hi:[0,0,0]
v_pk_fma_f32 v[172:173], v[60:61], v[140:141], v[172:173] neg_lo:[1,0,0] neg_hi:[1,0,0]
v_pk_fma_f32 v[180:181], v[52:53], v[140:141], v[180:181] neg_lo:[0,0,0] neg_hi:[0,0,0]
v_pk_fma_f32 v[174:175], v[62:63], v[142:143], v[174:175] neg_lo:[1,0,0] neg_hi:[1,0,0]
v_pk_fma_f32 v[182:183], v[54:55], v[142:143], v[182:183] neg_lo:[0,0,0] neg_hi:[0,0,0]
buffer_load_dwordx4 a[244:247], v231, s[4:7], s58 offen offset:3072
s_add_u32 s58, s58, 4096
s_cmp_eq_u32 s58, s39
s_cselect_b32 s59, 4096, 0
s_add_u32 s58, s58, s59
buffer_load_dwordx4 a[248:251], v231, s[4:7], s58 offen offset:0
v_cvt_pk_bf16_f32 v64, v168, v169
v_cvt_pk_bf16_f32 v68, v176, v177
v_cvt_pk_bf16_f32 v65, v170, v171
v_cvt_pk_bf16_f32 v69, v178, v179
v_cvt_pk_bf16_f32 v66, v172, v173
v_cvt_pk_bf16_f32 v70, v180, v181
v_cvt_pk_bf16_f32 v67, v174, v175
v_cvt_pk_bf16_f32 v71, v182, v183
ds_write_b128 v186, v[64:67] offset:8192
ds_write_b128 v186, v[68:71] offset:12288
s_mul_i32 s28, s20, 458752
s_lshl_b32 s29, s2, 8
s_add_u32 s28, s28, s29
s_add_u32 s28, s28, 11534336
buffer_load_dwordx4 a[252:255], v231, s[4:7], s58 offen offset:1024
buffer_load_dwordx4 v[232:235], v231, s[4:7], s58 offen offset:2048
s_waitcnt lgkmcnt(0)
s_barrier
ds_read_b64_tr_b16 v[16:17], v187 offset:8192
ds_read_b64_tr_b16 v[18:19], v187 offset:9216
ds_read_b64_tr_b16 v[20:21], v188 offset:8192
ds_read_b64_tr_b16 v[22:23], v188 offset:9216
ds_read_b64_tr_b16 v[24:25], v187 offset:12288
ds_read_b64_tr_b16 v[26:27], v187 offset:13312
ds_read_b64_tr_b16 v[28:29], v188 offset:12288
ds_read_b64_tr_b16 v[30:31], v188 offset:13312
ds_read_b64_tr_b16 v[32:33], v187 offset:10240
ds_read_b64_tr_b16 v[34:35], v187 offset:11264
ds_read_b64_tr_b16 v[36:37], v188 offset:10240
ds_read_b64_tr_b16 v[38:39], v188 offset:11264
ds_read_b64_tr_b16 v[40:41], v187 offset:14336
ds_read_b64_tr_b16 v[42:43], v187 offset:15360
ds_read_b64_tr_b16 v[44:45], v188 offset:14336
ds_read_b64_tr_b16 v[46:47], v188 offset:15360
buffer_load_dwordx4 v[236:239], v231, s[4:7], s58 offen offset:3072
s_add_u32 s58, s58, 4096
s_cmp_eq_u32 s58, s39
s_cselect_b32 s59, 4096, 0
s_add_u32 s58, s58, s59
buffer_load_dwordx4 v[240:243], v231, s[4:7], s58 offen offset:0
s_waitcnt lgkmcnt(12)
v_mfma_f32_16x16x32_bf16 v[48:51], v[16:19], v[80:83], 0
v_mfma_f32_16x16x32_bf16 v[56:59], v[16:19], v[88:91], 0
v_mfma_f32_16x16x32_bf16 v[52:55], v[20:23], v[80:83], 0
v_mfma_f32_16x16x32_bf16 v[60:63], v[20:23], v[88:91], 0
s_waitcnt lgkmcnt(8)
v_mfma_f32_16x16x32_bf16 v[48:51], v[24:27], v[96:99], v[48:51]
v_mfma_f32_16x16x32_bf16 v[56:59], v[24:27], v[80:83], v[56:59]
v_mfma_f32_16x16x32_bf16 v[52:55], v[28:31], v[96:99], v[52:55]
v_mfma_f32_16x16x32_bf16 v[60:63], v[28:31], v[80:83], v[60:63]
s_waitcnt lgkmcnt(4)
v_mfma_f32_16x16x32_bf16 v[48:51], v[32:35], v[84:87], v[48:51]
v_mfma_f32_16x16x32_bf16 v[56:59], v[32:35], v[92:95], v[56:59]
v_mfma_f32_16x16x32_bf16 v[52:55], v[36:39], v[84:87], v[52:55]
v_mfma_f32_16x16x32_bf16 v[60:63], v[36:39], v[92:95], v[60:63]
s_waitcnt lgkmcnt(0)
v_mfma_f32_16x16x32_bf16 v[48:51], v[40:43], v[100:103], v[48:51]
v_mfma_f32_16x16x32_bf16 v[56:59], v[40:43], v[84:87], v[56:59]
v_mfma_f32_16x16x32_bf16 v[52:55], v[44:47], v[100:103], v[52:55]
v_mfma_f32_16x16x32_bf16 v[60:63], v[44:47], v[84:87], v[60:63]
s_cmp_lg_u32 s20, 0
s_cbranch_scc1 hint_30
s_and_b32 s59, s2, 15
s_lshl_b32 s59, s59, 7
s_add_u32 s59, s59, 20545536
v_mul_u32_u24 v7, 2048, v1
v_mov_b32 v2, 1
s_mov_b32 exec_lo, 65535
s_mov_b32 exec_hi, 0
buffer_atomic_add v2, v7, s[4:7], s59 offen sc1
s_mov_b64 exec, -1
hint_30:
s_nop 2
v_add_f32 v144, v144, v48
v_fma_f32 v152, v56, s25, v152
v_add_f32 v145, v145, v49
v_fma_f32 v153, v57, s25, v153
v_add_f32 v146, v146, v50
v_fma_f32 v154, v58, s25, v154
v_add_f32 v147, v147, v51
v_fma_f32 v155, v59, s25, v155
v_add_f32 v148, v148, v52
v_fma_f32 v156, v60, s25, v156
v_add_f32 v149, v149, v53
v_fma_f32 v157, v61, s25, v157
v_add_f32 v150, v150, v54
v_fma_f32 v158, v62, s25, v158
v_add_f32 v151, v151, v55
v_fma_f32 v159, v63, s25, v159
v_cvt_pk_bf16_f32 v64, v144, v145
v_cvt_pk_bf16_f32 v68, v152, v153
v_cvt_pk_bf16_f32 v65, v146, v147
v_cvt_pk_bf16_f32 v69, v154, v155
v_cvt_pk_bf16_f32 v66, v148, v149
v_cvt_pk_bf16_f32 v70, v156, v157
v_cvt_pk_bf16_f32 v67, v150, v151
v_cvt_pk_bf16_f32 v71, v158, v159
buffer_store_dwordx4 v[64:67], v189, s[4:7], s28 offen sc1
buffer_store_dwordx4 v[68:71], v189, s[4:7], s28 offen offset:128 sc1
buffer_load_dwordx4 v[244:247], v231, s[4:7], s58 offen offset:1024
buffer_load_dwordx4 v[248:251], v231, s[4:7], s58 offen offset:2048
v_lshrrev_b32 v156, 2, v1
v_lshlrev_b32 v100, 7, v156
v_bfe_u32 v156, v1, 3, 2
v_lshl_add_u32 v100, v156, 5, v100
v_and_b32 v156, 3, v1
v_lshl_add_u32 v100, v156, 3, v100
v_xor_b32 v101, 32, v100
v_xor_b32 v102, 64, v100
v_xor_b32 v103, 0x60, v100
s_lshl_b32 s29, s20, 5
v_xor_b32 v104, s29, v100
buffer_load_dwordx4 v[252:255], v231, s[4:7], s58 offen offset:3072
s_cmp_lg_u32 s20, 0
s_cbranch_scc1 pi_31
s_and_b32 s28, s2, 15
s_mul_i32 s29, s28, 2048
s_add_u32 s29, s29, 20545536
v_and_b32 v5, 15, v1
v_lshlrev_b32 v5, 7, v5
v_add_u32 v5, s29, v5
v_mov_b32 v6, 14
s_mov_b32 s50, 131071
s_mov_b32 s51, 0
s_lshl_b32 s29, s28, 7
s_add_u32 s29, s29, 20656128
v_mov_b32 v7, s29
v_cmp_lt_u32 vcc, 15, v1
s_nop 1
v_cndmask_b32 v5, v5, v7, vcc
v_cndmask_b32 v6, v6, 21, vcc
v_mov_b32 v2, 0
s_mov_b64 exec, s[50:51]
buffer_atomic_or v2, v5, s[4:7], 0 offen sc0 sc1
s_mov_b64 exec, -1
pi_31:
s_cmp_lg_u32 s20, 0
s_cbranch_scc1 poll_32_d
s_mov_b32 s28, 0
s_mov_b64 exec, s[50:51]
s_waitcnt vmcnt(0)
poll_32:
v_cmp_gt_u32 vcc, v6, v2
s_add_u32 s28, s28, 1
s_and_b64 exec, vcc, vcc
s_cbranch_scc0 poll_32_d
s_cmp_gt_u32 s28, 32768
s_cbranch_scc1 poll_32_d
v_mov_b32 v2, 0
buffer_atomic_or v2, v5, s[4:7], 0 offen sc0 sc1
s_waitcnt vmcnt(0)
s_branch poll_32
poll_32_d:
s_mov_b64 exec, -1
s_barrier
s_mov_b32 s34, s27
s_mov_b32 s35, s58
s_mov_b32 s3, s26
SC_redo1:
s_mov_b32 s26, s3
s_mov_b32 s27, s34
s_mov_b32 s58, s35
s_lshl_b32 s29, s20, 10
s_mov_b32 m0, s29
s_mul_i32 s30, s23, 57344
s_add_u32 s30, s30, s29
s_add_u32 s30, s30, 11534336
buffer_load_dwordx4 v231, s[4:7], s30 offen sc1 lds
s_add_u32 m0, m0, 4096
s_add_u32 s30, s30, 4096
buffer_load_dwordx4 v231, s[4:7], s30 offen sc1 lds
s_add_u32 m0, m0, 4096
s_add_u32 s30, s30, 4096
buffer_load_dwordx4 v231, s[4:7], s30 offen sc1 lds
s_add_u32 m0, m0, 4096
s_add_u32 s30, s30, 4096
buffer_load_dwordx4 v231, s[4:7], s30 offen sc1 lds
s_add_u32 m0, m0, 4096
s_add_u32 s30, s30, 4096
buffer_load_dwordx4 v231, s[4:7], s30 offen sc1 lds
s_add_u32 m0, m0, 4096
s_add_u32 s30, s30, 4096
buffer_load_dwordx4 v231, s[4:7], s30 offen sc1 lds
s_add_u32 m0, m0, 4096
s_add_u32 s30, s30, 4096
buffer_load_dwordx4 v231, s[4:7], s30 offen sc1 lds
s_add_u32 m0, m0, 4096
s_add_u32 s30, s30, 4096
buffer_load_dwordx4 v231, s[4:7], s30 offen sc1 lds
s_add_u32 m0, m0, 4096
s_add_u32 s30, s30, 4096
buffer_load_dwordx4 v231, s[4:7], s30 offen sc1 lds
s_add_u32 m0, m0, 4096
s_add_u32 s30, s30, 4096
buffer_load_dwordx4 v231, s[4:7], s30 offen sc1 lds
s_add_u32 m0, m0, 4096
s_add_u32 s30, s30, 4096
buffer_load_dwordx4 v231, s[4:7], s30 offen sc1 lds
s_add_u32 m0, m0, 4096
s_add_u32 s30, s30, 4096
buffer_load_dwordx4 v231, s[4:7], s30 offen sc1 lds
s_add_u32 m0, m0, 4096
s_add_u32 s30, s30, 4096
buffer_load_dwordx4 v231, s[4:7], s30 offen sc1 lds
s_add_u32 m0, m0, 4096
s_add_u32 s30, s30, 4096
buffer_load_dwordx4 v231, s[4:7], s30 offen sc1 lds
s_waitcnt vmcnt(12)
s_barrier
ds_read_b64_tr_b16 v[60:61], v100 offset:0
ds_read_b64_tr_b16 v[62:63], v100 offset:2048
ds_read_b64_tr_b16 v[64:65], v101 offset:0
ds_read_b64_tr_b16 v[66:67], v101 offset:2048
ds_read_b64_tr_b16 v[68:69], v102 offset:0
ds_read_b64_tr_b16 v[70:71], v102 offset:2048
ds_read_b64_tr_b16 v[72:73], v103 offset:0
ds_read_b64_tr_b16 v[74:75], v103 offset:2048
ds_read_b64_tr_b16 v[76:77], v104 offset:0
ds_read_b64_tr_b16 v[78:79], v104 offset:2048
s_waitcnt lgkmcnt(8)
v_mfma_f32_16x16x32_bf16 v[8:11], v[60:63], a[0:3], 0
ds_read_b64_tr_b16 v[80:81], v100 offset:4096
v_mfma_f32_16x16x32_bf16 v[24:27], v[60:63], a[4:7], 0
ds_read_b64_tr_b16 v[82:83], v100 offset:6144
s_waitcnt lgkmcnt(8)
v_mfma_f32_16x16x32_bf16 v[12:15], v[64:67], a[0:3], 0
ds_read_b64_tr_b16 v[84:85], v101 offset:4096
v_mfma_f32_16x16x32_bf16 v[28:31], v[64:67], a[4:7], 0
ds_read_b64_tr_b16 v[86:87], v101 offset:6144
s_waitcnt lgkmcnt(8)
v_mfma_f32_16x16x32_bf16 v[16:19], v[68:71], a[0:3], 0
ds_read_b64_tr_b16 v[88:89], v102 offset:4096
v_mfma_f32_16x16x32_bf16 v[32:35], v[68:71], a[4:7], 0
ds_read_b64_tr_b16 v[90:91], v102 offset:6144
s_waitcnt lgkmcnt(8)
v_mfma_f32_16x16x32_bf16 v[20:23], v[72:75], a[0:3], 0
ds_read_b64_tr_b16 v[92:93], v103 offset:4096
v_mfma_f32_16x16x32_bf16 v[36:39], v[72:75], a[4:7], 0
ds_read_b64_tr_b16 v[94:95], v103 offset:6144
s_waitcnt lgkmcnt(8)
v_mfma_f32_16x16x32_bf16 v[56:59], v[76:79], v[76:79], 0
ds_read_b64_tr_b16 v[96:97], v104 offset:4096
ds_read_b64_tr_b16 v[98:99], v104 offset:6144
s_waitcnt vmcnt(10)
s_barrier
s_waitcnt lgkmcnt(8)
v_mfma_f32_16x16x32_bf16 v[8:11], v[80:83], a[8:11], v[8:11]
ds_read_b64_tr_b16 v[60:61], v100 offset:8192
v_mfma_f32_16x16x32_bf16 v[24:27], v[80:83], a[12:15], v[24:27]
ds_read_b64_tr_b16 v[62:63], v100 offset:10240
s_waitcnt lgkmcnt(8)
v_mfma_f32_16x16x32_bf16 v[12:15], v[84:87], a[8:11], v[12:15]
ds_read_b64_tr_b16 v[64:65], v101 offset:8192
v_mfma_f32_16x16x32_bf16 v[28:31], v[84:87], a[12:15], v[28:31]
ds_read_b64_tr_b16 v[66:67], v101 offset:10240
s_waitcnt lgkmcnt(8)
v_mfma_f32_16x16x32_bf16 v[16:19], v[88:91], a[8:11], v[16:19]
ds_read_b64_tr_b16 v[68:69], v102 offset:8192
v_mfma_f32_16x16x32_bf16 v[32:35], v[88:91], a[12:15], v[32:35]
ds_read_b64_tr_b16 v[70:71], v102 offset:10240
s_waitcnt lgkmcnt(8)
v_mfma_f32_16x16x32_bf16 v[20:23], v[92:95], a[8:11], v[20:23]
ds_read_b64_tr_b16 v[72:73], v103 offset:8192
v_mfma_f32_16x16x32_bf16 v[36:39], v[92:95], a[12:15], v[36:39]
ds_read_b64_tr_b16 v[74:75], v103 offset:10240
s_waitcnt lgkmcnt(8)
v_mfma_f32_16x16x32_bf16 v[56:59], v[96:99], v[96:99], v[56:59]
ds_read_b64_tr_b16 v[76:77], v104 offset:8192
ds_read_b64_tr_b16 v[78:79], v104 offset:10240
s_waitcnt lgkmcnt(8)
v_mfma_f32_16x16x32_bf16 v[8:11], v[60:63], a[16:19], v[8:11]
ds_read_b64_tr_b16 v[80:81], v100 offset:12288
v_mfma_f32_16x16x32_bf16 v[24:27], v[60:63], a[20:23], v[24:27]
ds_read_b64_tr_b16 v[82:83], v100 offset:14336
s_waitcnt lgkmcnt(8)
v_mfma_f32_16x16x32_bf16 v[12:15], v[64:67], a[16:19], v[12:15]
ds_read_b64_tr_b16 v[84:85], v101 offset:12288
v_mfma_f32_16x16x32_bf16 v[28:31], v[64:67], a[20:23], v[28:31]
ds_read_b64_tr_b16 v[86:87], v101 offset:14336
s_waitcnt lgkmcnt(8)
v_mfma_f32_16x16x32_bf16 v[16:19], v[68:71], a[16:19], v[16:19]
ds_read_b64_tr_b16 v[88:89], v102 offset:12288
v_mfma_f32_16x16x32_bf16 v[32:35], v[68:71], a[20:23], v[32:35]
ds_read_b64_tr_b16 v[90:91], v102 offset:14336
s_waitcnt lgkmcnt(8)
v_mfma_f32_16x16x32_bf16 v[20:23], v[72:75], a[16:19], v[20:23]
ds_read_b64_tr_b16 v[92:93], v103 offset:12288
v_mfma_f32_16x16x32_bf16 v[36:39], v[72:75], a[20:23], v[36:39]
ds_read_b64_tr_b16 v[94:95], v103 offset:14336
s_waitcnt lgkmcnt(8)
v_mfma_f32_16x16x32_bf16 v[56:59], v[76:79], v[76:79], v[56:59]
ds_read_b64_tr_b16 v[96:97], v104 offset:12288
ds_read_b64_tr_b16 v[98:99], v104 offset:14336
s_waitcnt vmcnt(5)
s_barrier
s_waitcnt lgkmcnt(8)
v_mfma_f32_16x16x32_bf16 v[8:11], v[80:83], a[24:27], v[8:11]
ds_read_b64_tr_b16 v[60:61], v100 offset:16384
v_mfma_f32_16x16x32_bf16 v[24:27], v[80:83], a[28:31], v[24:27]
ds_read_b64_tr_b16 v[62:63], v100 offset:18432
s_waitcnt lgkmcnt(8)
v_mfma_f32_16x16x32_bf16 v[12:15], v[84:87], a[24:27], v[12:15]
ds_read_b64_tr_b16 v[64:65], v101 offset:16384
v_mfma_f32_16x16x32_bf16 v[28:31], v[84:87], a[28:31], v[28:31]
ds_read_b64_tr_b16 v[66:67], v101 offset:18432
s_waitcnt lgkmcnt(8)
v_mfma_f32_16x16x32_bf16 v[16:19], v[88:91], a[24:27], v[16:19]
ds_read_b64_tr_b16 v[68:69], v102 offset:16384
v_mfma_f32_16x16x32_bf16 v[32:35], v[88:91], a[28:31], v[32:35]
ds_read_b64_tr_b16 v[70:71], v102 offset:18432
s_waitcnt lgkmcnt(8)
v_mfma_f32_16x16x32_bf16 v[20:23], v[92:95], a[24:27], v[20:23]
ds_read_b64_tr_b16 v[72:73], v103 offset:16384
v_mfma_f32_16x16x32_bf16 v[36:39], v[92:95], a[28:31], v[36:39]
ds_read_b64_tr_b16 v[74:75], v103 offset:18432
s_waitcnt lgkmcnt(8)
v_mfma_f32_16x16x32_bf16 v[56:59], v[96:99], v[96:99], v[56:59]
ds_read_b64_tr_b16 v[76:77], v104 offset:16384
ds_read_b64_tr_b16 v[78:79], v104 offset:18432
s_waitcnt lgkmcnt(8)
v_mfma_f32_16x16x32_bf16 v[8:11], v[60:63], a[32:35], v[8:11]
ds_read_b64_tr_b16 v[80:81], v100 offset:20480
v_mfma_f32_16x16x32_bf16 v[24:27], v[60:63], a[36:39], v[24:27]
ds_read_b64_tr_b16 v[82:83], v100 offset:22528
s_waitcnt lgkmcnt(8)
v_mfma_f32_16x16x32_bf16 v[12:15], v[64:67], a[32:35], v[12:15]
ds_read_b64_tr_b16 v[84:85], v101 offset:20480
v_mfma_f32_16x16x32_bf16 v[28:31], v[64:67], a[36:39], v[28:31]
ds_read_b64_tr_b16 v[86:87], v101 offset:22528
s_waitcnt lgkmcnt(8)
v_mfma_f32_16x16x32_bf16 v[16:19], v[68:71], a[32:35], v[16:19]
ds_read_b64_tr_b16 v[88:89], v102 offset:20480
v_mfma_f32_16x16x32_bf16 v[32:35], v[68:71], a[36:39], v[32:35]
ds_read_b64_tr_b16 v[90:91], v102 offset:22528
s_waitcnt lgkmcnt(8)
v_mfma_f32_16x16x32_bf16 v[20:23], v[72:75], a[32:35], v[20:23]
ds_read_b64_tr_b16 v[92:93], v103 offset:20480
v_mfma_f32_16x16x32_bf16 v[36:39], v[72:75], a[36:39], v[36:39]
ds_read_b64_tr_b16 v[94:95], v103 offset:22528
s_waitcnt lgkmcnt(8)
v_mfma_f32_16x16x32_bf16 v[56:59], v[76:79], v[76:79], v[56:59]
ds_read_b64_tr_b16 v[96:97], v104 offset:20480
ds_read_b64_tr_b16 v[98:99], v104 offset:22528
s_waitcnt lgkmcnt(8)
v_mfma_f32_16x16x32_bf16 v[8:11], v[80:83], a[40:43], v[8:11]
ds_read_b64_tr_b16 v[60:61], v100 offset:24576
v_mfma_f32_16x16x32_bf16 v[24:27], v[80:83], a[44:47], v[24:27]
ds_read_b64_tr_b16 v[62:63], v100 offset:26624
s_waitcnt lgkmcnt(8)
v_mfma_f32_16x16x32_bf16 v[12:15], v[84:87], a[40:43], v[12:15]
ds_read_b64_tr_b16 v[64:65], v101 offset:24576
v_mfma_f32_16x16x32_bf16 v[28:31], v[84:87], a[44:47], v[28:31]
ds_read_b64_tr_b16 v[66:67], v101 offset:26624
s_waitcnt lgkmcnt(8)
v_mfma_f32_16x16x32_bf16 v[16:19], v[88:91], a[40:43], v[16:19]
ds_read_b64_tr_b16 v[68:69], v102 offset:24576
v_mfma_f32_16x16x32_bf16 v[32:35], v[88:91], a[44:47], v[32:35]
ds_read_b64_tr_b16 v[70:71], v102 offset:26624
s_waitcnt lgkmcnt(8)
v_mfma_f32_16x16x32_bf16 v[20:23], v[92:95], a[40:43], v[20:23]
ds_read_b64_tr_b16 v[72:73], v103 offset:24576
v_mfma_f32_16x16x32_bf16 v[36:39], v[92:95], a[44:47], v[36:39]
ds_read_b64_tr_b16 v[74:75], v103 offset:26624
s_waitcnt lgkmcnt(8)
v_mfma_f32_16x16x32_bf16 v[56:59], v[96:99], v[96:99], v[56:59]
ds_read_b64_tr_b16 v[76:77], v104 offset:24576
ds_read_b64_tr_b16 v[78:79], v104 offset:26624
s_waitcnt lgkmcnt(8)
v_mfma_f32_16x16x32_bf16 v[8:11], v[60:63], a[48:51], v[8:11]
ds_read_b64_tr_b16 v[80:81], v100 offset:28672
v_mfma_f32_16x16x32_bf16 v[24:27], v[60:63], a[52:55], v[24:27]
ds_read_b64_tr_b16 v[82:83], v100 offset:30720
s_waitcnt lgkmcnt(8)
v_mfma_f32_16x16x32_bf16 v[12:15], v[64:67], a[48:51], v[12:15]
ds_read_b64_tr_b16 v[84:85], v101 offset:28672
v_mfma_f32_16x16x32_bf16 v[28:31], v[64:67], a[52:55], v[28:31]
ds_read_b64_tr_b16 v[86:87], v101 offset:30720
s_waitcnt lgkmcnt(8)
v_mfma_f32_16x16x32_bf16 v[16:19], v[68:71], a[48:51], v[16:19]
ds_read_b64_tr_b16 v[88:89], v102 offset:28672
v_mfma_f32_16x16x32_bf16 v[32:35], v[68:71], a[52:55], v[32:35]
ds_read_b64_tr_b16 v[90:91], v102 offset:30720
s_waitcnt lgkmcnt(8)
v_mfma_f32_16x16x32_bf16 v[20:23], v[72:75], a[48:51], v[20:23]
ds_read_b64_tr_b16 v[92:93], v103 offset:28672
v_mfma_f32_16x16x32_bf16 v[36:39], v[72:75], a[52:55], v[36:39]
ds_read_b64_tr_b16 v[94:95], v103 offset:30720
s_waitcnt lgkmcnt(8)
v_mfma_f32_16x16x32_bf16 v[56:59], v[76:79], v[76:79], v[56:59]
ds_read_b64_tr_b16 v[96:97], v104 offset:28672
ds_read_b64_tr_b16 v[98:99], v104 offset:30720
s_waitcnt lgkmcnt(8)
v_mfma_f32_16x16x32_bf16 v[8:11], v[80:83], a[56:59], v[8:11]
ds_read_b64_tr_b16 v[60:61], v100 offset:32768
v_mfma_f32_16x16x32_bf16 v[24:27], v[80:83], a[60:63], v[24:27]
ds_read_b64_tr_b16 v[62:63], v100 offset:34816
s_waitcnt lgkmcnt(8)
v_mfma_f32_16x16x32_bf16 v[12:15], v[84:87], a[56:59], v[12:15]
ds_read_b64_tr_b16 v[64:65], v101 offset:32768
v_mfma_f32_16x16x32_bf16 v[28:31], v[84:87], a[60:63], v[28:31]
ds_read_b64_tr_b16 v[66:67], v101 offset:34816
s_waitcnt lgkmcnt(8)
v_mfma_f32_16x16x32_bf16 v[16:19], v[88:91], a[56:59], v[16:19]
ds_read_b64_tr_b16 v[68:69], v102 offset:32768
v_mfma_f32_16x16x32_bf16 v[32:35], v[88:91], a[60:63], v[32:35]
ds_read_b64_tr_b16 v[70:71], v102 offset:34816
s_waitcnt lgkmcnt(8)
v_mfma_f32_16x16x32_bf16 v[20:23], v[92:95], a[56:59], v[20:23]
ds_read_b64_tr_b16 v[72:73], v103 offset:32768
v_mfma_f32_16x16x32_bf16 v[36:39], v[92:95], a[60:63], v[36:39]
ds_read_b64_tr_b16 v[74:75], v103 offset:34816
s_waitcnt lgkmcnt(8)
v_mfma_f32_16x16x32_bf16 v[56:59], v[96:99], v[96:99], v[56:59]
ds_read_b64_tr_b16 v[76:77], v104 offset:32768
ds_read_b64_tr_b16 v[78:79], v104 offset:34816
s_waitcnt vmcnt(0)
s_barrier
s_waitcnt lgkmcnt(8)
v_mfma_f32_16x16x32_bf16 v[8:11], v[60:63], a[64:67], v[8:11]
ds_read_b64_tr_b16 v[80:81], v100 offset:36864
v_mfma_f32_16x16x32_bf16 v[24:27], v[60:63], a[68:71], v[24:27]
ds_read_b64_tr_b16 v[82:83], v100 offset:38912
s_waitcnt lgkmcnt(8)
v_mfma_f32_16x16x32_bf16 v[12:15], v[64:67], a[64:67], v[12:15]
ds_read_b64_tr_b16 v[84:85], v101 offset:36864
v_mfma_f32_16x16x32_bf16 v[28:31], v[64:67], a[68:71], v[28:31]
ds_read_b64_tr_b16 v[86:87], v101 offset:38912
s_waitcnt lgkmcnt(8)
v_mfma_f32_16x16x32_bf16 v[16:19], v[68:71], a[64:67], v[16:19]
ds_read_b64_tr_b16 v[88:89], v102 offset:36864
v_mfma_f32_16x16x32_bf16 v[32:35], v[68:71], a[68:71], v[32:35]
ds_read_b64_tr_b16 v[90:91], v102 offset:38912
s_waitcnt lgkmcnt(8)
v_mfma_f32_16x16x32_bf16 v[20:23], v[72:75], a[64:67], v[20:23]
ds_read_b64_tr_b16 v[92:93], v103 offset:36864
v_mfma_f32_16x16x32_bf16 v[36:39], v[72:75], a[68:71], v[36:39]
ds_read_b64_tr_b16 v[94:95], v103 offset:38912
s_waitcnt lgkmcnt(8)
v_mfma_f32_16x16x32_bf16 v[56:59], v[76:79], v[76:79], v[56:59]
ds_read_b64_tr_b16 v[96:97], v104 offset:36864
ds_read_b64_tr_b16 v[98:99], v104 offset:38912
s_waitcnt lgkmcnt(8)
v_mfma_f32_16x16x32_bf16 v[8:11], v[80:83], a[72:75], v[8:11]
ds_read_b64_tr_b16 v[60:61], v100 offset:40960
v_mfma_f32_16x16x32_bf16 v[24:27], v[80:83], a[76:79], v[24:27]
ds_read_b64_tr_b16 v[62:63], v100 offset:43008
s_waitcnt lgkmcnt(8)
v_mfma_f32_16x16x32_bf16 v[12:15], v[84:87], a[72:75], v[12:15]
ds_read_b64_tr_b16 v[64:65], v101 offset:40960
v_mfma_f32_16x16x32_bf16 v[28:31], v[84:87], a[76:79], v[28:31]
ds_read_b64_tr_b16 v[66:67], v101 offset:43008
s_waitcnt lgkmcnt(8)
v_mfma_f32_16x16x32_bf16 v[16:19], v[88:91], a[72:75], v[16:19]
ds_read_b64_tr_b16 v[68:69], v102 offset:40960
v_mfma_f32_16x16x32_bf16 v[32:35], v[88:91], a[76:79], v[32:35]
ds_read_b64_tr_b16 v[70:71], v102 offset:43008
s_waitcnt lgkmcnt(8)
v_mfma_f32_16x16x32_bf16 v[20:23], v[92:95], a[72:75], v[20:23]
ds_read_b64_tr_b16 v[72:73], v103 offset:40960
v_mfma_f32_16x16x32_bf16 v[36:39], v[92:95], a[76:79], v[36:39]
ds_read_b64_tr_b16 v[74:75], v103 offset:43008
s_waitcnt lgkmcnt(8)
v_mfma_f32_16x16x32_bf16 v[56:59], v[96:99], v[96:99], v[56:59]
ds_read_b64_tr_b16 v[76:77], v104 offset:40960
ds_read_b64_tr_b16 v[78:79], v104 offset:43008
s_waitcnt lgkmcnt(8)
v_mfma_f32_16x16x32_bf16 v[8:11], v[60:63], a[80:83], v[8:11]
ds_read_b64_tr_b16 v[80:81], v100 offset:45056
v_mfma_f32_16x16x32_bf16 v[24:27], v[60:63], a[84:87], v[24:27]
ds_read_b64_tr_b16 v[82:83], v100 offset:47104
s_waitcnt lgkmcnt(8)
v_mfma_f32_16x16x32_bf16 v[12:15], v[64:67], a[80:83], v[12:15]
ds_read_b64_tr_b16 v[84:85], v101 offset:45056
v_mfma_f32_16x16x32_bf16 v[28:31], v[64:67], a[84:87], v[28:31]
ds_read_b64_tr_b16 v[86:87], v101 offset:47104
s_waitcnt lgkmcnt(8)
v_mfma_f32_16x16x32_bf16 v[16:19], v[68:71], a[80:83], v[16:19]
ds_read_b64_tr_b16 v[88:89], v102 offset:45056
v_mfma_f32_16x16x32_bf16 v[32:35], v[68:71], a[84:87], v[32:35]
ds_read_b64_tr_b16 v[90:91], v102 offset:47104
s_waitcnt lgkmcnt(8)
v_mfma_f32_16x16x32_bf16 v[20:23], v[72:75], a[80:83], v[20:23]
ds_read_b64_tr_b16 v[92:93], v103 offset:45056
v_mfma_f32_16x16x32_bf16 v[36:39], v[72:75], a[84:87], v[36:39]
ds_read_b64_tr_b16 v[94:95], v103 offset:47104
s_waitcnt lgkmcnt(8)
v_mfma_f32_16x16x32_bf16 v[56:59], v[76:79], v[76:79], v[56:59]
ds_read_b64_tr_b16 v[96:97], v104 offset:45056
ds_read_b64_tr_b16 v[98:99], v104 offset:47104
s_waitcnt lgkmcnt(8)
v_mfma_f32_16x16x32_bf16 v[8:11], v[80:83], a[88:91], v[8:11]
ds_read_b64_tr_b16 v[60:61], v100 offset:49152
v_mfma_f32_16x16x32_bf16 v[24:27], v[80:83], a[92:95], v[24:27]
ds_read_b64_tr_b16 v[62:63], v100 offset:51200
s_waitcnt lgkmcnt(8)
v_mfma_f32_16x16x32_bf16 v[12:15], v[84:87], a[88:91], v[12:15]
ds_read_b64_tr_b16 v[64:65], v101 offset:49152
v_mfma_f32_16x16x32_bf16 v[28:31], v[84:87], a[92:95], v[28:31]
ds_read_b64_tr_b16 v[66:67], v101 offset:51200
s_waitcnt lgkmcnt(8)
v_mfma_f32_16x16x32_bf16 v[16:19], v[88:91], a[88:91], v[16:19]
ds_read_b64_tr_b16 v[68:69], v102 offset:49152
v_mfma_f32_16x16x32_bf16 v[32:35], v[88:91], a[92:95], v[32:35]
ds_read_b64_tr_b16 v[70:71], v102 offset:51200
s_waitcnt lgkmcnt(8)
v_mfma_f32_16x16x32_bf16 v[20:23], v[92:95], a[88:91], v[20:23]
ds_read_b64_tr_b16 v[72:73], v103 offset:49152
v_mfma_f32_16x16x32_bf16 v[36:39], v[92:95], a[92:95], v[36:39]
ds_read_b64_tr_b16 v[74:75], v103 offset:51200
s_waitcnt lgkmcnt(8)
v_mfma_f32_16x16x32_bf16 v[56:59], v[96:99], v[96:99], v[56:59]
ds_read_b64_tr_b16 v[76:77], v104 offset:49152
ds_read_b64_tr_b16 v[78:79], v104 offset:51200
s_waitcnt lgkmcnt(8)
v_mfma_f32_16x16x32_bf16 v[8:11], v[60:63], a[96:99], v[8:11]
ds_read_b64_tr_b16 v[80:81], v100 offset:53248
v_mfma_f32_16x16x32_bf16 v[24:27], v[60:63], a[100:103], v[24:27]
ds_read_b64_tr_b16 v[82:83], v100 offset:55296
s_waitcnt lgkmcnt(8)
v_mfma_f32_16x16x32_bf16 v[12:15], v[64:67], a[96:99], v[12:15]
ds_read_b64_tr_b16 v[84:85], v101 offset:53248
v_mfma_f32_16x16x32_bf16 v[28:31], v[64:67], a[100:103], v[28:31]
ds_read_b64_tr_b16 v[86:87], v101 offset:55296
s_waitcnt lgkmcnt(8)
v_mfma_f32_16x16x32_bf16 v[16:19], v[68:71], a[96:99], v[16:19]
ds_read_b64_tr_b16 v[88:89], v102 offset:53248
v_mfma_f32_16x16x32_bf16 v[32:35], v[68:71], a[100:103], v[32:35]
ds_read_b64_tr_b16 v[90:91], v102 offset:55296
s_waitcnt lgkmcnt(8)
v_mfma_f32_16x16x32_bf16 v[20:23], v[72:75], a[96:99], v[20:23]
ds_read_b64_tr_b16 v[92:93], v103 offset:53248
v_mfma_f32_16x16x32_bf16 v[36:39], v[72:75], a[100:103], v[36:39]
ds_read_b64_tr_b16 v[94:95], v103 offset:55296
s_waitcnt lgkmcnt(8)
v_mfma_f32_16x16x32_bf16 v[56:59], v[76:79], v[76:79], v[56:59]
ds_read_b64_tr_b16 v[96:97], v104 offset:53248
ds_read_b64_tr_b16 v[98:99], v104 offset:55296
s_waitcnt lgkmcnt(8)
v_mfma_f32_16x16x32_bf16 v[8:11], v[80:83], a[104:107], v[8:11]
v_mfma_f32_16x16x32_bf16 v[24:27], v[80:83], a[108:111], v[24:27]
s_waitcnt lgkmcnt(6)
v_mfma_f32_16x16x32_bf16 v[12:15], v[84:87], a[104:107], v[12:15]
v_mfma_f32_16x16x32_bf16 v[28:31], v[84:87], a[108:111], v[28:31]
s_waitcnt lgkmcnt(4)
v_mfma_f32_16x16x32_bf16 v[16:19], v[88:91], a[104:107], v[16:19]
v_mfma_f32_16x16x32_bf16 v[32:35], v[88:91], a[108:111], v[32:35]
s_waitcnt lgkmcnt(2)
v_mfma_f32_16x16x32_bf16 v[20:23], v[92:95], a[104:107], v[20:23]
v_mfma_f32_16x16x32_bf16 v[36:39], v[92:95], a[108:111], v[36:39]
s_waitcnt lgkmcnt(0)
v_mfma_f32_16x16x32_bf16 v[56:59], v[96:99], v[96:99], v[56:59]
v_and_b32 v159, 3, v1
v_lshlrev_b32 v158, 3, v4
v_lshl_add_u32 v158, v159, 1, v158
s_lshl_b32 s28, s20, 5
v_add_u32 v158, s28, v158
ds_read_u16 v156, v158 offset:128
v_cmp_eq_u32 s[50:51], 1, v159
v_cmp_eq_u32 s[52:53], 2, v159
v_cmp_eq_u32 s[54:55], 3, v159
v_lshlrev_b32 v158, 6, v4
v_lshl_add_u32 v158, v159, 2, v158
s_lshl_b32 s28, s20, 4
v_add_u32 v158, s28, v158
v_lshrrev_b32 v160, 2, v3
v_cmp_eq_u32 vcc, v160, v4
v_cndmask_b32 v157, v56, v57, s[50:51]
v_cndmask_b32 v157, v157, v58, s[52:53]
v_cndmask_b32 v157, v157, v59, s[54:55]
s_waitcnt lgkmcnt(0)
v_lshlrev_b32 v156, 16, v156
v_fma_f32 v157, -v156, v156, v157
v_max_f32 v157, 0, v157
v_mov_b32 v160, 0x3627c5ac
v_fmac_f32 v160, 0x3a124925, v157
v_rsq_f32 v160, v160
v_mul_f32 v156, 0x3d41848f, v156
s_and_saveexec_b64 s[56:57], vcc
ds_write2st64_b32 v158, v160, v156 offset0:224 offset1:225
s_mov_b64 exec, s[56:57]
v_lshlrev_b32 v158, 6, v4
s_waitcnt lgkmcnt(0)
s_barrier
ds_read_b128 v[106:109], v158 offset:57344
ds_read_b128 v[110:113], v158 offset:57360
ds_read_b128 v[114:117], v158 offset:57376
ds_read_b128 v[118:121], v158 offset:57392
ds_read_b128 v[122:125], v158 offset:57600
ds_read_b128 v[126:129], v158 offset:57616
ds_read_b128 v[130:133], v158 offset:57632
ds_read_b128 v[134:137], v158 offset:57648
s_waitcnt lgkmcnt(7)
v_pk_mul_f32 v[8:9], v[8:9], v[106:107]
v_pk_mul_f32 v[24:25], v[24:25], v[106:107]
v_pk_mul_f32 v[10:11], v[10:11], v[108:109]
v_pk_mul_f32 v[26:27], v[26:27], v[108:109]
v_fmac_f32 v9, v190, v8
v_fmac_f32 v25, v190, v24
v_fma_f32 v9, -v206, v24, v9
v_fmac_f32 v25, v206, v8
v_fmac_f32 v10, v190, v9
v_fmac_f32 v26, v190, v25
v_fma_f32 v10, -v206, v25, v10
v_fmac_f32 v26, v206, v9
v_fmac_f32 v11, v190, v10
v_fmac_f32 v27, v190, v26
v_fma_f32 v11, -v206, v26, v11
v_fmac_f32 v27, v206, v10
s_waitcnt lgkmcnt(6)
v_pk_mul_f32 v[12:13], v[12:13], v[110:111]
v_pk_mul_f32 v[28:29], v[28:29], v[110:111]
v_pk_mul_f32 v[14:15], v[14:15], v[112:113]
v_pk_mul_f32 v[30:31], v[30:31], v[112:113]
v_fmac_f32 v12, v190, v11
v_fmac_f32 v28, v190, v27
v_fma_f32 v12, -v206, v27, v12
v_fmac_f32 v28, v206, v11
v_fmac_f32 v13, v190, v12
v_fmac_f32 v29, v190, v28
v_fma_f32 v13, -v206, v28, v13
v_fmac_f32 v29, v206, v12
v_fmac_f32 v14, v190, v13
v_fmac_f32 v30, v190, v29
v_fma_f32 v14, -v206, v29, v14
v_fmac_f32 v30, v206, v13
v_fmac_f32 v15, v190, v14
v_fmac_f32 v31, v190, v30
v_fma_f32 v15, -v206, v30, v15
v_fmac_f32 v31, v206, v14
s_waitcnt lgkmcnt(5)
v_pk_mul_f32 v[16:17], v[16:17], v[114:115]
v_pk_mul_f32 v[32:33], v[32:33], v[114:115]
v_pk_mul_f32 v[18:19], v[18:19], v[116:117]
v_pk_mul_f32 v[34:35], v[34:35], v[116:117]
v_fmac_f32 v16, v190, v15
v_fmac_f32 v32, v190, v31
v_fma_f32 v16, -v206, v31, v16
v_fmac_f32 v32, v206, v15
v_fmac_f32 v17, v190, v16
v_fmac_f32 v33, v190, v32
v_fma_f32 v17, -v206, v32, v17
v_fmac_f32 v33, v206, v16
v_fmac_f32 v18, v190, v17
v_fmac_f32 v34, v190, v33
v_fma_f32 v18, -v206, v33, v18
v_fmac_f32 v34, v206, v17
v_fmac_f32 v19, v190, v18
v_fmac_f32 v35, v190, v34
v_fma_f32 v19, -v206, v34, v19
v_fmac_f32 v35, v206, v18
s_waitcnt lgkmcnt(4)
v_pk_mul_f32 v[20:21], v[20:21], v[118:119]
v_pk_mul_f32 v[36:37], v[36:37], v[118:119]
v_pk_mul_f32 v[22:23], v[22:23], v[120:121]
v_pk_mul_f32 v[38:39], v[38:39], v[120:121]
v_fmac_f32 v20, v190, v19
v_fmac_f32 v36, v190, v35
v_fma_f32 v20, -v206, v35, v20
v_fmac_f32 v36, v206, v19
v_fmac_f32 v21, v190, v20
v_fmac_f32 v37, v190, v36
v_fma_f32 v21, -v206, v36, v21
v_fmac_f32 v37, v206, v20
v_fmac_f32 v22, v190, v21
v_fmac_f32 v38, v190, v37
v_fma_f32 v22, -v206, v37, v22
v_fmac_f32 v38, v206, v21
v_fmac_f32 v23, v190, v22
v_fmac_f32 v39, v190, v38
v_fma_f32 v23, -v206, v38, v23
v_fmac_f32 v39, v206, v22
v_mov_b32 v156, v23
v_mov_b32 v157, v23
v_mov_b32 v160, v39
v_mov_b32 v161, v39
s_lshl_b32 s28, s24, 2
s_add_u32 s28, s28, s20
s_lshl_b32 s28, s28, 7
s_mul_i32 s33, s23, 3584
s_add_u32 s33, s33, s28
v_permlane16_swap_b32 v156, v157
v_permlane16_swap_b32 v160, v161
v_mov_b32 v158, v156
v_mov_b32 v164, v157
v_mov_b32 v162, v160
v_mov_b32 v165, v161
v_lshlrev_b32 v166, 3, v3
v_permlane32_swap_b32 v156, v158
v_permlane32_swap_b32 v157, v164
v_permlane32_swap_b32 v160, v162
v_permlane32_swap_b32 v161, v165
v_fmac_f32 v157, v205, v156
v_fmac_f32 v161, v205, v160
v_fma_f32 v157, -v221, v160, v157
v_fmac_f32 v161, v221, v156
v_fmac_f32 v158, v205, v157
v_fmac_f32 v162, v205, v161
v_fma_f32 v158, -v221, v161, v158
v_fmac_f32 v162, v221, v157
v_fmac_f32 v164, v205, v158
v_fmac_f32 v165, v205, v162
v_fma_f32 v164, -v221, v162, v164
v_fmac_f32 v165, v221, v158
v_cmp_u_f32 vcc, v164, v165
s_cbranch_vccz ok_33
s_add_u32 s36, s36, 1
s_cmp_gt_u32 s36, 256
s_cbranch_scc1 ok_33
s_waitcnt vmcnt(0) lgkmcnt(0)
s_barrier
s_branch SC_redo1
ok_33:
s_mov_b64 exec, 0xffff
buffer_store_dwordx2 v[164:165], v166, s[12:15], s33 offen sc1
s_mov_b64 exec, -1
v_cndmask_b32 v154, 0, v156, s[44:45]
v_cndmask_b32 v154, v154, v157, s[46:47]
v_cndmask_b32 v154, v154, v158, s[48:49]
v_cndmask_b32 v155, 0, v160, s[44:45]
v_cndmask_b32 v155, v155, v161, s[46:47]
v_cndmask_b32 v155, v155, v162, s[48:49]
v_mul_u32_u24 v159, 3584, v4
v_sub_u32 v168, v166, v159
s_sub_u32 s33, s33, 3584
v_add_u32 v168, s33, v168
v_subrev_u32 v169, 14336, v168
v_subrev_u32 v170, 28672, v168
v_subrev_u32 v171, 43008, v168
v_subrev_u32 v172, 57344, v168
v_subrev_u32 v173, 71680, v168
v_subrev_u32 v174, 86016, v168
v_subrev_u32 v175, 100352, v168
ds_read_b64_tr_b16 v[60:61], v100 offset:0
ds_read_b64_tr_b16 v[62:63], v100 offset:2048
ds_read_b64_tr_b16 v[64:65], v101 offset:0
ds_read_b64_tr_b16 v[66:67], v101 offset:2048
ds_read_b64_tr_b16 v[68:69], v102 offset:0
ds_read_b64_tr_b16 v[70:71], v102 offset:2048
ds_read_b64_tr_b16 v[72:73], v103 offset:0
ds_read_b64_tr_b16 v[74:75], v103 offset:2048
s_waitcnt lgkmcnt(6)
v_mfma_f32_16x16x32_bf16 v[40:43], v[60:63], a[112:115], 0
ds_read_b64_tr_b16 v[80:81], v100 offset:4096
ds_read_b64_tr_b16 v[82:83], v100 offset:6144
s_waitcnt lgkmcnt(6)
v_mfma_f32_16x16x32_bf16 v[44:47], v[64:67], a[112:115], 0
ds_read_b64_tr_b16 v[84:85], v101 offset:4096
ds_read_b64_tr_b16 v[86:87], v101 offset:6144
s_waitcnt lgkmcnt(6)
v_mfma_f32_16x16x32_bf16 v[48:51], v[68:71], a[112:115], 0
ds_read_b64_tr_b16 v[88:89], v102 offset:4096
ds_read_b64_tr_b16 v[90:91], v102 offset:6144
s_waitcnt lgkmcnt(6)
v_mfma_f32_16x16x32_bf16 v[52:55], v[72:75], a[112:115], 0
ds_read_b64_tr_b16 v[92:93], v103 offset:4096
ds_read_b64_tr_b16 v[94:95], v103 offset:6144
s_waitcnt lgkmcnt(6)
v_mfma_f32_16x16x32_bf16 v[40:43], v[80:83], a[116:119], v[40:43]
ds_read_b64_tr_b16 v[60:61], v100 offset:8192
ds_read_b64_tr_b16 v[62:63], v100 offset:10240
s_waitcnt lgkmcnt(6)
v_mfma_f32_16x16x32_bf16 v[44:47], v[84:87], a[116:119], v[44:47]
ds_read_b64_tr_b16 v[64:65], v101 offset:8192
ds_read_b64_tr_b16 v[66:67], v101 offset:10240
s_waitcnt lgkmcnt(6)
v_mfma_f32_16x16x32_bf16 v[48:51], v[88:91], a[116:119], v[48:51]
ds_read_b64_tr_b16 v[68:69], v102 offset:8192
ds_read_b64_tr_b16 v[70:71], v102 offset:10240
s_waitcnt lgkmcnt(6)
v_mfma_f32_16x16x32_bf16 v[52:55], v[92:95], a[116:119], v[52:55]
ds_read_b64_tr_b16 v[72:73], v103 offset:8192
ds_read_b64_tr_b16 v[74:75], v103 offset:10240
s_waitcnt lgkmcnt(6)
v_mfma_f32_16x16x32_bf16 v[40:43], v[60:63], a[120:123], v[40:43]
ds_read_b64_tr_b16 v[80:81], v100 offset:12288
ds_read_b64_tr_b16 v[82:83], v100 offset:14336
s_waitcnt lgkmcnt(6)
v_mfma_f32_16x16x32_bf16 v[44:47], v[64:67], a[120:123], v[44:47]
ds_read_b64_tr_b16 v[84:85], v101 offset:12288
ds_read_b64_tr_b16 v[86:87], v101 offset:14336
s_waitcnt lgkmcnt(6)
v_mfma_f32_16x16x32_bf16 v[48:51], v[68:71], a[120:123], v[48:51]
ds_read_b64_tr_b16 v[88:89], v102 offset:12288
ds_read_b64_tr_b16 v[90:91], v102 offset:14336
s_waitcnt lgkmcnt(6)
v_mfma_f32_16x16x32_bf16 v[52:55], v[72:75], a[120:123], v[52:55]
ds_read_b64_tr_b16 v[92:93], v103 offset:12288
ds_read_b64_tr_b16 v[94:95], v103 offset:14336
s_waitcnt lgkmcnt(6)
v_mfma_f32_16x16x32_bf16 v[40:43], v[80:83], a[124:127], v[40:43]
ds_read_b64_tr_b16 v[60:61], v100 offset:16384
ds_read_b64_tr_b16 v[62:63], v100 offset:18432
s_waitcnt lgkmcnt(6)
v_mfma_f32_16x16x32_bf16 v[44:47], v[84:87], a[124:127], v[44:47]
ds_read_b64_tr_b16 v[64:65], v101 offset:16384
ds_read_b64_tr_b16 v[66:67], v101 offset:18432
s_waitcnt lgkmcnt(6)
v_mfma_f32_16x16x32_bf16 v[48:51], v[88:91], a[124:127], v[48:51]
ds_read_b64_tr_b16 v[68:69], v102 offset:16384
ds_read_b64_tr_b16 v[70:71], v102 offset:18432
s_waitcnt lgkmcnt(6)
v_mfma_f32_16x16x32_bf16 v[52:55], v[92:95], a[124:127], v[52:55]
ds_read_b64_tr_b16 v[72:73], v103 offset:16384
ds_read_b64_tr_b16 v[74:75], v103 offset:18432
s_waitcnt lgkmcnt(6)
v_mfma_f32_16x16x32_bf16 v[40:43], v[60:63], a[128:131], v[40:43]
ds_read_b64_tr_b16 v[80:81], v100 offset:20480
ds_read_b64_tr_b16 v[82:83], v100 offset:22528
s_waitcnt lgkmcnt(6)
v_mfma_f32_16x16x32_bf16 v[44:47], v[64:67], a[128:131], v[44:47]
ds_read_b64_tr_b16 v[84:85], v101 offset:20480
ds_read_b64_tr_b16 v[86:87], v101 offset:22528
s_waitcnt lgkmcnt(6)
v_mfma_f32_16x16x32_bf16 v[48:51], v[68:71], a[128:131], v[48:51]
ds_read_b64_tr_b16 v[88:89], v102 offset:20480
ds_read_b64_tr_b16 v[90:91], v102 offset:22528
s_waitcnt lgkmcnt(6)
v_mfma_f32_16x16x32_bf16 v[52:55], v[72:75], a[128:131], v[52:55]
ds_read_b64_tr_b16 v[92:93], v103 offset:20480
ds_read_b64_tr_b16 v[94:95], v103 offset:22528
s_waitcnt lgkmcnt(6)
v_mfma_f32_16x16x32_bf16 v[40:43], v[80:83], a[132:135], v[40:43]
ds_read_b64_tr_b16 v[60:61], v100 offset:24576
ds_read_b64_tr_b16 v[62:63], v100 offset:26624
s_waitcnt lgkmcnt(6)
v_mfma_f32_16x16x32_bf16 v[44:47], v[84:87], a[132:135], v[44:47]
ds_read_b64_tr_b16 v[64:65], v101 offset:24576
ds_read_b64_tr_b16 v[66:67], v101 offset:26624
s_waitcnt lgkmcnt(6)
v_mfma_f32_16x16x32_bf16 v[48:51], v[88:91], a[132:135], v[48:51]
ds_read_b64_tr_b16 v[68:69], v102 offset:24576
ds_read_b64_tr_b16 v[70:71], v102 offset:26624
s_waitcnt lgkmcnt(6)
v_mfma_f32_16x16x32_bf16 v[52:55], v[92:95], a[132:135], v[52:55]
ds_read_b64_tr_b16 v[72:73], v103 offset:24576
ds_read_b64_tr_b16 v[74:75], v103 offset:26624
s_waitcnt lgkmcnt(6)
v_mfma_f32_16x16x32_bf16 v[40:43], v[60:63], a[136:139], v[40:43]
ds_read_b64_tr_b16 v[80:81], v100 offset:28672
ds_read_b64_tr_b16 v[82:83], v100 offset:30720
s_waitcnt lgkmcnt(6)
v_mfma_f32_16x16x32_bf16 v[44:47], v[64:67], a[136:139], v[44:47]
ds_read_b64_tr_b16 v[84:85], v101 offset:28672
ds_read_b64_tr_b16 v[86:87], v101 offset:30720
s_waitcnt lgkmcnt(6)
v_mfma_f32_16x16x32_bf16 v[48:51], v[68:71], a[136:139], v[48:51]
ds_read_b64_tr_b16 v[88:89], v102 offset:28672
ds_read_b64_tr_b16 v[90:91], v102 offset:30720
s_waitcnt lgkmcnt(6)
v_mfma_f32_16x16x32_bf16 v[52:55], v[72:75], a[136:139], v[52:55]
ds_read_b64_tr_b16 v[92:93], v103 offset:28672
ds_read_b64_tr_b16 v[94:95], v103 offset:30720
s_waitcnt lgkmcnt(6)
v_mfma_f32_16x16x32_bf16 v[40:43], v[80:83], a[140:143], v[40:43]
ds_read_b64_tr_b16 v[60:61], v100 offset:32768
ds_read_b64_tr_b16 v[62:63], v100 offset:34816
s_waitcnt lgkmcnt(6)
v_mfma_f32_16x16x32_bf16 v[44:47], v[84:87], a[140:143], v[44:47]
ds_read_b64_tr_b16 v[64:65], v101 offset:32768
ds_read_b64_tr_b16 v[66:67], v101 offset:34816
s_waitcnt lgkmcnt(6)
v_mfma_f32_16x16x32_bf16 v[48:51], v[88:91], a[140:143], v[48:51]
ds_read_b64_tr_b16 v[68:69], v102 offset:32768
ds_read_b64_tr_b16 v[70:71], v102 offset:34816
s_waitcnt lgkmcnt(6)
v_mfma_f32_16x16x32_bf16 v[52:55], v[92:95], a[140:143], v[52:55]
ds_read_b64_tr_b16 v[72:73], v103 offset:32768
ds_read_b64_tr_b16 v[74:75], v103 offset:34816
s_waitcnt lgkmcnt(6)
v_mfma_f32_16x16x32_bf16 v[40:43], v[60:63], a[144:147], v[40:43]
ds_read_b64_tr_b16 v[80:81], v100 offset:36864
ds_read_b64_tr_b16 v[82:83], v100 offset:38912
s_waitcnt lgkmcnt(6)
v_mfma_f32_16x16x32_bf16 v[44:47], v[64:67], a[144:147], v[44:47]
ds_read_b64_tr_b16 v[84:85], v101 offset:36864
ds_read_b64_tr_b16 v[86:87], v101 offset:38912
s_waitcnt lgkmcnt(6)
v_mfma_f32_16x16x32_bf16 v[48:51], v[68:71], a[144:147], v[48:51]
ds_read_b64_tr_b16 v[88:89], v102 offset:36864
ds_read_b64_tr_b16 v[90:91], v102 offset:38912
s_waitcnt lgkmcnt(6)
v_mfma_f32_16x16x32_bf16 v[52:55], v[72:75], a[144:147], v[52:55]
ds_read_b64_tr_b16 v[92:93], v103 offset:36864
ds_read_b64_tr_b16 v[94:95], v103 offset:38912
buffer_load_dwordx2 v[138:139], v168, s[12:15], 0 offen sc1
buffer_load_dwordx2 v[140:141], v169, s[12:15], 0 offen sc1
buffer_load_dwordx2 v[142:143], v170, s[12:15], 0 offen sc1
buffer_load_dwordx2 v[144:145], v171, s[12:15], 0 offen sc1
buffer_load_dwordx2 v[146:147], v172, s[12:15], 0 offen sc1
buffer_load_dwordx2 v[148:149], v173, s[12:15], 0 offen sc1
buffer_load_dwordx2 v[150:151], v174, s[12:15], 0 offen sc1
buffer_load_dwordx2 v[152:153], v175, s[12:15], 0 offen sc1
s_waitcnt lgkmcnt(6)
v_mfma_f32_16x16x32_bf16 v[40:43], v[80:83], a[148:151], v[40:43]
ds_read_b64_tr_b16 v[60:61], v100 offset:40960
ds_read_b64_tr_b16 v[62:63], v100 offset:43008
s_waitcnt lgkmcnt(6)
v_mfma_f32_16x16x32_bf16 v[44:47], v[84:87], a[148:151], v[44:47]
ds_read_b64_tr_b16 v[64:65], v101 offset:40960
ds_read_b64_tr_b16 v[66:67], v101 offset:43008
s_waitcnt lgkmcnt(6)
v_mfma_f32_16x16x32_bf16 v[48:51], v[88:91], a[148:151], v[48:51]
ds_read_b64_tr_b16 v[68:69], v102 offset:40960
ds_read_b64_tr_b16 v[70:71], v102 offset:43008
s_waitcnt lgkmcnt(6)
v_mfma_f32_16x16x32_bf16 v[52:55], v[92:95], a[148:151], v[52:55]
ds_read_b64_tr_b16 v[72:73], v103 offset:40960
ds_read_b64_tr_b16 v[74:75], v103 offset:43008
s_waitcnt lgkmcnt(6)
v_mfma_f32_16x16x32_bf16 v[40:43], v[60:63], a[152:155], v[40:43]
ds_read_b64_tr_b16 v[80:81], v100 offset:45056
ds_read_b64_tr_b16 v[82:83], v100 offset:47104
s_waitcnt lgkmcnt(6)
v_mfma_f32_16x16x32_bf16 v[44:47], v[64:67], a[152:155], v[44:47]
ds_read_b64_tr_b16 v[84:85], v101 offset:45056
ds_read_b64_tr_b16 v[86:87], v101 offset:47104
s_waitcnt lgkmcnt(6)
v_mfma_f32_16x16x32_bf16 v[48:51], v[68:71], a[152:155], v[48:51]
ds_read_b64_tr_b16 v[88:89], v102 offset:45056
ds_read_b64_tr_b16 v[90:91], v102 offset:47104
s_waitcnt lgkmcnt(6)
v_mfma_f32_16x16x32_bf16 v[52:55], v[72:75], a[152:155], v[52:55]
ds_read_b64_tr_b16 v[92:93], v103 offset:45056
ds_read_b64_tr_b16 v[94:95], v103 offset:47104
s_waitcnt lgkmcnt(6)
v_mfma_f32_16x16x32_bf16 v[40:43], v[80:83], a[156:159], v[40:43]
ds_read_b64_tr_b16 v[60:61], v100 offset:49152
ds_read_b64_tr_b16 v[62:63], v100 offset:51200
s_waitcnt lgkmcnt(6)
v_mfma_f32_16x16x32_bf16 v[44:47], v[84:87], a[156:159], v[44:47]
ds_read_b64_tr_b16 v[64:65], v101 offset:49152
ds_read_b64_tr_b16 v[66:67], v101 offset:51200
s_waitcnt lgkmcnt(6)
v_mfma_f32_16x16x32_bf16 v[48:51], v[88:91], a[156:159], v[48:51]
ds_read_b64_tr_b16 v[68:69], v102 offset:49152
ds_read_b64_tr_b16 v[70:71], v102 offset:51200
s_waitcnt lgkmcnt(6)
v_mfma_f32_16x16x32_bf16 v[52:55], v[92:95], a[156:159], v[52:55]
ds_read_b64_tr_b16 v[72:73], v103 offset:49152
ds_read_b64_tr_b16 v[74:75], v103 offset:51200
s_waitcnt lgkmcnt(6)
v_mfma_f32_16x16x32_bf16 v[40:43], v[60:63], a[160:163], v[40:43]
ds_read_b64_tr_b16 v[80:81], v100 offset:53248
ds_read_b64_tr_b16 v[82:83], v100 offset:55296
s_waitcnt lgkmcnt(6)
v_mfma_f32_16x16x32_bf16 v[44:47], v[64:67], a[160:163], v[44:47]
ds_read_b64_tr_b16 v[84:85], v101 offset:53248
ds_read_b64_tr_b16 v[86:87], v101 offset:55296
s_waitcnt lgkmcnt(6)
v_mfma_f32_16x16x32_bf16 v[48:51], v[68:71], a[160:163], v[48:51]
ds_read_b64_tr_b16 v[88:89], v102 offset:53248
ds_read_b64_tr_b16 v[90:91], v102 offset:55296
s_waitcnt lgkmcnt(6)
v_mfma_f32_16x16x32_bf16 v[52:55], v[72:75], a[160:163], v[52:55]
ds_read_b64_tr_b16 v[92:93], v103 offset:53248
ds_read_b64_tr_b16 v[94:95], v103 offset:55296
s_waitcnt lgkmcnt(6)
v_mfma_f32_16x16x32_bf16 v[40:43], v[80:83], a[164:167], v[40:43]
s_waitcnt lgkmcnt(4)
v_mfma_f32_16x16x32_bf16 v[44:47], v[84:87], a[164:167], v[44:47]
s_waitcnt lgkmcnt(2)
v_mfma_f32_16x16x32_bf16 v[48:51], v[88:91], a[164:167], v[48:51]
s_waitcnt lgkmcnt(0)
v_mfma_f32_16x16x32_bf16 v[52:55], v[92:95], a[164:167], v[52:55]
v_lshlrev_b32 v159, 2, v4
v_xor_b32 v159, v159, v3
v_lshlrev_b32 v159, 4, v159
v_lshl_add_u32 v159, v3, 8, v159
s_lshl_b32 s28, s20, 12
s_add_u32 s28, s28, 114688
v_add_u32 v159, s28, v159
v_sub_f32 v122, v40, v122
v_mul_f32 v106, v106, v228
v_fmac_f32 v40, v106, v122
v_sub_f32 v123, v41, v123
v_mul_f32 v107, v107, v228
v_fmac_f32 v41, v107, v123
v_sub_f32 v124, v42, v124
v_mul_f32 v108, v108, v228
v_fmac_f32 v42, v108, v124
v_sub_f32 v125, v43, v125
v_mul_f32 v109, v109, v228
v_fmac_f32 v43, v109, v125
ds_write_b128 v159, v[40:43]
v_sub_f32 v126, v44, v126
v_mul_f32 v110, v110, v228
v_fmac_f32 v44, v110, v126
v_sub_f32 v127, v45, v127
v_mul_f32 v111, v111, v228
v_fmac_f32 v45, v111, v127
v_sub_f32 v128, v46, v128
v_mul_f32 v112, v112, v228
v_fmac_f32 v46, v112, v128
v_sub_f32 v129, v47, v129
v_mul_f32 v113, v113, v228
v_fmac_f32 v47, v113, v129
v_xor_b32 v160, 16, v159
ds_write_b128 v160, v[44:47]
v_sub_f32 v130, v48, v130
v_mul_f32 v114, v114, v228
v_fmac_f32 v48, v114, v130
v_sub_f32 v131, v49, v131
v_mul_f32 v115, v115, v228
v_fmac_f32 v49, v115, v131
v_sub_f32 v132, v50, v132
v_mul_f32 v116, v116, v228
v_fmac_f32 v50, v116, v132
v_sub_f32 v133, v51, v133
v_mul_f32 v117, v117, v228
v_fmac_f32 v51, v117, v133
v_xor_b32 v160, 32, v159
ds_write_b128 v160, v[48:51]
v_sub_f32 v134, v52, v134
v_mul_f32 v118, v118, v228
v_fmac_f32 v52, v118, v134
v_sub_f32 v135, v53, v135
v_mul_f32 v119, v119, v228
v_fmac_f32 v53, v119, v135
v_sub_f32 v136, v54, v136
v_mul_f32 v120, v120, v228
v_fmac_f32 v54, v120, v136
v_sub_f32 v137, v55, v137
v_mul_f32 v121, v121, v228
v_fmac_f32 v55, v121, v137
v_xor_b32 v160, 48, v159
ds_write_b128 v160, v[52:55]
v_lshlrev_b32 v160, 6, v3
v_lshl_add_u32 v160, v4, 4, v160
s_lshl_b32 s29, s24, 2
s_add_u32 s29, s29, s20
s_lshl_b32 s29, s29, 10
s_mul_i32 s30, s23, 114688
s_add_u32 s29, s29, s30
s_add_u32 s29, s29, 20971520
s_add_u32 s30, s29, 28672
s_add_u32 s31, s29, 57344
s_add_u32 s32, s29, 86016
s_mov_b32 s28, 0
s_waitcnt vmcnt(0)
lb_34:
v_max3_u32 v156, v138, v139, v140
v_max3_u32 v156, v156, v141, v142
v_max3_u32 v156, v156, v143, v144
v_max3_u32 v156, v156, v145, v146
v_max3_u32 v156, v156, v147, v148
v_max3_u32 v156, v156, v149, v150
v_max3_u32 v156, v156, v151, v152
v_max_u32 v156, v156, v153
v_cmp_eq_u32 vcc, -1, v156
s_cbranch_vccz lb_34_r
s_add_u32 s28, s28, 1
s_cmp_gt_u32 s28, 32768
s_cbranch_scc1 lb_34_r
buffer_load_dwordx2 v[138:139], v168, s[12:15], 0 offen sc1
buffer_load_dwordx2 v[140:141], v169, s[12:15], 0 offen sc1
buffer_load_dwordx2 v[142:143], v170, s[12:15], 0 offen sc1
buffer_load_dwordx2 v[144:145], v171, s[12:15], 0 offen sc1
buffer_load_dwordx2 v[146:147], v172, s[12:15], 0 offen sc1
buffer_load_dwordx2 v[148:149], v173, s[12:15], 0 offen sc1
buffer_load_dwordx2 v[150:151], v174, s[12:15], 0 offen sc1
buffer_load_dwordx2 v[152:153], v175, s[12:15], 0 offen sc1
s_waitcnt vmcnt(0)
s_branch lb_34
lb_34_r:
v_fmac_f32 v150, v226, v152
v_fmac_f32 v151, v226, v153
v_fma_f32 v150, -v227, v153, v150
v_fmac_f32 v151, v227, v152
v_fmac_f32 v148, v226, v150
v_fmac_f32 v149, v226, v151
v_fma_f32 v148, -v227, v151, v148
v_fmac_f32 v149, v227, v150
v_fmac_f32 v146, v226, v148
v_fmac_f32 v147, v226, v149
v_fma_f32 v146, -v227, v149, v146
v_fmac_f32 v147, v227, v148
v_fmac_f32 v144, v226, v146
v_fmac_f32 v145, v226, v147
v_fma_f32 v144, -v227, v147, v144
v_fmac_f32 v145, v227, v146
v_fmac_f32 v142, v226, v144
v_fmac_f32 v143, v226, v145
v_fma_f32 v142, -v227, v145, v142
v_fmac_f32 v143, v227, v144
v_fmac_f32 v140, v226, v142
v_fmac_f32 v141, v226, v143
v_fma_f32 v140, -v227, v143, v140
v_fmac_f32 v141, v227, v142
v_fmac_f32 v138, v226, v140
v_fmac_f32 v139, v226, v141
v_fma_f32 v138, -v227, v141, v138
v_fmac_f32 v139, v227, v140
v_mul_f32 v156, v224, v138
v_mul_f32 v157, v224, v139
v_fma_f32 v156, -v225, v139, v156
v_fmac_f32 v157, v225, v138
v_mov_b32 v158, v156
v_mov_b32 v159, v157
s_nop 0
v_permlane16_swap_b32 v156, v158
v_permlane16_swap_b32 v157, v159
v_add_f32 v156, v156, v158
v_add_f32 v157, v157, v159
v_mov_b32 v158, v156
v_mov_b32 v159, v157
s_nop 0
v_permlane32_swap_b32 v156, v158
v_permlane32_swap_b32 v157, v159
v_add_f32 v156, v156, v158
v_add_f32 v157, v157, v159
v_fmac_f32 v154, v222, v156
v_fmac_f32 v155, v222, v157
v_fma_f32 v154, -v223, v157, v154
v_fmac_f32 v155, v223, v156
s_cmp_lg_u32 s20, 0
s_cbranch_scc1 hint_35
s_lshl_b32 s59, s23, 7
s_add_u32 s59, s59, 20582400
v_mov_b32 v7, 0
v_mov_b32 v2, 1
s_mov_b32 exec_lo, 1
s_mov_b32 exec_hi, 0
buffer_atomic_add v2, v7, s[4:7], s59 offen sc1
s_mov_b64 exec, -1
hint_35:
v_pk_fma_f32 v[8:9], v[190:191], v[154:155], v[8:9] op_sel_hi:[1,0,1]
v_pk_fma_f32 v[24:25], v[190:191], v[154:155], v[24:25] op_sel:[0,1,0] op_sel_hi:[1,1,1]
v_pk_fma_f32 v[10:11], v[192:193], v[154:155], v[10:11] op_sel_hi:[1,0,1]
v_pk_fma_f32 v[26:27], v[192:193], v[154:155], v[26:27] op_sel:[0,1,0] op_sel_hi:[1,1,1]
v_pk_fma_f32 v[12:13], v[194:195], v[154:155], v[12:13] op_sel_hi:[1,0,1]
v_pk_fma_f32 v[28:29], v[194:195], v[154:155], v[28:29] op_sel:[0,1,0] op_sel_hi:[1,1,1]
v_pk_fma_f32 v[14:15], v[196:197], v[154:155], v[14:15] op_sel_hi:[1,0,1]
v_pk_fma_f32 v[30:31], v[196:197], v[154:155], v[30:31] op_sel:[0,1,0] op_sel_hi:[1,1,1]
v_pk_fma_f32 v[8:9], v[206:207], v[154:155], v[8:9] op_sel:[0,1,0] op_sel_hi:[1,1,1] neg_lo:[1,0,0] neg_hi:[1,0,0]
v_pk_fma_f32 v[24:25], v[206:207], v[154:155], v[24:25] op_sel_hi:[1,0,1]
v_pk_fma_f32 v[10:11], v[208:209], v[154:155], v[10:11] op_sel:[0,1,0] op_sel_hi:[1,1,1] neg_lo:[1,0,0] neg_hi:[1,0,0]
v_pk_fma_f32 v[26:27], v[208:209], v[154:155], v[26:27] op_sel_hi:[1,0,1]
v_pk_fma_f32 v[12:13], v[210:211], v[154:155], v[12:13] op_sel:[0,1,0] op_sel_hi:[1,1,1] neg_lo:[1,0,0] neg_hi:[1,0,0]
v_pk_fma_f32 v[28:29], v[210:211], v[154:155], v[28:29] op_sel_hi:[1,0,1]
v_pk_fma_f32 v[14:15], v[212:213], v[154:155], v[14:15] op_sel:[0,1,0] op_sel_hi:[1,1,1] neg_lo:[1,0,0] neg_hi:[1,0,0]
v_pk_fma_f32 v[30:31], v[212:213], v[154:155], v[30:31] op_sel_hi:[1,0,1]
v_cvt_pk_bf16_f32 v60, v8, v9
v_cvt_pk_bf16_f32 v68, -v24, -v25
v_cvt_pk_bf16_f32 v61, v10, v11
v_cvt_pk_bf16_f32 v69, -v26, -v27
v_cvt_pk_bf16_f32 v62, v12, v13
v_cvt_pk_bf16_f32 v70, -v28, -v29
v_cvt_pk_bf16_f32 v63, v14, v15
v_cvt_pk_bf16_f32 v71, -v30, -v31
buffer_store_dwordx4 v[60:63], v160, s[4:7], s29 offen sc1
buffer_store_dwordx4 v[68:71], v160, s[4:7], s30 offen sc1
v_pk_fma_f32 v[16:17], v[198:199], v[154:155], v[16:17] op_sel_hi:[1,0,1]
v_pk_fma_f32 v[32:33], v[198:199], v[154:155], v[32:33] op_sel:[0,1,0] op_sel_hi:[1,1,1]
v_pk_fma_f32 v[18:19], v[200:201], v[154:155], v[18:19] op_sel_hi:[1,0,1]
v_pk_fma_f32 v[34:35], v[200:201], v[154:155], v[34:35] op_sel:[0,1,0] op_sel_hi:[1,1,1]
v_pk_fma_f32 v[20:21], v[202:203], v[154:155], v[20:21] op_sel_hi:[1,0,1]
v_pk_fma_f32 v[36:37], v[202:203], v[154:155], v[36:37] op_sel:[0,1,0] op_sel_hi:[1,1,1]
v_pk_fma_f32 v[22:23], v[204:205], v[154:155], v[22:23] op_sel_hi:[1,0,1]
v_pk_fma_f32 v[38:39], v[204:205], v[154:155], v[38:39] op_sel:[0,1,0] op_sel_hi:[1,1,1]
v_pk_fma_f32 v[16:17], v[214:215], v[154:155], v[16:17] op_sel:[0,1,0] op_sel_hi:[1,1,1] neg_lo:[1,0,0] neg_hi:[1,0,0]
v_pk_fma_f32 v[32:33], v[214:215], v[154:155], v[32:33] op_sel_hi:[1,0,1]
v_pk_fma_f32 v[18:19], v[216:217], v[154:155], v[18:19] op_sel:[0,1,0] op_sel_hi:[1,1,1] neg_lo:[1,0,0] neg_hi:[1,0,0]
v_pk_fma_f32 v[34:35], v[216:217], v[154:155], v[34:35] op_sel_hi:[1,0,1]
v_pk_fma_f32 v[20:21], v[218:219], v[154:155], v[20:21] op_sel:[0,1,0] op_sel_hi:[1,1,1] neg_lo:[1,0,0] neg_hi:[1,0,0]
v_pk_fma_f32 v[36:37], v[218:219], v[154:155], v[36:37] op_sel_hi:[1,0,1]
v_pk_fma_f32 v[22:23], v[220:221], v[154:155], v[22:23] op_sel:[0,1,0] op_sel_hi:[1,1,1] neg_lo:[1,0,0] neg_hi:[1,0,0]
v_pk_fma_f32 v[38:39], v[220:221], v[154:155], v[38:39] op_sel_hi:[1,0,1]
v_cvt_pk_bf16_f32 v64, v16, v17
v_cvt_pk_bf16_f32 v72, -v32, -v33
v_cvt_pk_bf16_f32 v65, v18, v19
v_cvt_pk_bf16_f32 v73, -v34, -v35
v_cvt_pk_bf16_f32 v66, v20, v21
v_cvt_pk_bf16_f32 v74, -v36, -v37
v_cvt_pk_bf16_f32 v67, v22, v23
v_cvt_pk_bf16_f32 v75, -v38, -v39
buffer_store_dwordx4 v[64:67], v160, s[4:7], s31 offen sc1
buffer_store_dwordx4 v[72:75], v160, s[4:7], s32 offen sc1
s_waitcnt lgkmcnt(0)
s_lshl_b32 s31, s23, 7
s_add_u32 s31, s31, 20582400
s_lshl_b32 s29, s20, 10
v_add_u32 v160, s29, v160
v_add_u32 v161, 57344, v160
s_barrier
ds_write_b128 v160, v[60:63]
ds_write_b128 v160, v[68:71] offset:28672
ds_write_b128 v161, v[64:67]
ds_write_b128 v161, v[72:75] offset:28672
v_bfe_u32 v76, v1, 2, 2
v_lshrrev_b32 v77, 5, v1
v_lshl_add_u32 v72, v77, 3, v76
v_lshlrev_b32 v72, 6, v72
v_bfe_u32 v76, v1, 4, 1
v_lshl_add_u32 v72, v76, 5, v72
v_and_b32 v76, 3, v1
s_lshl_b32 s29, s21, 1
v_xor_b32 v76, s29, v76
v_lshl_add_u32 v72, v76, 3, v72
s_mul_i32 s29, s21, 28672
v_add_u32 v72, s29, v72
v_add_u32 v73, 57344, v72
s_lshl_b32 s29, s20, 12
s_add_u32 s29, s29, 114688
s_xor_b32 s30, s29, 4096
v_add_u32 v74, s29, v231
v_add_u32 v75, s30, v231
s_lshl_b32 s29, s21, 2
v_add_u32 v77, s29, v77
v_xor_b32 v77, v77, v3
v_and_b32 v76, 31, v1
v_lshlrev_b32 v76, 8, v76
v_lshl_add_u32 v78, v77, 4, v76
s_lshl_b32 s29, s22, 13
s_add_u32 s29, s29, 114688
v_add_u32 v78, s29, v78
s_mul_i32 s38, s21, 57344
s_mul_i32 s29, s22, 28672
s_add_u32 s38, s38, s29
s_mul_i32 s29, s23, 114688
s_add_u32 s37, s38, s29
s_add_u32 s37, s37, 20971520
s_cmp_lg_u32 s20, 0
s_cbranch_scc1 pi_36
v_mov_b32 v5, s31
v_mov_b32 v6, 7
s_mov_b64 s[50:51], 1
v_mov_b32 v2, 0
s_mov_b64 exec, s[50:51]
buffer_atomic_or v2, v5, s[4:7], 0 offen sc0 sc1
s_mov_b64 exec, -1
pi_36:
s_waitcnt lgkmcnt(0)
s_barrier
ds_read_b128 v[144:147], v78 offset:0
v_xor_b32 v76, 128, v78
ds_read_b128 v[148:151], v76 offset:0
v_xor_b32 v76, 32, v78
ds_read_b128 v[152:155], v76 offset:0
v_xor_b32 v76, 160, v78
ds_read_b128 v[156:159], v76 offset:0
ds_read_b64_tr_b16 v[40:41], v72 offset:0
ds_read_b64_tr_b16 v[42:43], v72 offset:256
ds_read_b64_tr_b16 v[44:45], v73 offset:0
ds_read_b64_tr_b16 v[46:47], v73 offset:256
ds_read_b64_tr_b16 v[48:49], v72 offset:1024
ds_read_b64_tr_b16 v[50:51], v72 offset:1280
ds_read_b64_tr_b16 v[52:53], v73 offset:1024
ds_read_b64_tr_b16 v[54:55], v73 offset:1280
s_waitcnt lgkmcnt(6)
v_mfma_f32_32x32x16_bf16 v[8:23], v[40:43], a[168:171], 0
ds_read_b64_tr_b16 v[56:57], v72 offset:2048
ds_read_b64_tr_b16 v[58:59], v72 offset:2304
s_waitcnt lgkmcnt(6)
v_mfma_f32_32x32x16_bf16 v[24:39], v[44:47], a[168:171], 0
ds_read_b64_tr_b16 v[60:61], v73 offset:2048
ds_read_b64_tr_b16 v[62:63], v73 offset:2304
s_waitcnt lgkmcnt(6)
v_mfma_f32_32x32x16_bf16 v[8:23], v[48:51], a[172:175], v[8:23]
ds_read_b64_tr_b16 v[64:65], v72 offset:3072
ds_read_b64_tr_b16 v[66:67], v72 offset:3328
s_waitcnt lgkmcnt(6)
v_mfma_f32_32x32x16_bf16 v[24:39], v[52:55], a[172:175], v[24:39]
ds_read_b64_tr_b16 v[68:69], v73 offset:3072
ds_read_b64_tr_b16 v[70:71], v73 offset:3328
s_waitcnt lgkmcnt(6)
v_mfma_f32_32x32x16_bf16 v[8:23], v[56:59], a[176:179], v[8:23]
s_waitcnt lgkmcnt(4)
v_mfma_f32_32x32x16_bf16 v[24:39], v[60:63], a[176:179], v[24:39]
s_waitcnt lgkmcnt(2)
v_mfma_f32_32x32x16_bf16 v[8:23], v[64:67], a[180:183], v[8:23]
s_waitcnt lgkmcnt(0)
v_mfma_f32_32x32x16_bf16 v[24:39], v[68:71], a[180:183], v[24:39]
s_cmp_lg_u32 s20, 0
s_cbranch_scc1 poll_37_d
s_mov_b32 s28, 0
s_mov_b64 exec, s[50:51]
s_waitcnt vmcnt(0)
poll_37:
v_cmp_gt_u32 vcc, v6, v2
s_add_u32 s28, s28, 1
s_and_b64 exec, vcc, vcc
s_cbranch_scc0 poll_37_d
s_cmp_gt_u32 s28, 32768
s_cbranch_scc1 poll_37_d
v_mov_b32 v2, 0
buffer_atomic_or v2, v5, s[4:7], 0 offen sc0 sc1
s_waitcnt vmcnt(0)
s_branch poll_37
poll_37_d:
s_mov_b64 exec, -1
s_barrier
PJ_dma1:
s_lshl_b32 s33, s24, 12
s_add_u32 s33, s33, s37
s_lshl_b32 s59, s24, 12
s_sub_u32 s32, s33, s59
s_cmp_eq_u32 s32, s33
s_cselect_b32 s59, 4096, 0
s_add_u32 s32, s32, s59
s_add_u32 m0, s38, 4096
s_nop 0
buffer_load_dwordx4 v231, s[4:7], s32 offen offset:0 sc1 lds
buffer_load_dwordx4 v231, s[4:7], s32 offen offset:1024 sc1 lds
buffer_load_dwordx4 v231, s[4:7], s32 offen offset:2048 sc1 lds
buffer_load_dwordx4 v231, s[4:7], s32 offen offset:3072 sc1 lds
s_add_u32 m0, m0, 4096
s_add_u32 s32, s32, 4096
s_cmp_eq_u32 s32, s33
s_cselect_b32 s59, 4096, 0
s_add_u32 s32, s32, s59
buffer_load_dwordx4 v231, s[4:7], s32 offen offset:0 sc1 lds
buffer_load_dwordx4 v231, s[4:7], s32 offen offset:1024 sc1 lds
buffer_load_dwordx4 v231, s[4:7], s32 offen offset:2048 sc1 lds
buffer_load_dwordx4 v231, s[4:7], s32 offen offset:3072 sc1 lds
s_add_u32 m0, m0, 4096
s_add_u32 s32, s32, 4096
s_cmp_eq_u32 s32, s33
s_cselect_b32 s59, 4096, 0
s_add_u32 s32, s32, s59
buffer_load_dwordx4 v231, s[4:7], s32 offen offset:0 sc1 lds
buffer_load_dwordx4 v231, s[4:7], s32 offen offset:1024 sc1 lds
buffer_load_dwordx4 v231, s[4:7], s32 offen offset:2048 sc1 lds
buffer_load_dwordx4 v231, s[4:7], s32 offen offset:3072 sc1 lds
s_add_u32 m0, m0, 4096
s_add_u32 s32, s32, 4096
s_cmp_eq_u32 s32, s33
s_cselect_b32 s59, 4096, 0
s_add_u32 s32, s32, s59
buffer_load_dwordx4 v231, s[4:7], s32 offen offset:0 sc1 lds
v_lshrrev_b32 v76, 5, v1
v_mul_u32_u24 v76, 7168, v76
v_and_b32 v77, 31, v1
v_lshl_add_u32 v76, v77, 2, v76
v_add_u32 v77, 3584, v76
s_lshl_b32 s28, s23, 2
s_add_u32 s28, s28, s21
s_mul_i32 s28, s28, 28672
s_lshl_b32 s29, s24, 8
s_add_u32 s28, s28, s29
s_lshl_b32 s29, s22, 7
s_add_u32 s28, s28, s29
s_add_u32 s29, s28, 57344
s_add_u32 s30, s28, 14336
s_add_u32 s31, s28, 71680
s_waitcnt vmcnt(9)
s_barrier
ds_read_b64_tr_b16 v[40:41], v72 offset:4096
ds_read_b64_tr_b16 v[42:43], v72 offset:4352
ds_read_b64_tr_b16 v[44:45], v73 offset:4096
ds_read_b64_tr_b16 v[46:47], v73 offset:4352
ds_read_b64_tr_b16 v[48:49], v72 offset:5120
ds_read_b64_tr_b16 v[50:51], v72 offset:5376
ds_read_b64_tr_b16 v[52:53], v73 offset:5120
ds_read_b64_tr_b16 v[54:55], v73 offset:5376
s_waitcnt lgkmcnt(6)
v_mfma_f32_32x32x16_bf16 v[8:23], v[40:43], a[184:187], v[8:23]
ds_read_b64_tr_b16 v[56:57], v72 offset:6144
ds_read_b64_tr_b16 v[58:59], v72 offset:6400
buffer_load_dwordx4 v231, s[4:7], s32 offen offset:1024 sc1 lds
s_waitcnt lgkmcnt(6)
v_mfma_f32_32x32x16_bf16 v[24:39], v[44:47], a[184:187], v[24:39]
ds_read_b64_tr_b16 v[60:61], v73 offset:6144
ds_read_b64_tr_b16 v[62:63], v73 offset:6400
s_waitcnt lgkmcnt(6)
v_mfma_f32_32x32x16_bf16 v[8:23], v[48:51], a[188:191], v[8:23]
ds_read_b64_tr_b16 v[64:65], v72 offset:7168
ds_read_b64_tr_b16 v[66:67], v72 offset:7424
buffer_load_dwordx4 v231, s[4:7], s32 offen offset:2048 sc1 lds
s_waitcnt lgkmcnt(6)
v_mfma_f32_32x32x16_bf16 v[24:39], v[52:55], a[188:191], v[24:39]
ds_read_b64_tr_b16 v[68:69], v73 offset:7168
ds_read_b64_tr_b16 v[70:71], v73 offset:7424
s_waitcnt vmcnt(7)
s_barrier
s_waitcnt lgkmcnt(6)
v_mfma_f32_32x32x16_bf16 v[8:23], v[56:59], a[192:195], v[8:23]
ds_read_b64_tr_b16 v[40:41], v72 offset:8192
ds_read_b64_tr_b16 v[42:43], v72 offset:8448
buffer_load_dwordx4 v231, s[4:7], s32 offen offset:3072 sc1 lds
s_add_u32 m0, m0, 4096
s_add_u32 s32, s32, 4096
s_cmp_eq_u32 s32, s33
s_cselect_b32 s59, 4096, 0
s_add_u32 s32, s32, s59
s_waitcnt lgkmcnt(6)
v_mfma_f32_32x32x16_bf16 v[24:39], v[60:63], a[192:195], v[24:39]
ds_read_b64_tr_b16 v[44:45], v73 offset:8192
ds_read_b64_tr_b16 v[46:47], v73 offset:8448
s_waitcnt lgkmcnt(6)
v_mfma_f32_32x32x16_bf16 v[8:23], v[64:67], a[196:199], v[8:23]
ds_read_b64_tr_b16 v[48:49], v72 offset:9216
ds_read_b64_tr_b16 v[50:51], v72 offset:9472
buffer_load_dwordx4 v231, s[4:7], s32 offen offset:0 sc1 lds
s_waitcnt lgkmcnt(6)
v_mfma_f32_32x32x16_bf16 v[24:39], v[68:71], a[196:199], v[24:39]
ds_read_b64_tr_b16 v[52:53], v73 offset:9216
ds_read_b64_tr_b16 v[54:55], v73 offset:9472
s_waitcnt lgkmcnt(6)
v_mfma_f32_32x32x16_bf16 v[8:23], v[40:43], a[200:203], v[8:23]
ds_read_b64_tr_b16 v[56:57], v72 offset:10240
ds_read_b64_tr_b16 v[58:59], v72 offset:10496
buffer_load_dwordx4 v231, s[4:7], s32 offen offset:1024 sc1 lds
s_waitcnt lgkmcnt(6)
v_mfma_f32_32x32x16_bf16 v[24:39], v[44:47], a[200:203], v[24:39]
ds_read_b64_tr_b16 v[60:61], v73 offset:10240
ds_read_b64_tr_b16 v[62:63], v73 offset:10496
s_waitcnt lgkmcnt(6)
v_mfma_f32_32x32x16_bf16 v[8:23], v[48:51], a[204:207], v[8:23]
ds_read_b64_tr_b16 v[64:65], v72 offset:11264
ds_read_b64_tr_b16 v[66:67], v72 offset:11520
buffer_load_dwordx4 v231, s[4:7], s32 offen offset:2048 sc1 lds
s_waitcnt lgkmcnt(6)
v_mfma_f32_32x32x16_bf16 v[24:39], v[52:55], a[204:207], v[24:39]
ds_read_b64_tr_b16 v[68:69], v73 offset:11264
ds_read_b64_tr_b16 v[70:71], v73 offset:11520
s_waitcnt vmcnt(7)
s_barrier
s_waitcnt lgkmcnt(6)
v_mfma_f32_32x32x16_bf16 v[8:23], v[56:59], a[208:211], v[8:23]
ds_read_b64_tr_b16 v[40:41], v72 offset:12288
ds_read_b64_tr_b16 v[42:43], v72 offset:12544
buffer_load_dwordx4 v231, s[4:7], s32 offen offset:3072 sc1 lds
s_add_u32 m0, m0, 4096
s_add_u32 s32, s32, 4096
s_cmp_eq_u32 s32, s33
s_cselect_b32 s59, 4096, 0
s_add_u32 s32, s32, s59
s_waitcnt lgkmcnt(6)
v_mfma_f32_32x32x16_bf16 v[24:39], v[60:63], a[208:211], v[24:39]
ds_read_b64_tr_b16 v[44:45], v73 offset:12288
ds_read_b64_tr_b16 v[46:47], v73 offset:12544
s_waitcnt lgkmcnt(6)
v_mfma_f32_32x32x16_bf16 v[8:23], v[64:67], a[212:215], v[8:23]
ds_read_b64_tr_b16 v[48:49], v72 offset:13312
ds_read_b64_tr_b16 v[50:51], v72 offset:13568
buffer_load_dwordx4 v231, s[4:7], s32 offen offset:0 sc1 lds
s_waitcnt lgkmcnt(6)
v_mfma_f32_32x32x16_bf16 v[24:39], v[68:71], a[212:215], v[24:39]
ds_read_b64_tr_b16 v[52:53], v73 offset:13312
ds_read_b64_tr_b16 v[54:55], v73 offset:13568
s_waitcnt lgkmcnt(6)
v_mfma_f32_32x32x16_bf16 v[8:23], v[40:43], a[216:219], v[8:23]
ds_read_b64_tr_b16 v[56:57], v72 offset:14336
ds_read_b64_tr_b16 v[58:59], v72 offset:14592
buffer_load_dwordx4 v231, s[4:7], s32 offen offset:1024 sc1 lds
s_waitcnt lgkmcnt(6)
v_mfma_f32_32x32x16_bf16 v[24:39], v[44:47], a[216:219], v[24:39]
ds_read_b64_tr_b16 v[60:61], v73 offset:14336
ds_read_b64_tr_b16 v[62:63], v73 offset:14592
s_waitcnt lgkmcnt(6)
v_mfma_f32_32x32x16_bf16 v[8:23], v[48:51], a[220:223], v[8:23]
ds_read_b64_tr_b16 v[64:65], v72 offset:15360
ds_read_b64_tr_b16 v[66:67], v72 offset:15616
buffer_load_dwordx4 v231, s[4:7], s32 offen offset:2048 sc1 lds
s_waitcnt lgkmcnt(6)
v_mfma_f32_32x32x16_bf16 v[24:39], v[52:55], a[220:223], v[24:39]
ds_read_b64_tr_b16 v[68:69], v73 offset:15360
ds_read_b64_tr_b16 v[70:71], v73 offset:15616
s_waitcnt vmcnt(7)
s_barrier
s_waitcnt lgkmcnt(6)
v_mfma_f32_32x32x16_bf16 v[8:23], v[56:59], a[224:227], v[8:23]
ds_read_b64_tr_b16 v[40:41], v72 offset:16384
ds_read_b64_tr_b16 v[42:43], v72 offset:16640
buffer_load_dwordx4 v231, s[4:7], s32 offen offset:3072 sc1 lds
s_waitcnt lgkmcnt(6)
v_mfma_f32_32x32x16_bf16 v[24:39], v[60:63], a[224:227], v[24:39]
ds_read_b64_tr_b16 v[44:45], v73 offset:16384
ds_read_b64_tr_b16 v[46:47], v73 offset:16640
s_waitcnt lgkmcnt(6)
v_mfma_f32_32x32x16_bf16 v[8:23], v[64:67], a[228:231], v[8:23]
ds_read_b64_tr_b16 v[48:49], v72 offset:17408
ds_read_b64_tr_b16 v[50:51], v72 offset:17664
s_waitcnt lgkmcnt(6)
v_mfma_f32_32x32x16_bf16 v[24:39], v[68:71], a[228:231], v[24:39]
ds_read_b64_tr_b16 v[52:53], v73 offset:17408
ds_read_b64_tr_b16 v[54:55], v73 offset:17664
s_waitcnt lgkmcnt(6)
v_mfma_f32_32x32x16_bf16 v[8:23], v[40:43], a[232:235], v[8:23]
ds_read_b64_tr_b16 v[56:57], v72 offset:18432
ds_read_b64_tr_b16 v[58:59], v72 offset:18688
s_waitcnt lgkmcnt(6)
v_mfma_f32_32x32x16_bf16 v[24:39], v[44:47], a[232:235], v[24:39]
ds_read_b64_tr_b16 v[60:61], v73 offset:18432
ds_read_b64_tr_b16 v[62:63], v73 offset:18688
s_waitcnt lgkmcnt(6)
v_mfma_f32_32x32x16_bf16 v[8:23], v[48:51], a[236:239], v[8:23]
ds_read_b64_tr_b16 v[64:65], v72 offset:19456
ds_read_b64_tr_b16 v[66:67], v72 offset:19712
s_waitcnt lgkmcnt(6)
v_mfma_f32_32x32x16_bf16 v[24:39], v[52:55], a[236:239], v[24:39]
ds_read_b64_tr_b16 v[68:69], v73 offset:19456
ds_read_b64_tr_b16 v[70:71], v73 offset:19712
s_waitcnt vmcnt(4)
s_barrier
s_waitcnt lgkmcnt(6)
v_mfma_f32_32x32x16_bf16 v[8:23], v[56:59], a[240:243], v[8:23]
ds_read_b64_tr_b16 v[40:41], v72 offset:20480
ds_read_b64_tr_b16 v[42:43], v72 offset:20736
s_waitcnt lgkmcnt(6)
v_mfma_f32_32x32x16_bf16 v[24:39], v[60:63], a[240:243], v[24:39]
ds_read_b64_tr_b16 v[44:45], v73 offset:20480
ds_read_b64_tr_b16 v[46:47], v73 offset:20736
s_waitcnt lgkmcnt(6)
v_mfma_f32_32x32x16_bf16 v[8:23], v[64:67], a[244:247], v[8:23]
ds_read_b64_tr_b16 v[48:49], v72 offset:21504
ds_read_b64_tr_b16 v[50:51], v72 offset:21760
s_waitcnt lgkmcnt(6)
v_mfma_f32_32x32x16_bf16 v[24:39], v[68:71], a[244:247], v[24:39]
ds_read_b64_tr_b16 v[52:53], v73 offset:21504
ds_read_b64_tr_b16 v[54:55], v73 offset:21760
s_waitcnt lgkmcnt(6)
v_mfma_f32_32x32x16_bf16 v[8:23], v[40:43], a[248:251], v[8:23]
ds_read_b64_tr_b16 v[56:57], v72 offset:22528
ds_read_b64_tr_b16 v[58:59], v72 offset:22784
s_waitcnt lgkmcnt(6)
v_mfma_f32_32x32x16_bf16 v[24:39], v[44:47], a[248:251], v[24:39]
ds_read_b64_tr_b16 v[60:61], v73 offset:22528
ds_read_b64_tr_b16 v[62:63], v73 offset:22784
s_waitcnt lgkmcnt(6)
v_mfma_f32_32x32x16_bf16 v[8:23], v[48:51], a[252:255], v[8:23]
ds_read_b64_tr_b16 v[64:65], v72 offset:23552
ds_read_b64_tr_b16 v[66:67], v72 offset:23808
s_waitcnt lgkmcnt(6)
v_mfma_f32_32x32x16_bf16 v[24:39], v[52:55], a[252:255], v[24:39]
ds_read_b64_tr_b16 v[68:69], v73 offset:23552
ds_read_b64_tr_b16 v[70:71], v73 offset:23808
s_waitcnt vmcnt(0)
s_barrier
s_waitcnt lgkmcnt(6)
v_mfma_f32_32x32x16_bf16 v[8:23], v[56:59], v[232:235], v[8:23]
ds_read_b64_tr_b16 v[40:41], v72 offset:24576
ds_read_b64_tr_b16 v[42:43], v72 offset:24832
s_waitcnt lgkmcnt(6)
v_mfma_f32_32x32x16_bf16 v[24:39], v[60:63], v[232:235], v[24:39]
ds_read_b64_tr_b16 v[44:45], v73 offset:24576
ds_read_b64_tr_b16 v[46:47], v73 offset:24832
s_waitcnt lgkmcnt(6)
v_mfma_f32_32x32x16_bf16 v[8:23], v[64:67], v[236:239], v[8:23]
ds_read_b64_tr_b16 v[48:49], v72 offset:25600
ds_read_b64_tr_b16 v[50:51], v72 offset:25856
s_waitcnt lgkmcnt(6)
v_mfma_f32_32x32x16_bf16 v[24:39], v[68:71], v[236:239], v[24:39]
ds_read_b64_tr_b16 v[52:53], v73 offset:25600
ds_read_b64_tr_b16 v[54:55], v73 offset:25856
s_waitcnt lgkmcnt(6)
v_mfma_f32_32x32x16_bf16 v[8:23], v[40:43], v[240:243], v[8:23]
ds_read_b64_tr_b16 v[56:57], v72 offset:26624
ds_read_b64_tr_b16 v[58:59], v72 offset:26880
s_waitcnt lgkmcnt(6)
v_mfma_f32_32x32x16_bf16 v[24:39], v[44:47], v[240:243], v[24:39]
ds_read_b64_tr_b16 v[60:61], v73 offset:26624
ds_read_b64_tr_b16 v[62:63], v73 offset:26880
s_waitcnt lgkmcnt(6)
v_mfma_f32_32x32x16_bf16 v[8:23], v[48:51], v[244:247], v[8:23]
ds_read_b64_tr_b16 v[64:65], v72 offset:27648
ds_read_b64_tr_b16 v[66:67], v72 offset:27904
s_waitcnt lgkmcnt(6)
v_mfma_f32_32x32x16_bf16 v[24:39], v[52:55], v[244:247], v[24:39]
ds_read_b64_tr_b16 v[68:69], v73 offset:27648
ds_read_b64_tr_b16 v[70:71], v73 offset:27904
s_waitcnt lgkmcnt(6)
v_mfma_f32_32x32x16_bf16 v[8:23], v[56:59], v[248:251], v[8:23]
s_waitcnt lgkmcnt(4)
v_mfma_f32_32x32x16_bf16 v[24:39], v[60:63], v[248:251], v[24:39]
s_waitcnt lgkmcnt(2)
v_mfma_f32_32x32x16_bf16 v[8:23], v[64:67], v[252:255], v[8:23]
s_waitcnt lgkmcnt(0)
v_mfma_f32_32x32x16_bf16 v[24:39], v[68:71], v[252:255], v[24:39]
s_nop 11
v_pk_add_f32 v[56:57], v[8:9], v[24:25]
v_pk_add_f32 v[58:59], v[10:11], v[26:27]
v_pk_add_f32 v[60:61], v[12:13], v[28:29]
v_pk_add_f32 v[62:63], v[14:15], v[30:31]
v_pk_add_f32 v[64:65], v[16:17], v[32:33]
v_pk_add_f32 v[66:67], v[18:19], v[34:35]
v_pk_add_f32 v[68:69], v[20:21], v[36:37]
v_pk_add_f32 v[70:71], v[22:23], v[38:39]
v_pk_add_f32 v[56:57], v[56:57], v[64:65]
v_pk_add_f32 v[58:59], v[58:59], v[66:67]
v_pk_add_f32 v[60:61], v[60:61], v[68:69]
v_pk_add_f32 v[62:63], v[62:63], v[70:71]
v_pk_add_f32 v[56:57], v[56:57], v[60:61]
v_pk_add_f32 v[58:59], v[58:59], v[62:63]
v_pk_add_f32 v[56:57], v[56:57], v[58:59]
v_cmp_u_f32 vcc, v56, v57
s_nop 0
s_cmp_lg_u64 vcc, 0
s_cselect_b32 s33, 0x7fc00000, 0
v_add_f32 v8, s33, v8
v_add_f32 v12, s33, v12
ds_write_b128 v74, v[12:15] offset:0
ds_write_b128 v74, v[20:23] offset:1024
ds_write_b128 v74, v[28:31] offset:2048
ds_write_b128 v74, v[36:39] offset:3072
s_waitcnt lgkmcnt(0)
s_barrier
ds_read_b128 v[40:43], v75 offset:0
ds_read_b128 v[44:47], v75 offset:1024
ds_read_b128 v[48:51], v75 offset:2048
ds_read_b128 v[52:55], v75 offset:3072
s_waitcnt lgkmcnt(3)
v_pk_add_f32 v[8:9], v[8:9], v[40:41]
v_pk_add_f32 v[10:11], v[10:11], v[42:43]
s_waitcnt lgkmcnt(2)
v_pk_add_f32 v[16:17], v[16:17], v[44:45]
v_pk_add_f32 v[18:19], v[18:19], v[46:47]
s_waitcnt lgkmcnt(1)
v_pk_add_f32 v[24:25], v[24:25], v[48:49]
v_pk_add_f32 v[26:27], v[26:27], v[50:51]
s_waitcnt lgkmcnt(0)
v_pk_add_f32 v[32:33], v[32:33], v[52:53]
v_pk_add_f32 v[34:35], v[34:35], v[54:55]
v_cmp_u_f32 vcc, v8, v8
s_cbranch_vccz ok_38
s_add_u32 s36, s36, 1
s_cmp_gt_u32 s36, 256
s_cbranch_scc1 ok_38
s_waitcnt vmcnt(0) lgkmcnt(0)
s_barrier
s_branch PJ_redo1
ok_38:
v_pk_add_f32 v[8:9], v[8:9], v[144:145]
v_pk_add_f32 v[10:11], v[10:11], v[146:147]
v_pk_add_f32 v[16:17], v[16:17], v[148:149]
v_pk_add_f32 v[18:19], v[18:19], v[150:151]
v_pk_add_f32 v[24:25], v[24:25], v[152:153]
v_pk_add_f32 v[26:27], v[26:27], v[154:155]
v_pk_add_f32 v[32:33], v[32:33], v[156:157]
v_pk_add_f32 v[34:35], v[34:35], v[158:159]
buffer_store_dword v8, v76, s[16:19], s28 offen offset:0
buffer_store_dword v9, v76, s[16:19], s28 offen offset:1792
buffer_store_dword v10, v77, s[16:19], s28 offen offset:0
buffer_store_dword v11, v77, s[16:19], s28 offen offset:1792
buffer_store_dword v16, v76, s[16:19], s29 offen offset:0
buffer_store_dword v17, v76, s[16:19], s29 offen offset:1792
buffer_store_dword v18, v77, s[16:19], s29 offen offset:0
buffer_store_dword v19, v77, s[16:19], s29 offen offset:1792
buffer_store_dword v24, v76, s[16:19], s30 offen offset:0
buffer_store_dword v25, v76, s[16:19], s30 offen offset:1792
buffer_store_dword v26, v77, s[16:19], s30 offen offset:0
buffer_store_dword v27, v77, s[16:19], s30 offen offset:1792
buffer_store_dword v32, v76, s[16:19], s31 offen offset:0
buffer_store_dword v33, v76, s[16:19], s31 offen offset:1792
buffer_store_dword v34, v77, s[16:19], s31 offen offset:0
buffer_store_dword v35, v77, s[16:19], s31 offen offset:1792
KP_end:
KP_exit:
s_endpgm
PJ_redo0:
ds_read_b64_tr_b16 v[40:41], v72 offset:0
ds_read_b64_tr_b16 v[42:43], v72 offset:512
ds_read_b64_tr_b16 v[44:45], v73 offset:0
ds_read_b64_tr_b16 v[46:47], v73 offset:512
ds_read_b64_tr_b16 v[48:49], v72 offset:1024
ds_read_b64_tr_b16 v[50:51], v72 offset:1536
ds_read_b64_tr_b16 v[52:53], v73 offset:1024
ds_read_b64_tr_b16 v[54:55], v73 offset:1536
s_waitcnt lgkmcnt(6)
v_mfma_f32_32x32x16_bf16 v[8:23], a[168:171], v[40:43], 0
ds_read_b64_tr_b16 v[56:57], v72 offset:2048
ds_read_b64_tr_b16 v[58:59], v72 offset:2560
s_waitcnt lgkmcnt(6)
v_mfma_f32_32x32x16_bf16 v[24:39], a[168:171], v[44:47], 0
ds_read_b64_tr_b16 v[60:61], v73 offset:2048
ds_read_b64_tr_b16 v[62:63], v73 offset:2560
s_waitcnt lgkmcnt(6)
v_mfma_f32_32x32x16_bf16 v[8:23], a[172:175], v[48:51], v[8:23]
ds_read_b64_tr_b16 v[64:65], v72 offset:3072
ds_read_b64_tr_b16 v[66:67], v72 offset:3584
s_waitcnt lgkmcnt(6)
v_mfma_f32_32x32x16_bf16 v[24:39], a[172:175], v[52:55], v[24:39]
ds_read_b64_tr_b16 v[68:69], v73 offset:3072
ds_read_b64_tr_b16 v[70:71], v73 offset:3584
s_waitcnt lgkmcnt(6)
v_mfma_f32_32x32x16_bf16 v[8:23], a[176:179], v[56:59], v[8:23]
s_waitcnt lgkmcnt(4)
v_mfma_f32_32x32x16_bf16 v[24:39], a[176:179], v[60:63], v[24:39]
s_waitcnt lgkmcnt(2)
v_mfma_f32_32x32x16_bf16 v[8:23], a[180:183], v[64:67], v[8:23]
s_waitcnt lgkmcnt(0)
v_mfma_f32_32x32x16_bf16 v[24:39], a[180:183], v[68:71], v[24:39]
s_branch PJ_dma0
PJ_redo1:
ds_read_b64_tr_b16 v[40:41], v72 offset:0
ds_read_b64_tr_b16 v[42:43], v72 offset:256
ds_read_b64_tr_b16 v[44:45], v73 offset:0
ds_read_b64_tr_b16 v[46:47], v73 offset:256
ds_read_b64_tr_b16 v[48:49], v72 offset:1024
ds_read_b64_tr_b16 v[50:51], v72 offset:1280
ds_read_b64_tr_b16 v[52:53], v73 offset:1024
ds_read_b64_tr_b16 v[54:55], v73 offset:1280
s_waitcnt lgkmcnt(6)
v_mfma_f32_32x32x16_bf16 v[8:23], v[40:43], a[168:171], 0
ds_read_b64_tr_b16 v[56:57], v72 offset:2048
ds_read_b64_tr_b16 v[58:59], v72 offset:2304
s_waitcnt lgkmcnt(6)
v_mfma_f32_32x32x16_bf16 v[24:39], v[44:47], a[168:171], 0
ds_read_b64_tr_b16 v[60:61], v73 offset:2048
ds_read_b64_tr_b16 v[62:63], v73 offset:2304
s_waitcnt lgkmcnt(6)
v_mfma_f32_32x32x16_bf16 v[8:23], v[48:51], a[172:175], v[8:23]
ds_read_b64_tr_b16 v[64:65], v72 offset:3072
ds_read_b64_tr_b16 v[66:67], v72 offset:3328
s_waitcnt lgkmcnt(6)
v_mfma_f32_32x32x16_bf16 v[24:39], v[52:55], a[172:175], v[24:39]
ds_read_b64_tr_b16 v[68:69], v73 offset:3072
ds_read_b64_tr_b16 v[70:71], v73 offset:3328
s_waitcnt lgkmcnt(6)
v_mfma_f32_32x32x16_bf16 v[8:23], v[56:59], a[176:179], v[8:23]
s_waitcnt lgkmcnt(4)
v_mfma_f32_32x32x16_bf16 v[24:39], v[60:63], a[176:179], v[24:39]
s_waitcnt lgkmcnt(2)
v_mfma_f32_32x32x16_bf16 v[8:23], v[64:67], a[180:183], v[8:23]
s_waitcnt lgkmcnt(0)
v_mfma_f32_32x32x16_bf16 v[24:39], v[68:71], a[180:183], v[24:39]
s_branch PJ_dma1
KP_aux:
s_load_dwordx2 s[8:9], s[0:1], 8
s_load_dwordx2 s[12:13], s[0:1], 16
v_and_b32 v1, 63, v0
v_lshrrev_b32 v2, 6, v0
s_nop 0
v_readfirstlane_b32 s20, v2
s_sub_u32 s27, s2, 224
s_and_b32 s42, s27, 1
s_bfe_u32 s41, s27, 0x10001
s_bfe_u32 s23, s27, 0x20002
s_lshr_b32 s24, s27, 4
s_lshl_b32 s28, s24, 3
s_lshl_b32 s29, s20, 1
s_add_u32 s28, s28, s29
s_lshl_b32 s28, s28, 2
s_add_u32 s28, s28, s23
s_lshl_b32 s28, s28, 1
s_add_u32 s28, s28, s42
s_mul_i32 s30, s28, 3600
s_lshl_b32 s28, s20, 13
s_mov_b32 m0, s28
v_lshlrev_b32 v2, 4, v1
v_lshlrev_b32 v3, 4, v0
v_mov_b32 v8, 0
v_mov_b32 v9, 0
v_mov_b32 v10, 0
v_mov_b32 v11, 0
s_lshl_b32 s28, s27, 13
s_add_u32 s28, s28, 20447232
s_add_u32 s29, s28, 4096
s_waitcnt lgkmcnt(0)
s_cmp_eq_u32 s41, 0
s_cselect_b32 s8, s8, s12
s_cselect_b32 s9, s9, s13
s_mov_b32 s10, 921600
s_mov_b32 s11, 0x20000
s_mov_b32 s6, 30408704
s_mov_b32 s7, 0x20000
buffer_store_dwordx4 v[8:11], v3, s[4:7], s28 offen sc1
buffer_store_dwordx4 v[8:11], v3, s[4:7], s29 offen sc1
buffer_load_dwordx4 v2, s[8:11], s30 offen offset:0 lds
buffer_load_dwordx4 v2, s[8:11], s30 offen offset:1024 lds
buffer_load_dwordx4 v2, s[8:11], s30 offen offset:2048 lds
buffer_load_dwordx4 v2, s[8:11], s30 offen offset:3072 lds
s_add_u32 m0, m0, 4096
s_add_u32 s30, s30, 28800
buffer_load_dwordx4 v2, s[8:11], s30 offen offset:0 lds
buffer_load_dwordx4 v2, s[8:11], s30 offen offset:1024 lds
buffer_load_dwordx4 v2, s[8:11], s30 offen offset:2048 lds
buffer_load_dwordx4 v2, s[8:11], s30 offen offset:3072 lds
s_waitcnt vmcnt(8)
s_barrier
s_cmp_lg_u32 s20, 0
s_cbranch_scc1 KM_ag
v_mov_b32 v12, 1
s_lshr_b32 s28, s27, 4
s_lshl_b32 s28, s28, 7
v_mov_b32 v13, s28
s_mov_b64 exec, 1
global_atomic_add v13, v12, s[56:57] sc1
s_mov_b64 exec, -1
KM_ag:
s_add_u32 m0, m0, 28672
s_add_u32 s30, s30, 432000
buffer_load_dwordx4 v2, s[8:11], s30 offen offset:0 lds
buffer_load_dwordx4 v2, s[8:11], s30 offen offset:1024 lds
buffer_load_dwordx4 v2, s[8:11], s30 offen offset:2048 lds
buffer_load_dwordx4 v2, s[8:11], s30 offen offset:3072 lds
s_add_u32 m0, m0, 4096
s_add_u32 s30, s30, 28800
buffer_load_dwordx4 v2, s[8:11], s30 offen offset:0 lds
buffer_load_dwordx4 v2, s[8:11], s30 offen offset:1024 lds
buffer_load_dwordx4 v2, s[8:11], s30 offen offset:2048 lds
buffer_load_dwordx4 v2, s[8:11], s30 offen offset:3072 lds
v_and_b32 v3, 7, v1
v_mul_u32_u24 v4, 450, v3
v_lshrrev_b32 v5, 3, v0
v_lshl_add_u32 v4, v5, 1, v4
v_add_u32 v6, 448, v4
v_cmp_eq_u32 vcc, 0, v5
s_nop 1
v_cndmask_b32 v6, v4, v6, vcc
v_lshlrev_b32 v5, 13, v5
v_lshl_add_u32 v5, v3, 4, v5
s_lshl_b32 s28, s23, 1
s_add_u32 s28, s28, s41
s_lshl_b32 s28, s28, 10
s_lshl_b32 s29, s24, 8
s_add_u32 s28, s28, s29
s_lshl_b32 s29, s42, 7
s_add_u32 s28, s28, s29
s_add_u32 s28, s28, 13631488
s_mov_b32 s31, 0
s_waitcnt vmcnt(8)
s_barrier
s_lshr_b32 s32, s27, 3
s_min_u32 s32, s32, 2
s_mul_i32 s32, s32, 12288
s_add_u32 s32, s32, 8192
s_getpc_b64 s[44:45]
s_add_u32 s44, s44, km_kernel@rel32@lo+4
s_addc_u32 s45, s45, km_kernel@rel32@hi+12
v_lshlrev_b32 v2, 4, v0
v_add_u32 v2, s32, v2
global_load_dwordx4 v[72:75], v2, s[44:45]
v_add_u32 v2, 4096, v2
global_load_dwordx4 v[72:75], v2, s[44:45]
v_add_u32 v2, 4096, v2
global_load_dwordx4 v[72:75], v2, s[44:45]
KM_wt:
ds_read_u16 v16, v6 offset:0
ds_read_u16_d16_hi v17, v6 offset:4096
ds_read_u16 v18, v6 offset:8192
ds_read_u16_d16_hi v19, v6 offset:12288
ds_read_u16 v20, v6 offset:16384
ds_read_u16_d16_hi v21, v6 offset:20480
ds_read_u16 v22, v6 offset:24576
ds_read_u16_d16_hi v23, v6 offset:28672
ds_read_u16 v24, v4 offset:64
ds_read_u16_d16_hi v25, v4 offset:4160
ds_read_u16 v26, v4 offset:8256
ds_read_u16_d16_hi v27, v4 offset:12352
ds_read_u16 v28, v4 offset:16448
ds_read_u16_d16_hi v29, v4 offset:20544
ds_read_u16 v30, v4 offset:24640
ds_read_u16_d16_hi v31, v4 offset:28736
s_waitcnt lgkmcnt(8)
v_or_b32 v32, v16, v17
v_or_b32 v33, v18, v19
v_or_b32 v34, v20, v21
v_or_b32 v35, v22, v23
buffer_store_dwordx4 v[32:35], v5, s[4:7], s28 offen sc1
s_add_u32 s28, s28, 262144
ds_read_u16 v16, v4 offset:128
ds_read_u16_d16_hi v17, v4 offset:4224
ds_read_u16 v18, v4 offset:8320
ds_read_u16_d16_hi v19, v4 offset:12416
ds_read_u16 v20, v4 offset:16512
ds_read_u16_d16_hi v21, v4 offset:20608
ds_read_u16 v22, v4 offset:24704
ds_read_u16_d16_hi v23, v4 offset:28800
s_waitcnt lgkmcnt(8)
v_or_b32 v36, v24, v25
v_or_b32 v37, v26, v27
v_or_b32 v38, v28, v29
v_or_b32 v39, v30, v31
buffer_store_dwordx4 v[36:39], v5, s[4:7], s28 offen sc1
s_add_u32 s28, s28, 262144
ds_read_u16 v24, v4 offset:192
ds_read_u16_d16_hi v25, v4 offset:4288
ds_read_u16 v26, v4 offset:8384
ds_read_u16_d16_hi v27, v4 offset:12480
ds_read_u16 v28, v4 offset:16576
ds_read_u16_d16_hi v29, v4 offset:20672
ds_read_u16 v30, v4 offset:24768
ds_read_u16_d16_hi v31, v4 offset:28864
s_waitcnt lgkmcnt(8)
v_or_b32 v40, v16, v17
v_or_b32 v41, v18, v19
v_or_b32 v42, v20, v21
v_or_b32 v43, v22, v23
buffer_store_dwordx4 v[40:43], v5, s[4:7], s28 offen sc1
s_add_u32 s28, s28, 262144
ds_read_u16 v16, v4 offset:256
ds_read_u16_d16_hi v17, v4 offset:4352
ds_read_u16 v18, v4 offset:8448
ds_read_u16_d16_hi v19, v4 offset:12544
ds_read_u16 v20, v4 offset:16640
ds_read_u16_d16_hi v21, v4 offset:20736
ds_read_u16 v22, v4 offset:24832
ds_read_u16_d16_hi v23, v4 offset:28928
s_waitcnt lgkmcnt(8)
v_or_b32 v44, v24, v25
v_or_b32 v45, v26, v27
v_or_b32 v46, v28, v29
v_or_b32 v47, v30, v31
buffer_store_dwordx4 v[44:47], v5, s[4:7], s28 offen sc1
s_add_u32 s28, s28, 262144
ds_read_u16 v24, v4 offset:320
ds_read_u16_d16_hi v25, v4 offset:4416
ds_read_u16 v26, v4 offset:8512
ds_read_u16_d16_hi v27, v4 offset:12608
ds_read_u16 v28, v4 offset:16704
ds_read_u16_d16_hi v29, v4 offset:20800
ds_read_u16 v30, v4 offset:24896
ds_read_u16_d16_hi v31, v4 offset:28992
s_waitcnt lgkmcnt(8)
v_or_b32 v48, v16, v17
v_or_b32 v49, v18, v19
v_or_b32 v50, v20, v21
v_or_b32 v51, v22, v23
buffer_store_dwordx4 v[48:51], v5, s[4:7], s28 offen sc1
s_add_u32 s28, s28, 262144
ds_read_u16 v16, v4 offset:384
ds_read_u16_d16_hi v17, v4 offset:4480
ds_read_u16 v18, v4 offset:8576
ds_read_u16_d16_hi v19, v4 offset:12672
ds_read_u16 v20, v4 offset:16768
ds_read_u16_d16_hi v21, v4 offset:20864
ds_read_u16 v22, v4 offset:24960
ds_read_u16_d16_hi v23, v4 offset:29056
s_waitcnt lgkmcnt(8)
v_or_b32 v52, v24, v25
v_or_b32 v53, v26, v27
v_or_b32 v54, v28, v29
v_or_b32 v55, v30, v31
buffer_store_dwordx4 v[52:55], v5, s[4:7], s28 offen sc1
s_add_u32 s28, s28, 262144
s_waitcnt lgkmcnt(0)
v_or_b32 v56, v16, v17
v_or_b32 v57, v18, v19
v_or_b32 v58, v20, v21
v_or_b32 v59, v22, v23
buffer_store_dwordx4 v[56:59], v5, s[4:7], s28 offen sc1
s_add_u32 s28, s28, 262144
s_sub_u32 s28, s28, 1834496
v_add_u32 v4, 32768, v4
v_add_u32 v6, 32768, v6
s_add_u32 s31, s31, 1
s_waitcnt vmcnt(10)
s_barrier
s_cmp_lt_u32 s31, 2
s_cbranch_scc1 KM_wt
s_load_dword s33, s[56:57], 0
s_load_dword s38, s[56:57], 128
s_waitcnt lgkmcnt(0)
s_add_u32 s33, s33, s38
s_cmp_ge_u32 s33, 32
s_cbranch_scc1 gate_39_d
v_and_b32 v2, 1, v1
v_lshlrev_b32 v2, 7, v2
s_mov_b32 s33, 0
gate_39:
global_load_dword v7, v2, s[56:57] sc1
s_add_u32 s33, s33, 1
s_cmp_gt_u32 s33, 32768
s_cbranch_scc1 gate_39_d
s_waitcnt vmcnt(0)
v_cmp_gt_u32 vcc, 16, v7
s_cbranch_vccnz gate_39
gate_39_d:
s_mov_b32 s29, 20635648
s_waitcnt vmcnt(0)
s_barrier
s_cmp_lg_u32 s20, 0
s_cbranch_scc1 sig_40
v_mov_b32 v5, 1
v_mul_u32_u24 v6, 128, v1
s_mov_b32 exec_lo, 4294967295
s_mov_b32 exec_hi, 4294967295
buffer_atomic_add v5, v6, s[4:7], s29 offen sc1
s_mov_b64 exec, -1
sig_40:
v_lshlrev_b32 v2, 4, v0
v_mov_b32 v8, -1
v_mov_b32 v9, -1
v_mov_b32 v10, -1
v_mov_b32 v11, -1
s_sub_u32 s28, s2, 224
s_lshl_b32 s28, s28, 12
s_add_u32 s28, s28, 5242880
pf_41:
buffer_store_dwordx4 v[8:11], v2, s[4:7], s28 offen sc1
s_add_u32 s28, s28, 131072
s_cmp_lt_u32 s28, 8912896
s_cbranch_scc1 pf_41
s_mov_b32 s29, 20643840
s_waitcnt vmcnt(0)
s_barrier
s_cmp_lg_u32 s20, 0
s_cbranch_scc1 sig_42
v_mov_b32 v5, 1
v_mul_u32_u24 v6, 128, v1
s_mov_b32 exec_lo, 4294967295
s_mov_b32 exec_hi, 4294967295
buffer_atomic_add v5, v6, s[4:7], s29 offen sc1
s_mov_b64 exec, -1
sig_42:
s_cmp_ge_u32 s2, 252
s_cbranch_scc1 KP_pf
KP_m2a:
s_cmp_lg_u32 s20, 0
s_cbranch_scc1 pi_43
s_and_b32 s28, s2, 7
s_lshl_b32 s28, s28, 7
s_add_u32 s28, s28, 20609024
v_mov_b32 v5, s28
v_mov_b32 v6, 28
s_mov_b64 s[50:51], 1
v_mov_b32 v2, 0
s_mov_b64 exec, s[50:51]
buffer_atomic_or v2, v5, s[4:7], 0 offen sc0 sc1
s_mov_b64 exec, -1
pi_43:
s_cmp_lg_u32 s20, 0
s_cbranch_scc1 poll_44_d
s_mov_b32 s28, 0
s_mov_b64 exec, s[50:51]
s_waitcnt vmcnt(0)
poll_44:
v_cmp_gt_u32 vcc, v6, v2
s_add_u32 s28, s28, 1
s_and_b64 exec, vcc, vcc
s_cbranch_scc0 poll_44_d
s_cmp_gt_u32 s28, 32768
s_cbranch_scc1 poll_44_d
v_mov_b32 v2, 0
buffer_atomic_or v2, v5, s[4:7], 0 offen sc0 sc1
s_waitcnt vmcnt(0)
s_branch poll_44
poll_44_d:
s_mov_b64 exec, -1
s_barrier
s_mov_b32 s28, 2129920
v_add_u32 v16, 0, v0
v_subrev_u32 v17, 224, v16
v_sub_u32 v18, 224, v16
v_max_i32 v17, v17, v18
v_sub_u32 v18, 448, v17
v_min_i32 v17, v17, v18
v_lshlrev_b32 v18, 3, v17
v_cmp_eq_u32 vcc, 224, v17
s_nop 1
v_cndmask_b32 v18, v18, 0, vcc
buffer_load_dwordx2 v[20:21], v18, s[4:7], s28 offen
v_add_u32 v24, 256, v0
v_subrev_u32 v25, 224, v24
v_sub_u32 v26, 224, v24
v_max_i32 v25, v25, v26
v_sub_u32 v26, 448, v25
v_min_i32 v25, v25, v26
v_lshlrev_b32 v26, 3, v25
v_cmp_eq_u32 vcc, 224, v25
s_nop 1
v_cndmask_b32 v26, v26, 0, vcc
buffer_load_dwordx2 v[28:29], v26, s[4:7], s28 offen
v_add_u32 v32, 512, v0
v_subrev_u32 v33, 224, v32
v_sub_u32 v34, 224, v32
v_max_i32 v33, v33, v34
v_sub_u32 v34, 448, v33
v_min_i32 v33, v33, v34
v_lshlrev_b32 v34, 3, v33
v_cmp_eq_u32 vcc, 224, v33
s_nop 1
v_cndmask_b32 v34, v34, 0, vcc
buffer_load_dwordx2 v[36:37], v34, s[4:7], s28 offen
s_waitcnt vmcnt(2)
v_cmp_eq_u32 vcc, 0, v17
s_nop 1
v_cndmask_b32 v20, v20, v21, vcc
v_cmp_eq_u32 s[40:41], 0, v17
v_cmp_eq_u32 vcc, 224, v17
s_nop 0
s_or_b64 vcc, vcc, s[40:41]
v_mov_b32 v18, 0x3c88d677
v_mov_b32 v19, 0x3cc1848f
v_cndmask_b32 v19, v18, v19, vcc
v_cndmask_b32 v21, v21, 0, vcc
v_mul_f32 v20, v20, v19
v_mul_f32 v21, v21, v18
v_cmp_gt_u32 vcc, 224, v16
s_nop 0
s_mov_b64 s[40:41], vcc
v_cmp_lt_u32 vcc, 448, v16
s_nop 0
s_or_b64 vcc, vcc, s[40:41]
v_xor_b32 v19, 0x80000000, v21
v_cndmask_b32 v21, v21, v19, vcc
v_xor_b32 v22, 0x80000000, v21
v_mov_b32 v23, v20
v_xor_b32 v19, 0x80000000, v20
v_mov_b32 v18, v21
v_lshlrev_b32 v17, 3, v16
v_cmp_gt_u32 vcc, 673, v16
s_nop 0
s_and_saveexec_b64 s[40:41], vcc
ds_write_b64 v17, v[20:21]
ds_write_b64 v17, v[22:23] offset:5392
ds_write_b64 v17, v[20:21] offset:10784
ds_write_b64 v17, v[18:19] offset:16176
s_mov_b64 exec, s[40:41]
s_waitcnt vmcnt(1)
v_cmp_eq_u32 vcc, 0, v25
s_nop 1
v_cndmask_b32 v28, v28, v29, vcc
v_cmp_eq_u32 s[40:41], 0, v25
v_cmp_eq_u32 vcc, 224, v25
s_nop 0
s_or_b64 vcc, vcc, s[40:41]
v_mov_b32 v26, 0x3c88d677
v_mov_b32 v27, 0x3cc1848f
v_cndmask_b32 v27, v26, v27, vcc
v_cndmask_b32 v29, v29, 0, vcc
v_mul_f32 v28, v28, v27
v_mul_f32 v29, v29, v26
v_cmp_gt_u32 vcc, 224, v24
s_nop 0
s_mov_b64 s[40:41], vcc
v_cmp_lt_u32 vcc, 448, v24
s_nop 0
s_or_b64 vcc, vcc, s[40:41]
v_xor_b32 v27, 0x80000000, v29
v_cndmask_b32 v29, v29, v27, vcc
v_xor_b32 v30, 0x80000000, v29
v_mov_b32 v31, v28
v_xor_b32 v27, 0x80000000, v28
v_mov_b32 v26, v29
v_lshlrev_b32 v25, 3, v24
v_cmp_gt_u32 vcc, 673, v24
s_nop 0
s_and_saveexec_b64 s[40:41], vcc
ds_write_b64 v25, v[28:29]
ds_write_b64 v25, v[30:31] offset:5392
ds_write_b64 v25, v[28:29] offset:10784
ds_write_b64 v25, v[26:27] offset:16176
s_mov_b64 exec, s[40:41]
s_waitcnt vmcnt(0)
v_cmp_eq_u32 vcc, 0, v33
s_nop 1
v_cndmask_b32 v36, v36, v37, vcc
v_cmp_eq_u32 s[40:41], 0, v33
v_cmp_eq_u32 vcc, 224, v33
s_nop 0
s_or_b64 vcc, vcc, s[40:41]
v_mov_b32 v34, 0x3c88d677
v_mov_b32 v35, 0x3cc1848f
v_cndmask_b32 v35, v34, v35, vcc
v_cndmask_b32 v37, v37, 0, vcc
v_mul_f32 v36, v36, v35
v_mul_f32 v37, v37, v34
v_cmp_gt_u32 vcc, 224, v32
s_nop 0
s_mov_b64 s[40:41], vcc
v_cmp_lt_u32 vcc, 448, v32
s_nop 0
s_or_b64 vcc, vcc, s[40:41]
v_xor_b32 v35, 0x80000000, v37
v_cndmask_b32 v37, v37, v35, vcc
v_xor_b32 v38, 0x80000000, v37
v_mov_b32 v39, v36
v_xor_b32 v35, 0x80000000, v36
v_mov_b32 v34, v37
v_lshlrev_b32 v33, 3, v32
v_cmp_gt_u32 vcc, 673, v32
s_nop 0
s_and_saveexec_b64 s[40:41], vcc
ds_write_b64 v33, v[36:37]
ds_write_b64 v33, v[38:39] offset:5392
ds_write_b64 v33, v[36:37] offset:10784
ds_write_b64 v33, v[34:35] offset:16176
s_mov_b64 exec, s[40:41]
s_sub_u32 s28, s2, 224
s_lshl_b32 s29, s28, 4
s_mul_i32 s28, s28, 14
s_add_u32 s28, s28, s20
s_lshl_b32 s28, s28, 10
s_add_u32 s28, s28, 16777216
v_and_b32 v5, 15, v1
v_add_u32 v5, s29, v5
v_lshrrev_b32 v6, 1, v5
v_and_b32 v7, 1, v5
v_mov_b32 v12, 224
v_cmp_eq_u32 vcc, 0, v5
s_nop 1
v_cndmask_b32 v6, v6, v12, vcc
v_cmp_gt_u32 vcc, 2, v5
s_nop 1
v_cndmask_b32 v7, v7, 0, vcc
v_mov_b32 v12, 0x3f3504f3
v_cndmask_b32 v10, 1.0, v12, vcc
v_mul_u32_u24 v7, 5392, v7
v_lshrrev_b32 v13, 4, v1
v_lshlrev_b32 v14, 1, v13
s_lshl_b32 s30, s20, 4
v_add_u32 v14, s30, v14
v_or_b32 v13, s20, v13
v_sub_u32 v8, 224, v6
v_add_u32 v9, 224, v6
v_lshl_add_u32 v15, v8, 3, v7
v_lshl_add_u32 v12, v9, 3, v7
v_add_u32 v8, v8, v14
v_add_u32 v9, v9, v14
v_lshl_add_u32 v8, v8, 3, v7
v_lshl_add_u32 v9, v9, 3, v7
s_waitcnt lgkmcnt(0)
s_barrier
ds_read_b32 v40, v15 offset:1792
ds_read_b32 v41, v12 offset:12576
ds_read_b64 v[112:113], v8 offset:0
ds_read_b64 v[114:115], v9 offset:10784
ds_read_b64 v[116:117], v8 offset:8
ds_read_b64 v[118:119], v9 offset:10792
ds_read_b64 v[120:121], v8 offset:64
ds_read_b64 v[122:123], v9 offset:10848
ds_read_b64 v[124:125], v8 offset:72
ds_read_b64 v[126:127], v9 offset:10856
ds_read_b64 v[128:129], v8 offset:512
ds_read_b64 v[130:131], v9 offset:11296
ds_read_b64 v[132:133], v8 offset:520
ds_read_b64 v[134:135], v9 offset:11304
ds_read_b64 v[136:137], v8 offset:576
ds_read_b64 v[138:139], v9 offset:11360
ds_read_b64 v[140:141], v8 offset:584
ds_read_b64 v[142:143], v9 offset:11368
ds_read_b64 v[144:145], v8 offset:1024
ds_read_b64 v[146:147], v9 offset:11808
ds_read_b64 v[148:149], v8 offset:1032
ds_read_b64 v[150:151], v9 offset:11816
ds_read_b64 v[152:153], v8 offset:1088
ds_read_b64 v[154:155], v9 offset:11872
ds_read_b64 v[156:157], v8 offset:1096
ds_read_b64 v[158:159], v9 offset:11880
ds_read_b64 v[160:161], v8 offset:1536
ds_read_b64 v[162:163], v9 offset:12320
ds_read_b64 v[164:165], v8 offset:1544
ds_read_b64 v[166:167], v9 offset:12328
ds_read_b64 v[168:169], v8 offset:1600
ds_read_b64 v[170:171], v9 offset:12384
ds_read_b64 v[172:173], v8 offset:1608
ds_read_b64 v[174:175], v9 offset:12392
v_lshlrev_b32 v6, 4, v1
s_waitcnt lgkmcnt(15)
v_pk_add_f32 v[112:113], v[112:113], v[114:115]
v_pk_add_f32 v[116:117], v[116:117], v[118:119]
v_pk_add_f32 v[120:121], v[120:121], v[122:123]
v_pk_add_f32 v[124:125], v[124:125], v[126:127]
v_add_f32 v40, v40, v41
v_mul_f32 v40, 0x3f3504f3, v40
v_cmp_eq_u32 vcc, 0, v13
s_nop 1
v_cndmask_b32 v112, v112, v40, vcc
v_cndmask_b32 v113, v113, 0, vcc
v_pk_mul_f32 v[112:113], v[112:113], v[10:11] op_sel_hi:[1,0]
v_pk_mul_f32 v[116:117], v[116:117], v[10:11] op_sel_hi:[1,0]
v_pk_mul_f32 v[120:121], v[120:121], v[10:11] op_sel_hi:[1,0]
v_pk_mul_f32 v[124:125], v[124:125], v[10:11] op_sel_hi:[1,0]
v_cvt_pk_bf16_f32 v48, v112, v113
v_cvt_pk_bf16_f32 v49, v116, v117
v_cvt_pk_bf16_f32 v50, v120, v121
v_cvt_pk_bf16_f32 v51, v124, v125
buffer_store_dwordx4 v[48:51], v6, s[4:7], s28 offen sc1
s_add_u32 s28, s28, 4096
s_waitcnt lgkmcnt(15)
v_pk_add_f32 v[128:129], v[128:129], v[130:131]
v_pk_add_f32 v[132:133], v[132:133], v[134:135]
v_pk_add_f32 v[136:137], v[136:137], v[138:139]
v_pk_add_f32 v[140:141], v[140:141], v[142:143]
v_pk_mul_f32 v[128:129], v[128:129], v[10:11] op_sel_hi:[1,0]
v_pk_mul_f32 v[132:133], v[132:133], v[10:11] op_sel_hi:[1,0]
v_pk_mul_f32 v[136:137], v[136:137], v[10:11] op_sel_hi:[1,0]
v_pk_mul_f32 v[140:141], v[140:141], v[10:11] op_sel_hi:[1,0]
v_cvt_pk_bf16_f32 v52, v128, v129
v_cvt_pk_bf16_f32 v53, v132, v133
v_cvt_pk_bf16_f32 v54, v136, v137
v_cvt_pk_bf16_f32 v55, v140, v141
buffer_store_dwordx4 v[52:55], v6, s[4:7], s28 offen sc1
s_add_u32 s28, s28, 4096
s_waitcnt lgkmcnt(8)
v_pk_add_f32 v[144:145], v[144:145], v[146:147]
v_pk_add_f32 v[148:149], v[148:149], v[150:151]
v_pk_add_f32 v[152:153], v[152:153], v[154:155]
v_pk_add_f32 v[156:157], v[156:157], v[158:159]
v_pk_mul_f32 v[144:145], v[144:145], v[10:11] op_sel_hi:[1,0]
v_pk_mul_f32 v[148:149], v[148:149], v[10:11] op_sel_hi:[1,0]
v_pk_mul_f32 v[152:153], v[152:153], v[10:11] op_sel_hi:[1,0]
v_pk_mul_f32 v[156:157], v[156:157], v[10:11] op_sel_hi:[1,0]
v_cvt_pk_bf16_f32 v56, v144, v145
v_cvt_pk_bf16_f32 v57, v148, v149
v_cvt_pk_bf16_f32 v58, v152, v153
v_cvt_pk_bf16_f32 v59, v156, v157
buffer_store_dwordx4 v[56:59], v6, s[4:7], s28 offen sc1
s_add_u32 s28, s28, 4096
s_waitcnt lgkmcnt(0)
v_pk_add_f32 v[160:161], v[160:161], v[162:163]
v_pk_add_f32 v[164:165], v[164:165], v[166:167]
v_pk_add_f32 v[168:169], v[168:169], v[170:171]
v_pk_add_f32 v[172:173], v[172:173], v[174:175]
v_pk_mul_f32 v[160:161], v[160:161], v[10:11] op_sel_hi:[1,0]
v_pk_mul_f32 v[164:165], v[164:165], v[10:11] op_sel_hi:[1,0]
v_pk_mul_f32 v[168:169], v[168:169], v[10:11] op_sel_hi:[1,0]
v_pk_mul_f32 v[172:173], v[172:173], v[10:11] op_sel_hi:[1,0]
v_cvt_pk_bf16_f32 v60, v160, v161
v_cvt_pk_bf16_f32 v61, v164, v165
v_cvt_pk_bf16_f32 v62, v168, v169
v_cvt_pk_bf16_f32 v63, v172, v173
s_cmp_ge_u32 s20, 2
s_cbranch_scc1 KP_m2s
buffer_store_dwordx4 v[60:63], v6, s[4:7], s28 offen sc1
s_add_u32 s28, s28, 4096
KP_m2s:
s_mov_b32 s29, 20627456
s_waitcnt vmcnt(0)
s_barrier
s_cmp_lg_u32 s20, 0
s_cbranch_scc1 sig_45
v_mov_b32 v5, 1
v_mul_u32_u24 v6, 128, v1
s_mov_b32 exec_lo, 4294967295
s_mov_b32 exec_hi, 4294967295
buffer_atomic_add v5, v6, s[4:7], s29 offen sc1
s_mov_b64 exec, -1
sig_45:
s_load_dwordx2 s[8:9], s[0:1], 64
s_load_dwordx2 s[12:13], s[0:1], 72
s_cmp_ge_u32 s2, 245
s_cbranch_scc1 KP_pf
s_cmp_lt_u32 s2, 231
s_cbranch_scc1 KP_qt
s_sub_u32 s28, s2, 231
s_and_b32 s29, s28, 1
s_lshr_b32 s30, s20, 1
s_and_b32 s31, s20, 1
s_andn2_b32 s32, s28, 1
s_add_u32 s32, s32, s30
s_mul_i32 s32, s32, 28672
s_mul_i32 s33, s31, 448
s_add_u32 s32, s32, s33
s_lshl_b32 s33, s28, 1
s_add_u32 s33, s33, s30
s_lshl_b32 s33, s33, 1
s_add_u32 s33, s33, s31
s_mul_i32 s33, s33, 14336
s_add_u32 s33, s33, 18628608
v_and_b32 v5, 31, v1
v_mul_u32_u24 v5, 896, v5
v_lshrrev_b32 v6, 5, v1
v_lshl_add_u32 v5, v6, 4, v5
v_lshlrev_b32 v6, 4, v1
s_waitcnt lgkmcnt(0)
s_cmp_eq_u32 s29, 0
s_cselect_b32 s8, s8, s12
s_cselect_b32 s9, s9, s13
s_mov_b32 s10, 401408
s_mov_b32 s11, 0x20000
s_mov_b32 s6, 30408704
s_mov_b32 s7, 0x20000
buffer_load_dwordx4 v[8:11], v5, s[8:11], s32 offen offset:0
buffer_load_dwordx4 v[12:15], v5, s[8:11], s32 offen offset:32
buffer_load_dwordx4 v[16:19], v5, s[8:11], s32 offen offset:64
buffer_load_dwordx4 v[20:23], v5, s[8:11], s32 offen offset:96
buffer_load_dwordx4 v[24:27], v5, s[8:11], s32 offen offset:128
buffer_load_dwordx4 v[28:31], v5, s[8:11], s32 offen offset:160
buffer_load_dwordx4 v[32:35], v5, s[8:11], s32 offen offset:192
buffer_load_dwordx4 v[36:39], v5, s[8:11], s32 offen offset:224
buffer_load_dwordx4 v[40:43], v5, s[8:11], s32 offen offset:256
buffer_load_dwordx4 v[44:47], v5, s[8:11], s32 offen offset:288
buffer_load_dwordx4 v[48:51], v5, s[8:11], s32 offen offset:320
buffer_load_dwordx4 v[52:55], v5, s[8:11], s32 offen offset:352
buffer_load_dwordx4 v[56:59], v5, s[8:11], s32 offen offset:384
buffer_load_dwordx4 v[60:63], v5, s[8:11], s32 offen offset:416
s_waitcnt vmcnt(13)
buffer_store_dwordx4 v[8:11], v6, s[4:7], s33 offen sc1
s_add_u32 s33, s33, 1024
s_waitcnt vmcnt(13)
buffer_store_dwordx4 v[12:15], v6, s[4:7], s33 offen sc1
s_add_u32 s33, s33, 1024
s_waitcnt vmcnt(13)
buffer_store_dwordx4 v[16:19], v6, s[4:7], s33 offen sc1
s_add_u32 s33, s33, 1024
s_waitcnt vmcnt(13)
buffer_store_dwordx4 v[20:23], v6, s[4:7], s33 offen sc1
s_add_u32 s33, s33, 1024
s_waitcnt vmcnt(13)
buffer_store_dwordx4 v[24:27], v6, s[4:7], s33 offen sc1
s_add_u32 s33, s33, 1024
s_waitcnt vmcnt(13)
buffer_store_dwordx4 v[28:31], v6, s[4:7], s33 offen sc1
s_add_u32 s33, s33, 1024
s_waitcnt vmcnt(13)
buffer_store_dwordx4 v[32:35], v6, s[4:7], s33 offen sc1
s_add_u32 s33, s33, 1024
s_waitcnt vmcnt(13)
buffer_store_dwordx4 v[36:39], v6, s[4:7], s33 offen sc1
s_add_u32 s33, s33, 1024
s_waitcnt vmcnt(13)
buffer_store_dwordx4 v[40:43], v6, s[4:7], s33 offen sc1
s_add_u32 s33, s33, 1024
s_waitcnt vmcnt(13)
buffer_store_dwordx4 v[44:47], v6, s[4:7], s33 offen sc1
s_add_u32 s33, s33, 1024
s_waitcnt vmcnt(13)
buffer_store_dwordx4 v[48:51], v6, s[4:7], s33 offen sc1
s_add_u32 s33, s33, 1024
s_waitcnt vmcnt(13)
buffer_store_dwordx4 v[52:55], v6, s[4:7], s33 offen sc1
s_add_u32 s33, s33, 1024
s_waitcnt vmcnt(13)
buffer_store_dwordx4 v[56:59], v6, s[4:7], s33 offen sc1
s_add_u32 s33, s33, 1024
s_waitcnt vmcnt(13)
buffer_store_dwordx4 v[60:63], v6, s[4:7], s33 offen sc1
s_add_u32 s33, s33, 1024
s_branch KP_auxsig
KP_qt:
s_mov_b32 s25, 0x3b124925
s_mov_b32 s26, 0x43e00000
s_sub_u32 s28, s2, 224
s_lshl_b32 s28, s28, 2
s_add_u32 s28, s28, s20
s_lshl_b32 s29, s28, 4
s_mul_i32 s28, s28, 14336
s_add_u32 s28, s28, 17178624
v_and_b32 v12, 15, v1
v_add_u32 v12, s29, v12
v_cvt_f32_u32 v7, v12
v_lshrrev_b32 v13, 4, v1
v_lshlrev_b32 v14, 1, v13
v_cvt_f32_u32 v14, v14
v_add_f32 v10, 0x42c00000, v14
v_mul_f32 v10, v10, v7
v_mul_f32 v9, 0x41800000, v7
v_mul_f32 v114, 0x40e00000, v7
v_mov_b32 v6, 0x3d88d677
v_mul_f32 v115, s25, v10
v_rndne_f32 v115, v115
v_fma_f32 v10, -v115, s26, v10
v_mul_f32 v10, s25, v10
v_mul_f32 v115, s25, v9
v_rndne_f32 v115, v115
v_fma_f32 v9, -v115, s26, v9
v_mul_f32 v9, s25, v9
v_mul_f32 v115, s25, v114
v_rndne_f32 v115, v115
v_fma_f32 v114, -v115, s26, v114
v_mul_f32 v114, s25, v114
v_cos_f32 v8, v9
v_add_f32 v11, v10, v9
v_mov_b32 v112, 0x3e800000
v_mul_f32 v113, s25, v7
v_subrev_f32 v113, 0x3e800000, v113
v_subrev_f32 v114, 0x3e800000, v114
v_cos_f32 v16, v10
v_add_f32 v10, v10, v112
v_cos_f32 v24, v11
v_add_f32 v11, v11, v112
v_cos_f32 v17, v10
v_add_f32 v10, v10, v113
v_cos_f32 v25, v11
v_add_f32 v11, v11, v113
v_cos_f32 v18, v10
v_add_f32 v10, v10, v112
v_cos_f32 v26, v11
v_add_f32 v11, v11, v112
v_cos_f32 v19, v10
v_add_f32 v10, v10, v114
v_cos_f32 v27, v11
v_add_f32 v11, v11, v114
v_cos_f32 v20, v10
v_add_f32 v10, v10, v112
v_cos_f32 v28, v11
v_add_f32 v11, v11, v112
v_cos_f32 v21, v10
v_add_f32 v10, v10, v113
v_cos_f32 v29, v11
v_add_f32 v11, v11, v113
v_cos_f32 v22, v10
v_add_f32 v10, v10, v112
v_cos_f32 v30, v11
v_add_f32 v11, v11, v112
v_cos_f32 v23, v10
v_cos_f32 v31, v11
v_add_f32 v8, v8, v8
v_pk_mul_f32 v[16:17], v[16:17], v[6:7] op_sel_hi:[1,0]
v_pk_mul_f32 v[18:19], v[18:19], v[6:7] op_sel_hi:[1,0]
v_pk_mul_f32 v[20:21], v[20:21], v[6:7] op_sel_hi:[1,0]
v_pk_mul_f32 v[22:23], v[22:23], v[6:7] op_sel_hi:[1,0]
v_pk_mul_f32 v[24:25], v[24:25], v[6:7] op_sel_hi:[1,0]
v_pk_mul_f32 v[26:27], v[26:27], v[6:7] op_sel_hi:[1,0]
v_pk_mul_f32 v[28:29], v[28:29], v[6:7] op_sel_hi:[1,0]
v_pk_mul_f32 v[30:31], v[30:31], v[6:7] op_sel_hi:[1,0]
v_pk_fma_f32 v[32:33], v[8:9], v[16:17], v[24:25] op_sel_hi:[0,1,1] neg_lo:[0,0,1] neg_hi:[0,0,1]
v_pk_fma_f32 v[34:35], v[8:9], v[18:19], v[26:27] op_sel_hi:[0,1,1] neg_lo:[0,0,1] neg_hi:[0,0,1]
v_pk_fma_f32 v[36:37], v[8:9], v[20:21], v[28:29] op_sel_hi:[0,1,1] neg_lo:[0,0,1] neg_hi:[0,0,1]
v_pk_fma_f32 v[38:39], v[8:9], v[22:23], v[30:31] op_sel_hi:[0,1,1] neg_lo:[0,0,1] neg_hi:[0,0,1]
v_pk_fma_f32 v[40:41], v[8:9], v[24:25], v[16:17] op_sel_hi:[0,1,1] neg_lo:[0,0,1] neg_hi:[0,0,1]
v_pk_fma_f32 v[42:43], v[8:9], v[26:27], v[18:19] op_sel_hi:[0,1,1] neg_lo:[0,0,1] neg_hi:[0,0,1]
v_pk_fma_f32 v[44:45], v[8:9], v[28:29], v[20:21] op_sel_hi:[0,1,1] neg_lo:[0,0,1] neg_hi:[0,0,1]
v_pk_fma_f32 v[46:47], v[8:9], v[30:31], v[22:23] op_sel_hi:[0,1,1] neg_lo:[0,0,1] neg_hi:[0,0,1]
v_cvt_pk_bf16_f32 v72, v16, v17
v_cvt_pk_bf16_f32 v73, v18, v19
v_cvt_pk_bf16_f32 v74, v20, v21
v_cvt_pk_bf16_f32 v75, v22, v23
v_cvt_pk_bf16_f32 v76, v24, v25
v_cvt_pk_bf16_f32 v77, v26, v27
v_cvt_pk_bf16_f32 v78, v28, v29
v_cvt_pk_bf16_f32 v79, v30, v31
v_pk_fma_f32 v[24:25], v[8:9], v[40:41], v[24:25] op_sel_hi:[0,1,1] neg_lo:[0,0,1] neg_hi:[0,0,1]
v_pk_fma_f32 v[26:27], v[8:9], v[42:43], v[26:27] op_sel_hi:[0,1,1] neg_lo:[0,0,1] neg_hi:[0,0,1]
v_pk_fma_f32 v[28:29], v[8:9], v[44:45], v[28:29] op_sel_hi:[0,1,1] neg_lo:[0,0,1] neg_hi:[0,0,1]
v_pk_fma_f32 v[30:31], v[8:9], v[46:47], v[30:31] op_sel_hi:[0,1,1] neg_lo:[0,0,1] neg_hi:[0,0,1]
v_pk_fma_f32 v[16:17], v[8:9], v[32:33], v[16:17] op_sel_hi:[0,1,1] neg_lo:[0,0,1] neg_hi:[0,0,1]
v_pk_fma_f32 v[18:19], v[8:9], v[34:35], v[18:19] op_sel_hi:[0,1,1] neg_lo:[0,0,1] neg_hi:[0,0,1]
v_pk_fma_f32 v[20:21], v[8:9], v[36:37], v[20:21] op_sel_hi:[0,1,1] neg_lo:[0,0,1] neg_hi:[0,0,1]
v_pk_fma_f32 v[22:23], v[8:9], v[38:39], v[22:23] op_sel_hi:[0,1,1] neg_lo:[0,0,1] neg_hi:[0,0,1]
v_cvt_pk_bf16_f32 v80, v40, v41
v_cvt_pk_bf16_f32 v81, v42, v43
v_cvt_pk_bf16_f32 v82, v44, v45
v_cvt_pk_bf16_f32 v83, v46, v47
v_cvt_pk_bf16_f32 v68, v32, v33
v_cvt_pk_bf16_f32 v69, v34, v35
v_cvt_pk_bf16_f32 v70, v36, v37
v_cvt_pk_bf16_f32 v71, v38, v39
v_pk_fma_f32 v[40:41], v[8:9], v[24:25], v[40:41] op_sel_hi:[0,1,1] neg_lo:[0,0,1] neg_hi:[0,0,1]
v_pk_fma_f32 v[42:43], v[8:9], v[26:27], v[42:43] op_sel_hi:[0,1,1] neg_lo:[0,0,1] neg_hi:[0,0,1]
v_pk_fma_f32 v[44:45], v[8:9], v[28:29], v[44:45] op_sel_hi:[0,1,1] neg_lo:[0,0,1] neg_hi:[0,0,1]
v_pk_fma_f32 v[46:47], v[8:9], v[30:31], v[46:47] op_sel_hi:[0,1,1] neg_lo:[0,0,1] neg_hi:[0,0,1]
v_pk_fma_f32 v[32:33], v[8:9], v[16:17], v[32:33] op_sel_hi:[0,1,1] neg_lo:[0,0,1] neg_hi:[0,0,1]
v_pk_fma_f32 v[34:35], v[8:9], v[18:19], v[34:35] op_sel_hi:[0,1,1] neg_lo:[0,0,1] neg_hi:[0,0,1]
v_pk_fma_f32 v[36:37], v[8:9], v[20:21], v[36:37] op_sel_hi:[0,1,1] neg_lo:[0,0,1] neg_hi:[0,0,1]
v_pk_fma_f32 v[38:39], v[8:9], v[22:23], v[38:39] op_sel_hi:[0,1,1] neg_lo:[0,0,1] neg_hi:[0,0,1]
v_cvt_pk_bf16_f32 v84, v24, v25
v_cvt_pk_bf16_f32 v85, v26, v27
v_cvt_pk_bf16_f32 v86, v28, v29
v_cvt_pk_bf16_f32 v87, v30, v31
v_cvt_pk_bf16_f32 v64, v16, v17
v_cvt_pk_bf16_f32 v65, v18, v19
v_cvt_pk_bf16_f32 v66, v20, v21
v_cvt_pk_bf16_f32 v67, v22, v23
v_pk_fma_f32 v[24:25], v[8:9], v[40:41], v[24:25] op_sel_hi:[0,1,1] neg_lo:[0,0,1] neg_hi:[0,0,1]
v_pk_fma_f32 v[26:27], v[8:9], v[42:43], v[26:27] op_sel_hi:[0,1,1] neg_lo:[0,0,1] neg_hi:[0,0,1]
v_pk_fma_f32 v[28:29], v[8:9], v[44:45], v[28:29] op_sel_hi:[0,1,1] neg_lo:[0,0,1] neg_hi:[0,0,1]
v_pk_fma_f32 v[30:31], v[8:9], v[46:47], v[30:31] op_sel_hi:[0,1,1] neg_lo:[0,0,1] neg_hi:[0,0,1]
v_pk_fma_f32 v[16:17], v[8:9], v[32:33], v[16:17] op_sel_hi:[0,1,1] neg_lo:[0,0,1] neg_hi:[0,0,1]
v_pk_fma_f32 v[18:19], v[8:9], v[34:35], v[18:19] op_sel_hi:[0,1,1] neg_lo:[0,0,1] neg_hi:[0,0,1]
v_pk_fma_f32 v[20:21], v[8:9], v[36:37], v[20:21] op_sel_hi:[0,1,1] neg_lo:[0,0,1] neg_hi:[0,0,1]
v_pk_fma_f32 v[22:23], v[8:9], v[38:39], v[22:23] op_sel_hi:[0,1,1] neg_lo:[0,0,1] neg_hi:[0,0,1]
v_cvt_pk_bf16_f32 v88, v40, v41
v_cvt_pk_bf16_f32 v89, v42, v43
v_cvt_pk_bf16_f32 v90, v44, v45
v_cvt_pk_bf16_f32 v91, v46, v47
v_cvt_pk_bf16_f32 v60, v32, v33
v_cvt_pk_bf16_f32 v61, v34, v35
v_cvt_pk_bf16_f32 v62, v36, v37
v_cvt_pk_bf16_f32 v63, v38, v39
v_pk_fma_f32 v[40:41], v[8:9], v[24:25], v[40:41] op_sel_hi:[0,1,1] neg_lo:[0,0,1] neg_hi:[0,0,1]
v_pk_fma_f32 v[42:43], v[8:9], v[26:27], v[42:43] op_sel_hi:[0,1,1] neg_lo:[0,0,1] neg_hi:[0,0,1]
v_pk_fma_f32 v[44:45], v[8:9], v[28:29], v[44:45] op_sel_hi:[0,1,1] neg_lo:[0,0,1] neg_hi:[0,0,1]
v_pk_fma_f32 v[46:47], v[8:9], v[30:31], v[46:47] op_sel_hi:[0,1,1] neg_lo:[0,0,1] neg_hi:[0,0,1]
v_pk_fma_f32 v[32:33], v[8:9], v[16:17], v[32:33] op_sel_hi:[0,1,1] neg_lo:[0,0,1] neg_hi:[0,0,1]
v_pk_fma_f32 v[34:35], v[8:9], v[18:19], v[34:35] op_sel_hi:[0,1,1] neg_lo:[0,0,1] neg_hi:[0,0,1]
v_pk_fma_f32 v[36:37], v[8:9], v[20:21], v[36:37] op_sel_hi:[0,1,1] neg_lo:[0,0,1] neg_hi:[0,0,1]
v_pk_fma_f32 v[38:39], v[8:9], v[22:23], v[38:39] op_sel_hi:[0,1,1] neg_lo:[0,0,1] neg_hi:[0,0,1]
v_cvt_pk_bf16_f32 v92, v24, v25
v_cvt_pk_bf16_f32 v93, v26, v27
v_cvt_pk_bf16_f32 v94, v28, v29
v_cvt_pk_bf16_f32 v95, v30, v31
v_cvt_pk_bf16_f32 v56, v16, v17
v_cvt_pk_bf16_f32 v57, v18, v19
v_cvt_pk_bf16_f32 v58, v20, v21
v_cvt_pk_bf16_f32 v59, v22, v23
v_pk_fma_f32 v[24:25], v[8:9], v[40:41], v[24:25] op_sel_hi:[0,1,1] neg_lo:[0,0,1] neg_hi:[0,0,1]
v_pk_fma_f32 v[26:27], v[8:9], v[42:43], v[26:27] op_sel_hi:[0,1,1] neg_lo:[0,0,1] neg_hi:[0,0,1]
v_pk_fma_f32 v[28:29], v[8:9], v[44:45], v[28:29] op_sel_hi:[0,1,1] neg_lo:[0,0,1] neg_hi:[0,0,1]
v_pk_fma_f32 v[30:31], v[8:9], v[46:47], v[30:31] op_sel_hi:[0,1,1] neg_lo:[0,0,1] neg_hi:[0,0,1]
v_pk_fma_f32 v[16:17], v[8:9], v[32:33], v[16:17] op_sel_hi:[0,1,1] neg_lo:[0,0,1] neg_hi:[0,0,1]
v_pk_fma_f32 v[18:19], v[8:9], v[34:35], v[18:19] op_sel_hi:[0,1,1] neg_lo:[0,0,1] neg_hi:[0,0,1]
v_pk_fma_f32 v[20:21], v[8:9], v[36:37], v[20:21] op_sel_hi:[0,1,1] neg_lo:[0,0,1] neg_hi:[0,0,1]
v_pk_fma_f32 v[22:23], v[8:9], v[38:39], v[22:23] op_sel_hi:[0,1,1] neg_lo:[0,0,1] neg_hi:[0,0,1]
v_cvt_pk_bf16_f32 v96, v40, v41
v_cvt_pk_bf16_f32 v97, v42, v43
v_cvt_pk_bf16_f32 v98, v44, v45
v_cvt_pk_bf16_f32 v99, v46, v47
v_cvt_pk_bf16_f32 v52, v32, v33
v_cvt_pk_bf16_f32 v53, v34, v35
v_cvt_pk_bf16_f32 v54, v36, v37
v_cvt_pk_bf16_f32 v55, v38, v39
v_cvt_pk_bf16_f32 v100, v24, v25
v_cvt_pk_bf16_f32 v101, v26, v27
v_cvt_pk_bf16_f32 v102, v28, v29
v_cvt_pk_bf16_f32 v103, v30, v31
v_cvt_pk_bf16_f32 v48, v16, v17
v_cvt_pk_bf16_f32 v49, v18, v19
v_cvt_pk_bf16_f32 v50, v20, v21
v_cvt_pk_bf16_f32 v51, v22, v23
v_mov_b32 v10, 0x3d41848f
v_cvt_pk_bf16_f32 v10, v10, v10
v_and_b32 v12, 1, v12
v_lshlrev_b32 v12, 15, v12
v_xor_b32 v10, v10, v12
v_cmp_eq_u32 vcc, 0, v13
s_nop 1
v_cndmask_b32 v48, v48, v10, vcc
v_lshlrev_b32 v6, 4, v1
s_waitcnt lgkmcnt(0)
s_mov_b32 s6, 30408704
s_mov_b32 s7, 0x20000
buffer_store_dwordx4 v[48:51], v6, s[4:7], s28 offen sc1
s_add_u32 s28, s28, 1024
buffer_store_dwordx4 v[52:55], v6, s[4:7], s28 offen sc1
s_add_u32 s28, s28, 1024
buffer_store_dwordx4 v[56:59], v6, s[4:7], s28 offen sc1
s_add_u32 s28, s28, 1024
buffer_store_dwordx4 v[60:63], v6, s[4:7], s28 offen sc1
s_add_u32 s28, s28, 1024
buffer_store_dwordx4 v[64:67], v6, s[4:7], s28 offen sc1
s_add_u32 s28, s28, 1024
buffer_store_dwordx4 v[68:71], v6, s[4:7], s28 offen sc1
s_add_u32 s28, s28, 1024
buffer_store_dwordx4 v[72:75], v6, s[4:7], s28 offen sc1
s_add_u32 s28, s28, 1024
buffer_store_dwordx4 v[76:79], v6, s[4:7], s28 offen sc1
s_add_u32 s28, s28, 1024
buffer_store_dwordx4 v[80:83], v6, s[4:7], s28 offen sc1
s_add_u32 s28, s28, 1024
buffer_store_dwordx4 v[84:87], v6, s[4:7], s28 offen sc1
s_add_u32 s28, s28, 1024
buffer_store_dwordx4 v[88:91], v6, s[4:7], s28 offen sc1
s_add_u32 s28, s28, 1024
buffer_store_dwordx4 v[92:95], v6, s[4:7], s28 offen sc1
s_add_u32 s28, s28, 1024
buffer_store_dwordx4 v[96:99], v6, s[4:7], s28 offen sc1
s_add_u32 s28, s28, 1024
buffer_store_dwordx4 v[100:103], v6, s[4:7], s28 offen sc1
s_add_u32 s28, s28, 1024
KP_auxsig:
s_mov_b32 s29, 20590592
s_waitcnt vmcnt(0)
s_barrier
s_cmp_lg_u32 s20, 0
s_cbranch_scc1 sig_46
v_mov_b32 v5, 1
v_mul_u32_u24 v6, 128, v1
s_mov_b32 exec_lo, 65535
s_mov_b32 exec_hi, 0
buffer_atomic_add v5, v6, s[4:7], s29 offen sc1
s_mov_b64 exec, -1
sig_46:
v_lshlrev_b32 v2, 4, v0
v_mov_b32 v8, -1
v_mov_b32 v9, -1
v_mov_b32 v10, -1
v_mov_b32 v11, -1
s_sub_u32 s28, s2, 224
s_lshl_b32 s28, s28, 12
s_add_u32 s28, s28, 20971520
pf_47:
buffer_store_dwordx4 v[8:11], v2, s[4:7], s28 offen sc1
s_add_u32 s28, s28, 86016
s_cmp_lt_u32 s28, 24641536
s_cbranch_scc1 pf_47
s_mov_b32 s29, 20656128
s_waitcnt vmcnt(0)
s_barrier
s_cmp_lg_u32 s20, 0
s_cbranch_scc1 sig_48
v_mov_b32 v5, 1
v_mul_u32_u24 v6, 128, v1
s_mov_b32 exec_lo, 65535
s_mov_b32 exec_hi, 0
buffer_atomic_add v5, v6, s[4:7], s29 offen sc1
s_mov_b64 exec, -1
sig_48:
s_endpgm
KP_pf:
v_lshlrev_b32 v2, 4, v0
v_mov_b32 v8, -1
v_mov_b32 v9, -1
v_mov_b32 v10, -1
v_mov_b32 v11, -1
s_sub_u32 s28, s2, 245
s_lshl_b32 s28, s28, 12
s_add_u32 s28, s28, 9437184
pf_49:
buffer_store_dwordx4 v[8:11], v2, s[4:7], s28 offen sc1
s_add_u32 s28, s28, 45056
s_cmp_lt_u32 s28, 11272192
s_cbranch_scc1 pf_49
s_mov_b32 s29, 20586496
s_waitcnt vmcnt(0)
s_barrier
s_cmp_lg_u32 s20, 0
s_cbranch_scc1 sig_50
v_mov_b32 v5, 1
v_mul_u32_u24 v6, 128, v1
s_mov_b32 exec_lo, 65535
s_mov_b32 exec_hi, 0
buffer_atomic_add v5, v6, s[4:7], s29 offen sc1
s_mov_b64 exec, -1
sig_50:
v_lshlrev_b32 v2, 4, v0
v_mov_b32 v8, -1
v_mov_b32 v9, -1
v_mov_b32 v10, -1
v_mov_b32 v11, -1
s_sub_u32 s28, s2, 245
s_lshl_b32 s28, s28, 12
s_add_u32 s28, s28, 11534336
pf_51:
buffer_store_dwordx4 v[8:11], v2, s[4:7], s28 offen sc1
s_add_u32 s28, s28, 45056
s_cmp_lt_u32 s28, 13369344
s_cbranch_scc1 pf_51
s_mov_b32 s29, 20652032
s_waitcnt vmcnt(0)
s_barrier
s_cmp_lg_u32 s20, 0
s_cbranch_scc1 sig_52
v_mov_b32 v5, 1
v_mul_u32_u24 v6, 128, v1
s_mov_b32 exec_lo, 65535
s_mov_b32 exec_hi, 0
buffer_atomic_add v5, v6, s[4:7], s29 offen sc1
s_mov_b64 exec, -1
sig_52:
s_endpgm
.text
.p2align 8
code_end:
.fill 768, 4, 0xbf800000
.section .rodata,"a"
.p2align 6
.amdhsa_kernel km_kernel
  .amdhsa_next_free_vgpr 512
  .amdhsa_next_free_sgpr 102
  .amdhsa_accum_offset 256
  .amdhsa_group_segment_fixed_size 0
  .amdhsa_kernarg_size 120
  .amdhsa_user_sgpr_count 2
  .amdhsa_user_sgpr_kernarg_segment_ptr 1
  .amdhsa_system_sgpr_workgroup_id_x 1
  .amdhsa_float_denorm_mode_32 3
.end_amdhsa_kernel
```
